```python
import torch

def _softmax(x, axis=-1):
    return torch.softmax(x, dim=axis)

def _gelu(x):
    return torch.nn.functional.gelu(x, approximate='tanh')

def _silu(x):
    return torch.nn.functional.silu(x)

def _sigmoid(x):
    return torch.sigmoid(x)

def _layernorm(x, axis=-1, eps=1e-05):
    m = x.mean(dim=axis, keepdim=True)
    v = x.var(dim=axis, keepdim=True, unbiased=False)
    return (x - m) / torch.sqrt(v + eps)

def _scatter_add(tgt, idx, src, axis=0):
    return tgt.clone().index_add_(axis, idx, src)

def _segment_sum(src, seg, n):
    out = torch.zeros((n,) + src.shape[1:], dtype=src.dtype)
    return out.index_add_(0, seg, src)

def _pad(x, pw):
    flat = tuple((v for pair in reversed(pw) for v in pair))
    return torch.nn.functional.pad(x, flat)
kernel_name = 'parallel_sum__mha_block__mixer_gmlp__prompt'

def setup_inputs():

    _w = lambda a: (lambda t: t.to(torch.bfloat16) if t.is_floating_point() else t)(torch.as_tensor(a))

    def _A_setup():
        B, S, D, H = (1, 2048, 576, 32)
        return {'x': _w((lambda *s: torch.randn(*s, dtype=torch.bfloat16) * 0.05)(B, S, D)), 'wqkv': _w((lambda *s: torch.randn(*s, dtype=torch.bfloat16) * 0.2)(D, 3 * D)), 'wo': _w((lambda *s: torch.randn(*s, dtype=torch.bfloat16) * 0.1)(D, D))}
    _A_in = _A_setup()

    def _B_setup():
        B, S, D, F = (1, 2048, 576, 4608)
        Fh = F // 2
        return {'x': _w((lambda *s: torch.randn(*s, dtype=torch.bfloat16) * 0.05)(B, S, D)), 'w_in': _w((lambda *s: torch.randn(*s, dtype=torch.bfloat16) * 0.8)(D, 2 * Fh)), 'w_sp': _w(0.01 * (lambda *s: torch.randn(*s, dtype=torch.bfloat16) * 0.8)(S, S)), 'b_sp': _w(1.0 + 0.01 * (lambda *s: torch.randn(*s, dtype=torch.bfloat16) * 0.1)(S)), 'w_out': _w((lambda *s: torch.randn(*s, dtype=torch.bfloat16) * 0.1)(Fh, D))}
    _B_in = _B_setup()
    return {'A_x': _A_in['x'], 'A_wqkv': _A_in['wqkv'], 'A_wo': _A_in['wo'], 'B_x': _B_in['x'], 'B_w_in': _B_in['w_in'], 'B_w_sp': _B_in['w_sp'], 'B_b_sp': _B_in['b_sp'], 'B_w_out': _B_in['w_out']}

def reference(A_x, A_wqkv, A_wo, B_x, B_w_in, B_w_sp, B_b_sp, B_w_out):

    def _A_ref(x, wqkv, wo):
        B, S, D = x.shape
        H = 32
        Dh = D // H
        qkv = (lambda x, *d: x.permute(*d))((x @ wqkv).reshape(B, S, 3, H, Dh), 2, 0, 3, 1, 4)
        q, k, v = (qkv[0], qkv[1], qkv[2])
        scores = torch.einsum('bhqd,bhkd->bhqk', q, k) * Dh ** (-0.5)
        p = _softmax(scores, axis=-1)
        o = torch.einsum('bhqk,bhkd->bhqd', p, v)
        return (lambda x, *d: x.permute(*d))(o, 0, 2, 1, 3).reshape(B, S, D) @ wo

    def _B_ref(x, w_in, w_sp, b_sp, w_out):
        B, S, D = x.shape
        F = w_in.shape[-1]
        Fh = F // 2
        z = _gelu(torch.einsum('bsd,df->bsf', x, w_in))
        z1 = z[..., :Fh].clone()
        z2 = _layernorm(z[..., Fh:], axis=-1)
        g = torch.einsum('ts,bsf->btf', w_sp, z2) + b_sp[None, :, None]
        return torch.einsum('bsf,fd->bsd', z1 * g, w_out)
    x = A_x
    xn = _layernorm(x, axis=-1)
    return x + _A_ref(xn, A_wqkv, A_wo) + _B_ref(xn, B_w_in, B_w_sp, B_b_sp, B_w_out)
```

```asm
; @launch kernel=k1_proj_kernel grid=(256,1,1) block=(512,1,1) lds=161536
; @launch kernel=k3_out_kernel grid=(240,1,1) block=(256,1,1) lds=87040
.amdgcn_target "amdgcn-amd-amdhsa--gfx950"
.text
.globl k1_proj_kernel
.p2align 8
.type k1_proj_kernel,@function
k1_proj_kernel:
    s_getpc_b64 s[38:39]
L1_pc:
    s_cmp_ge_u32 s2, 256
    s_cbranch_scc1 L1_end
    v_cmp_gt_u32 vcc, 64, v0
    v_lshlrev_b32 v2, 7, v0
    s_and_saveexec_b64 s[70:71], vcc
    s_cbranch_execz L1_pf0
    global_load_dword v3, v2, s[38:39]
L1_pf0:
    s_mov_b64 exec, s[70:71]
    s_load_dwordx4 s[24:27], s[0:1], 0
    s_load_dwordx2 s[32:33], s[0:1], 32
    s_load_dwordx2 s[4:5], s[0:1], 40
    s_load_dwordx2 s[28:29], s[0:1], 80
    s_load_dwordx2 s[30:31], s[0:1], 72
    s_and_b32 s43, s2, 7
    s_lshr_b32 s44, s2, 3
    s_and_b32 s41, s43, 3
    s_lshl_b32 s41, s41, 2
    s_and_b32 s45, s44, 3
    s_add_u32 s41, s41, s45
    s_lshr_b32 s42, s43, 2
    s_lshl_b32 s42, s42, 3
    s_lshr_b32 s45, s44, 2
    s_add_u32 s42, s42, s45
    v_lshrrev_b32 v2, 6, v0
    v_and_b32 v1, 63, v0
    v_readfirstlane_b32 s40, v2
    s_nop 0
    s_lshr_b32 s43, s40, 2
    s_lshl_b32 s46, s43, 1
    s_and_b32 s44, s40, 1
    s_add_u32 s46, s46, s44
    s_lshr_b32 s47, s40, 1
    s_xor_b32 s47, s47, s43
    s_and_b32 s47, s47, 1
    s_lshl_b32 s50, s42, 8
    s_add_u32 s49, s50, 4608
    s_lshr_b32 s43, s42, 1
    s_lshl_b32 s43, s43, 6
    s_add_u32 s48, s43, 4096
    s_add_u32 s43, s48, 4608
    s_bitcmp1_b32 s42, 0
    s_cselect_b32 s48, s48, s43
    s_lshl_b32 s51, s42, 1
    s_sub_u32 s43, s42, 6
    s_max_i32 s43, s43, 0
    s_min_u32 s43, s43, 2
    s_sub_u32 s51, s51, s43
    s_sub_u32 s43, s42, 13
    s_max_i32 s43, s43, 0
    s_sub_u32 s51, s51, s43
    s_lshl_b32 s51, s51, 7
    s_waitcnt lgkmcnt(0)
    s_sub_u32 s38, s38, L1_pc-k1_proj_kernel
    s_subb_u32 s39, s39, 0
    s_add_u32 s54, s38, L1_table-k1_proj_kernel
    s_addc_u32 s55, s39, 0
    s_mov_b32 s4, s4
    s_and_b32 s5, s5, 0xffff
    s_mov_b32 s6, 8388608
    s_mov_b32 s7, 0x20000
    s_cmp_lg_u32 s40, 7
    s_cbranch_scc1 L1_nopf
    s_lshr_b32 s43, s2, 3
    s_mul_i32 s43, s43, 1408
    s_add_u32 s43, s43, k1_proj_kernel+8192-k1_proj_kernel
    v_lshlrev_b32 v2, 7, v1
    v_add_u32 v2, s43, v2
    v_min_u32 v2, L1_codeend-k1_proj_kernel-4, v2
    s_mov_b64 exec, 0x7ff
    global_load_dword v3, v2, s[38:39]
    s_mov_b64 exec, -1
L1_nopf:
    s_mov_b32 s8, s24
    s_and_b32 s9, s25, 0xffff
    s_mov_b32 s10, 2359296
    s_mov_b32 s11, 0x20000
    s_mov_b32 s16, s26
    s_and_b32 s17, s27, 0xffff
    s_mov_b32 s18, 1990656
    s_mov_b32 s19, 0x20000
    s_mov_b32 s12, s32
    s_and_b32 s13, s33, 0xffff
    s_mov_b32 s14, 5308416
    s_mov_b32 s15, 0x20000
    s_mov_b32 s20, s28
    s_and_b32 s21, s29, 0xffff
    s_mov_b32 s22, 51380224
    s_mov_b32 s23, 0x20000
    s_cmp_eq_u32 s47, 1
    s_cbranch_scc1 L1_B
    v_lshrrev_b32 v20, 3, v1
    v_mul_u32_u24 v21, 1152, v20
    v_and_b32 v22, 7, v1
    v_lshlrev_b32 v23, 4, v22
    v_add_u32 v21, v21, v23
    s_add_u32 s70, s40, s42
    s_and_b32 s70, s70, 7
    s_lshl_b32 s43, s41, 7
    s_lshl_b32 s44, s70, 3
    s_add_u32 s43, s43, s44
    s_mul_i32 s43, s43, 1152
    s_add_u32 s44, s43, 73728
    s_mov_b32 s69, s44
    v_mov_b32 v240, v21
    buffer_load_dwordx4 v[204:207], v240, s[8:11], s43 offen offset:0
    buffer_load_dwordx4 v[208:211], v240, s[8:11], s43 offen offset:128
    buffer_load_dwordx4 v[212:215], v240, s[8:11], s43 offen offset:256
    buffer_load_dwordx4 v[216:219], v240, s[8:11], s43 offen offset:384
    buffer_load_dwordx4 v[220:223], v240, s[8:11], s43 offen offset:512
    buffer_load_dwordx4 v[224:227], v240, s[8:11], s43 offen offset:640
    buffer_load_dwordx4 v[228:231], v240, s[8:11], s43 offen offset:768
    buffer_load_dwordx4 v[232:235], v240, s[8:11], s43 offen offset:896
    buffer_load_dwordx4 v[236:239], v240, s[8:11], s43 offen offset:1024
    s_sub_u32 s68, s40, 5
    s_cmp_gt_u32 s68, 0
    s_cbranch_scc1 L1_t0e0
    s_cmp_eq_u32 s68, 0
    s_cbranch_scc0 L1_t0w0
    v_lshlrev_b32 v2, 7, v1
    buffer_load_dword v3, v2, s[8:11], s69 offen
    s_branch L1_t0e0
L1_t0w0:
    s_sub_u32 s67, s68, 1
    s_lshl_b32 s67, s67, 8
    s_add_u32 s67, s67, s2
    s_cmp_lt_u32 s67, 288
    s_cbranch_scc0 L1_t0e0
    s_and_b32 s68, s67, 31
    s_lshr_b32 s67, s67, 5
    s_mul_i32 s67, s67, 589824
    s_lshl_b32 s68, s68, 7
    s_add_u32 s67, s67, s68
    s_add_u32 s67, s67, 4608
    v_mul_u32_u24 v2, 9216, v1
    buffer_load_dword v3, v2, s[12:15], s67 offen
L1_t0e0:
    v_lshrrev_b32 v23, 4, v1
    v_and_b32 v23, 1, v23
    v_lshlrev_b32 v23, 2, v23
    v_xor_b32 v23, v23, v22
    v_lshlrev_b32 v23, 4, v23
    v_mul_u32_u24 v4, 9216, v20
    v_add_u32 v4, v4, v23
    v_mul_u32_u24 v7, 3456, v20
    v_add_u32 v7, v7, v23
    v_lshrrev_b32 v248, 2, v1
    v_mul_u32_u24 v248, 9216, v248
    v_and_b32 v25, 3, v1
    v_lshlrev_b32 v25, 4, v25
    v_add_u32 v248, v248, v25
    s_mul_i32 s53, s46, 9216
    v_add_u32 v5, 72704, v4
    v_add_u32 v8, 26624, v7
    v_add_u32 v249, 146432, v248
    v_add_u32 v6, 145408, v4
    v_add_u32 v9, 53248, v7
    v_add_u32 v250, 292864, v248
    v_lshrrev_b32 v26, 5, v1
    v_bfe_u32 v27, v1, 2, 2
    v_lshlrev_b32 v28, 3, v26
    v_add_u32 v28, v28, v27
    v_bfe_u32 v29, v1, 4, 1
    v_lshlrev_b32 v29, 5, v29
    v_and_b32 v30, 3, v1
    v_lshlrev_b32 v31, 3, v30
    v_and_b32 v32, 1, v1
    v_lshlrev_b32 v32, 4, v32
    v_bfe_u32 v33, v1, 1, 1
    v_lshlrev_b32 v33, 3, v33
    v_add_u32 v32, v32, v33
    v_lshrrev_b32 v33, 1, v27
    v_xor_b32 v33, 1, v33
    v_lshlrev_b32 v33, 6, v33
    v_lshlrev_b32 v34, 7, v28
    v_add3_u32 v34, v34, v33, v29
    v_add_u32 v10, v34, v31
    v_add_u32 v11, v34, v32
    s_bitcmp1_b32 s42, 0
    s_cselect_b64 vcc, -1, 0
    v_cndmask_b32 v31, v32, v31, vcc
    v_lshlrev_b32 v34, 6, v28
    v_add3_u32 v12, v34, v29, v31
    v_and_b32 v27, 31, v1
    v_bfe_u32 v28, v1, 2, 1
    v_lshlrev_b32 v28, 9, v28
    v_bfe_u32 v29, v1, 3, 2
    v_lshlrev_b32 v29, 7, v29
    v_lshlrev_b32 v30, 5, v30
    v_lshlrev_b32 v31, 4, v26
    v_add3_u32 v14, v28, v29, v30
    v_add_u32 v14, v14, v31
    v_bfe_u32 v28, v1, 4, 1
    v_mul_u32_u24 v28, 73728, v28
    v_and_b32 v29, 15, v1
    v_lshlrev_b32 v29, 4, v29
    v_lshlrev_b32 v30, 8, v26
    v_add3_u32 v15, v28, v29, v30
    s_lshl_b32 s43, s41, 2
    s_add_u32 s43, s43, s46
    s_mul_i32 s44, s43, 4608
    v_lshlrev_b32 v28, 3, v27
    v_add_u32 v16, s44, v28
    v_mov_b32 v18, 0
    v_mov_b32 v19, 0
    s_mov_b32 s52, 0xbede652a
    s_lshl_b32 s43, s43, 10
    s_lshl_b32 s44, s42, 3
    s_add_u32 s44, s44, 2
    s_mul_i32 s44, s44, 66560
    s_add_u32 s58, s43, s44
    s_add_u32 s59, s58, 66560
    s_add_u32 s60, s58, 266240
    s_add_u32 s61, s58, 332800
    s_add_u32 s44, s42, 128
    s_mul_i32 s44, s44, 66560
    s_add_u32 s62, s43, s44
    s_add_u32 s63, s62, 66560
    s_lshl_b32 s43, s41, 3
    s_lshl_b32 s44, s46, 1
    s_add_u32 s43, s43, s44
    s_mul_i32 s43, s43, 73728
    s_add_u32 s43, s43, 10485760
    s_lshl_b32 s44, s42, 12
    s_add_u32 s64, s43, s44
    s_add_u32 s64, s64, 1024
    s_add_u32 s65, s64, 2048
    s_lshr_b32 s44, s42, 1
    s_add_u32 s44, s44, 64
    s_lshl_b32 s44, s44, 10
    s_add_u32 s66, s43, s44
    s_lshl_b32 s43, s70, 3
    v_add_u32 v36, s43, v20
    v_lshlrev_b32 v38, 2, v36
    v_add_u32 v38, 149504, v38
    s_lshl_b32 s44, s46, 7
    s_add_u32 s44, s44, 149504
    v_lshlrev_b32 v39, 2, v27
    v_add_u32 v39, s44, v39
    v_lshrrev_b32 v37, 1, v36
    v_and_b32 v37, 7, v37
    v_xor_b32 v37, v37, v22
    v_lshlrev_b32 v37, 4, v37
    v_mul_u32_u24 v36, 1152, v36
    s_lshr_b32 s57, s40, 2
    s_mul_i32 s57, s57, 73728
    v_add_u32 v36, v36, v37
    v_add_u32 v37, 73728, v36
    s_and_b32 s43, s46, 1
    s_lshl_b32 s43, s43, 5
    v_add_u32 v28, s43, v27
    v_lshrrev_b32 v29, 1, v28
    v_and_b32 v29, 7, v29
    v_xor_b32 v29, v29, v26
    v_lshlrev_b32 v29, 4, v29
    v_mul_u32_u24 v28, 1152, v28
    v_add3_u32 v28, v28, v29, s57
    v_xor_b32 v29, 32, v28
    v_xor_b32 v30, 64, v28
    v_xor_b32 v31, 96, v28
    s_mov_b32 s45, 0x3ae38e39
    s_mov_b32 s44, 0x3f803f80
    s_mov_b32 s36, 0x3f80
    s_mov_b32 s37, 0x3f800000
    v_mov_b32 v32, 0
    v_mov_b32 v33, 0
    s_waitcnt vmcnt(8)
    v_dot2_f32_bf16 v32, v204, s44, v32
    v_dot2_f32_bf16 v33, v205, s44, v33
    v_dot2_f32_bf16 v32, v206, s44, v32
    v_dot2_f32_bf16 v33, v207, s44, v33
    s_waitcnt vmcnt(7)
    v_dot2_f32_bf16 v32, v208, s44, v32
    v_dot2_f32_bf16 v33, v209, s44, v33
    v_dot2_f32_bf16 v32, v210, s44, v32
    v_dot2_f32_bf16 v33, v211, s44, v33
    s_waitcnt vmcnt(6)
    v_dot2_f32_bf16 v32, v212, s44, v32
    v_dot2_f32_bf16 v33, v213, s44, v33
    v_dot2_f32_bf16 v32, v214, s44, v32
    v_dot2_f32_bf16 v33, v215, s44, v33
    s_waitcnt vmcnt(5)
    v_dot2_f32_bf16 v32, v216, s44, v32
    v_dot2_f32_bf16 v33, v217, s44, v33
    v_dot2_f32_bf16 v32, v218, s44, v32
    v_dot2_f32_bf16 v33, v219, s44, v33
    s_waitcnt vmcnt(4)
    v_dot2_f32_bf16 v32, v220, s44, v32
    v_dot2_f32_bf16 v33, v221, s44, v33
    v_dot2_f32_bf16 v32, v222, s44, v32
    v_dot2_f32_bf16 v33, v223, s44, v33
    s_waitcnt vmcnt(3)
    v_dot2_f32_bf16 v32, v224, s44, v32
    v_dot2_f32_bf16 v33, v225, s44, v33
    v_dot2_f32_bf16 v32, v226, s44, v32
    v_dot2_f32_bf16 v33, v227, s44, v33
    s_waitcnt vmcnt(2)
    v_dot2_f32_bf16 v32, v228, s44, v32
    v_dot2_f32_bf16 v33, v229, s44, v33
    v_dot2_f32_bf16 v32, v230, s44, v32
    v_dot2_f32_bf16 v33, v231, s44, v33
    s_waitcnt vmcnt(1)
    v_dot2_f32_bf16 v32, v232, s44, v32
    v_dot2_f32_bf16 v33, v233, s44, v33
    v_dot2_f32_bf16 v32, v234, s44, v32
    v_dot2_f32_bf16 v33, v235, s44, v33
    s_waitcnt vmcnt(0)
    v_dot2_f32_bf16 v32, v236, s44, v32
    v_dot2_f32_bf16 v33, v237, s44, v33
    v_dot2_f32_bf16 v32, v238, s44, v32
    v_dot2_f32_bf16 v33, v239, s44, v33
    s_nop 2
    v_add_f32 v32, v32, v33
    s_nop 1
    v_add_f32_dpp v32, v32, v32 quad_perm:[1,0,3,2] row_mask:0xf bank_mask:0xf
    s_nop 1
    v_add_f32_dpp v32, v32, v32 quad_perm:[2,3,0,1] row_mask:0xf bank_mask:0xf
    s_nop 1
    v_add_f32_dpp v32, v32, v32 row_half_mirror row_mask:0xf bank_mask:0xf
    v_mul_f32 v32, 0xbae38e39, v32
    s_cmp_ge_u32 s40, 4
    s_cbranch_scc1 L1_fx0b
    v_dot2_f32_bf16 v20, v204, s36, v32
    v_dot2_f32_bf16 v21, v204, s37, v32
    v_dot2_f32_bf16 v22, v205, s36, v32
    v_dot2_f32_bf16 v23, v205, s37, v32
    v_dot2_f32_bf16 v24, v206, s36, v32
    v_dot2_f32_bf16 v25, v206, s37, v32
    v_dot2_f32_bf16 v26, v207, s36, v32
    v_dot2_f32_bf16 v27, v207, s37, v32
    v_cvt_pk_bf16_f32 v204, v20, v21
    v_cvt_pk_bf16_f32 v205, v22, v23
    v_cvt_pk_bf16_f32 v206, v24, v25
    v_cvt_pk_bf16_f32 v207, v26, v27
    ds_write_b128 v36, v[204:207] offset:0
    v_dot2_f32_bf16 v20, v208, s36, v32
    v_dot2_f32_bf16 v21, v208, s37, v32
    v_dot2_f32_bf16 v22, v209, s36, v32
    v_dot2_f32_bf16 v23, v209, s37, v32
    v_dot2_f32_bf16 v24, v210, s36, v32
    v_dot2_f32_bf16 v25, v210, s37, v32
    v_dot2_f32_bf16 v26, v211, s36, v32
    v_dot2_f32_bf16 v27, v211, s37, v32
    v_cvt_pk_bf16_f32 v208, v20, v21
    v_cvt_pk_bf16_f32 v209, v22, v23
    v_cvt_pk_bf16_f32 v210, v24, v25
    v_cvt_pk_bf16_f32 v211, v26, v27
    ds_write_b128 v36, v[208:211] offset:128
    v_dot2_f32_bf16 v20, v212, s36, v32
    v_dot2_f32_bf16 v21, v212, s37, v32
    v_dot2_f32_bf16 v22, v213, s36, v32
    v_dot2_f32_bf16 v23, v213, s37, v32
    v_dot2_f32_bf16 v24, v214, s36, v32
    v_dot2_f32_bf16 v25, v214, s37, v32
    v_dot2_f32_bf16 v26, v215, s36, v32
    v_dot2_f32_bf16 v27, v215, s37, v32
    v_cvt_pk_bf16_f32 v212, v20, v21
    v_cvt_pk_bf16_f32 v213, v22, v23
    v_cvt_pk_bf16_f32 v214, v24, v25
    v_cvt_pk_bf16_f32 v215, v26, v27
    ds_write_b128 v36, v[212:215] offset:256
    v_dot2_f32_bf16 v20, v216, s36, v32
    v_dot2_f32_bf16 v21, v216, s37, v32
    v_dot2_f32_bf16 v22, v217, s36, v32
    v_dot2_f32_bf16 v23, v217, s37, v32
    v_dot2_f32_bf16 v24, v218, s36, v32
    v_dot2_f32_bf16 v25, v218, s37, v32
    v_dot2_f32_bf16 v26, v219, s36, v32
    v_dot2_f32_bf16 v27, v219, s37, v32
    v_cvt_pk_bf16_f32 v216, v20, v21
    v_cvt_pk_bf16_f32 v217, v22, v23
    v_cvt_pk_bf16_f32 v218, v24, v25
    v_cvt_pk_bf16_f32 v219, v26, v27
    ds_write_b128 v36, v[216:219] offset:384
    v_dot2_f32_bf16 v20, v220, s36, v32
    v_dot2_f32_bf16 v21, v220, s37, v32
    v_dot2_f32_bf16 v22, v221, s36, v32
    v_dot2_f32_bf16 v23, v221, s37, v32
    v_dot2_f32_bf16 v24, v222, s36, v32
    v_dot2_f32_bf16 v25, v222, s37, v32
    v_dot2_f32_bf16 v26, v223, s36, v32
    v_dot2_f32_bf16 v27, v223, s37, v32
    v_cvt_pk_bf16_f32 v220, v20, v21
    v_cvt_pk_bf16_f32 v221, v22, v23
    v_cvt_pk_bf16_f32 v222, v24, v25
    v_cvt_pk_bf16_f32 v223, v26, v27
    ds_write_b128 v36, v[220:223] offset:512
    v_dot2_f32_bf16 v20, v224, s36, v32
    v_dot2_f32_bf16 v21, v224, s37, v32
    v_dot2_f32_bf16 v22, v225, s36, v32
    v_dot2_f32_bf16 v23, v225, s37, v32
    v_dot2_f32_bf16 v24, v226, s36, v32
    v_dot2_f32_bf16 v25, v226, s37, v32
    v_dot2_f32_bf16 v26, v227, s36, v32
    v_dot2_f32_bf16 v27, v227, s37, v32
    v_cvt_pk_bf16_f32 v224, v20, v21
    v_cvt_pk_bf16_f32 v225, v22, v23
    v_cvt_pk_bf16_f32 v226, v24, v25
    v_cvt_pk_bf16_f32 v227, v26, v27
    ds_write_b128 v36, v[224:227] offset:640
    v_dot2_f32_bf16 v20, v228, s36, v32
    v_dot2_f32_bf16 v21, v228, s37, v32
    v_dot2_f32_bf16 v22, v229, s36, v32
    buffer_load_dwordx4 v[56:59], v240, s[8:11], s69 offen offset:0
    v_dot2_f32_bf16 v23, v229, s37, v32
    v_dot2_f32_bf16 v24, v230, s36, v32
    v_dot2_f32_bf16 v25, v230, s37, v32
    v_dot2_f32_bf16 v26, v231, s36, v32
    v_dot2_f32_bf16 v27, v231, s37, v32
    buffer_load_dwordx4 v[60:63], v240, s[8:11], s69 offen offset:128
    v_cvt_pk_bf16_f32 v228, v20, v21
    v_cvt_pk_bf16_f32 v229, v22, v23
    v_cvt_pk_bf16_f32 v230, v24, v25
    v_cvt_pk_bf16_f32 v231, v26, v27
    buffer_load_dwordx4 v[64:67], v240, s[8:11], s69 offen offset:256
    ds_write_b128 v36, v[228:231] offset:768
    v_dot2_f32_bf16 v20, v232, s36, v32
    v_dot2_f32_bf16 v21, v232, s37, v32
    v_dot2_f32_bf16 v22, v233, s36, v32
    v_dot2_f32_bf16 v23, v233, s37, v32
    buffer_load_dwordx4 v[68:71], v240, s[8:11], s69 offen offset:384
    v_dot2_f32_bf16 v24, v234, s36, v32
    v_dot2_f32_bf16 v25, v234, s37, v32
    v_dot2_f32_bf16 v26, v235, s36, v32
    v_dot2_f32_bf16 v27, v235, s37, v32
    buffer_load_dwordx4 v[72:75], v240, s[8:11], s69 offen offset:512
    v_cvt_pk_bf16_f32 v232, v20, v21
    v_cvt_pk_bf16_f32 v233, v22, v23
    v_cvt_pk_bf16_f32 v234, v24, v25
    v_cvt_pk_bf16_f32 v235, v26, v27
    ds_write_b128 v36, v[232:235] offset:896
    buffer_load_dwordx4 v[76:79], v240, s[8:11], s69 offen offset:640
    v_dot2_f32_bf16 v20, v236, s36, v32
    v_dot2_f32_bf16 v21, v236, s37, v32
    v_dot2_f32_bf16 v22, v237, s36, v32
    v_dot2_f32_bf16 v23, v237, s37, v32
    buffer_load_dwordx4 v[80:83], v240, s[8:11], s69 offen offset:768
    v_dot2_f32_bf16 v24, v238, s36, v32
    v_dot2_f32_bf16 v25, v238, s37, v32
    v_dot2_f32_bf16 v26, v239, s36, v32
    v_dot2_f32_bf16 v27, v239, s37, v32
    v_cvt_pk_bf16_f32 v236, v20, v21
    buffer_load_dwordx4 v[84:87], v240, s[8:11], s69 offen offset:896
    v_cvt_pk_bf16_f32 v237, v22, v23
    v_cvt_pk_bf16_f32 v238, v24, v25
    v_cvt_pk_bf16_f32 v239, v26, v27
    ds_write_b128 v36, v[236:239] offset:1024
    buffer_load_dwordx4 v[88:91], v240, s[8:11], s69 offen offset:1024
    s_lshl_b32 s67, s40, 8
    s_add_u32 s67, s67, s2
    s_and_b32 s68, s67, 31
    s_lshr_b32 s43, s67, 5
    s_mul_i32 s43, s43, 589824
    s_lshl_b32 s68, s68, 7
    s_add_u32 s43, s43, s68
    s_add_u32 s43, s43, 4608
    s_cmp_lt_u32 s67, 288
    s_cselect_b32 s43, s43, 0x7f000000
    v_mul_u32_u24 v2, 9216, v1
    buffer_load_dword v3, v2, s[12:15], s43 offen
    v_mov_b32 v34, 0
    v_mov_b32 v35, 0
    v_dot2_f32_bf16 v34, v204, v204, v34
    v_dot2_f32_bf16 v35, v205, v205, v35
    v_dot2_f32_bf16 v34, v206, v206, v34
    v_dot2_f32_bf16 v35, v207, v207, v35
    v_dot2_f32_bf16 v34, v208, v208, v34
    v_dot2_f32_bf16 v35, v209, v209, v35
    v_dot2_f32_bf16 v34, v210, v210, v34
    v_dot2_f32_bf16 v35, v211, v211, v35
    v_dot2_f32_bf16 v34, v212, v212, v34
    v_dot2_f32_bf16 v35, v213, v213, v35
    v_dot2_f32_bf16 v34, v214, v214, v34
    v_dot2_f32_bf16 v35, v215, v215, v35
    v_dot2_f32_bf16 v34, v216, v216, v34
    v_dot2_f32_bf16 v35, v217, v217, v35
    v_dot2_f32_bf16 v34, v218, v218, v34
    v_dot2_f32_bf16 v35, v219, v219, v35
    v_dot2_f32_bf16 v34, v220, v220, v34
    v_dot2_f32_bf16 v35, v221, v221, v35
    v_dot2_f32_bf16 v34, v222, v222, v34
    v_dot2_f32_bf16 v35, v223, v223, v35
    v_dot2_f32_bf16 v34, v224, v224, v34
    v_dot2_f32_bf16 v35, v225, v225, v35
    v_dot2_f32_bf16 v34, v226, v226, v34
    v_dot2_f32_bf16 v35, v227, v227, v35
    v_dot2_f32_bf16 v34, v228, v228, v34
    v_dot2_f32_bf16 v35, v229, v229, v35
    v_dot2_f32_bf16 v34, v230, v230, v34
    v_dot2_f32_bf16 v35, v231, v231, v35
    v_dot2_f32_bf16 v34, v232, v232, v34
    v_dot2_f32_bf16 v35, v233, v233, v35
    v_dot2_f32_bf16 v34, v234, v234, v34
    v_dot2_f32_bf16 v35, v235, v235, v35
    v_dot2_f32_bf16 v34, v236, v236, v34
    v_dot2_f32_bf16 v35, v237, v237, v35
    v_dot2_f32_bf16 v34, v238, v238, v34
    v_dot2_f32_bf16 v35, v239, v239, v35
    s_nop 2
    v_add_f32 v34, v34, v35
    s_nop 1
    v_add_f32_dpp v34, v34, v34 quad_perm:[1,0,3,2] row_mask:0xf bank_mask:0xf
    s_nop 1
    v_add_f32_dpp v34, v34, v34 quad_perm:[2,3,0,1] row_mask:0xf bank_mask:0xf
    s_nop 1
    v_add_f32_dpp v34, v34, v34 row_half_mirror row_mask:0xf bank_mask:0xf
    v_mul_f32 v34, s45, v34
    v_add_f32 v34, 0x3727c5ac, v34
    v_sqrt_f32 v34, v34
    s_nop 0
    ds_write_b32 v38, v34 offset:0
    s_waitcnt lgkmcnt(0)
    s_barrier
    v_mov_b32 v32, 0
    v_mov_b32 v33, 0
    ds_read_b128 v[96:99], v28 offset:0
    s_waitcnt vmcnt(9)
    ds_read_b128 v[100:103], v29 offset:0
    v_dot2_f32_bf16 v32, v56, s44, v32
    v_dot2_f32_bf16 v33, v57, s44, v33
    ds_read_b128 v[104:107], v30 offset:0
    v_dot2_f32_bf16 v32, v58, s44, v32
    ds_read_b128 v[108:111], v31 offset:0
    v_dot2_f32_bf16 v33, v59, s44, v33
    ds_read_b128 v[112:115], v28 offset:128
    s_waitcnt vmcnt(8)
    v_dot2_f32_bf16 v32, v60, s44, v32
    ds_read_b128 v[116:119], v29 offset:128
    v_dot2_f32_bf16 v33, v61, s44, v33
    ds_read_b128 v[120:123], v30 offset:128
    v_dot2_f32_bf16 v32, v62, s44, v32
    v_dot2_f32_bf16 v33, v63, s44, v33
    ds_read_b128 v[124:127], v31 offset:128
    s_waitcnt vmcnt(7)
    ds_read_b128 v[128:131], v28 offset:256
    v_dot2_f32_bf16 v32, v64, s44, v32
    ds_read_b128 v[132:135], v29 offset:256
    v_dot2_f32_bf16 v33, v65, s44, v33
    v_dot2_f32_bf16 v32, v66, s44, v32
    ds_read_b128 v[136:139], v30 offset:256
    v_dot2_f32_bf16 v33, v67, s44, v33
    ds_read_b128 v[140:143], v31 offset:256
    s_waitcnt vmcnt(6)
    v_dot2_f32_bf16 v32, v68, s44, v32
    ds_read_b128 v[144:147], v28 offset:384
    v_dot2_f32_bf16 v33, v69, s44, v33
    ds_read_b128 v[148:151], v29 offset:384
    v_dot2_f32_bf16 v32, v70, s44, v32
    ds_read_b128 v[152:155], v30 offset:384
    v_dot2_f32_bf16 v33, v71, s44, v33
    s_waitcnt vmcnt(5)
    ds_read_b128 v[156:159], v31 offset:384
    v_dot2_f32_bf16 v32, v72, s44, v32
    ds_read_b128 v[160:163], v28 offset:512
    v_dot2_f32_bf16 v33, v73, s44, v33
    ds_read_b128 v[164:167], v29 offset:512
    v_dot2_f32_bf16 v32, v74, s44, v32
    v_dot2_f32_bf16 v33, v75, s44, v33
    ds_read_b128 v[168:171], v30 offset:512
    s_waitcnt vmcnt(4)
    ds_read_b128 v[172:175], v31 offset:512
    v_dot2_f32_bf16 v32, v76, s44, v32
    v_dot2_f32_bf16 v33, v77, s44, v33
    ds_read_b128 v[176:179], v28 offset:640
    v_dot2_f32_bf16 v32, v78, s44, v32
    ds_read_b128 v[180:183], v29 offset:640
    v_dot2_f32_bf16 v33, v79, s44, v33
    ds_read_b128 v[184:187], v30 offset:640
    s_waitcnt vmcnt(3)
    v_dot2_f32_bf16 v32, v80, s44, v32
    ds_read_b128 v[188:191], v31 offset:640
    v_dot2_f32_bf16 v33, v81, s44, v33
    ds_read_b128 v[192:195], v28 offset:768
    v_dot2_f32_bf16 v32, v82, s44, v32
    v_dot2_f32_bf16 v33, v83, s44, v33
    ds_read_b128 v[196:199], v29 offset:768
    s_waitcnt vmcnt(2)
    ds_read_b128 v[200:203], v30 offset:768
    v_dot2_f32_bf16 v32, v84, s44, v32
    ds_read_b128 v[204:207], v31 offset:768
    v_dot2_f32_bf16 v33, v85, s44, v33
    v_dot2_f32_bf16 v32, v86, s44, v32
    ds_read_b128 v[208:211], v28 offset:896
    v_dot2_f32_bf16 v33, v87, s44, v33
    ds_read_b128 v[212:215], v29 offset:896
    s_waitcnt vmcnt(1)
    v_dot2_f32_bf16 v32, v88, s44, v32
    ds_read_b128 v[216:219], v30 offset:896
    v_dot2_f32_bf16 v33, v89, s44, v33
    ds_read_b128 v[220:223], v31 offset:896
    v_dot2_f32_bf16 v32, v90, s44, v32
    ds_read_b128 v[224:227], v28 offset:1024
    v_dot2_f32_bf16 v33, v91, s44, v33
    s_nop 2
    v_add_f32 v32, v32, v33
    ds_read_b128 v[228:231], v29 offset:1024
    s_nop 0
    v_add_f32_dpp v32, v32, v32 quad_perm:[1,0,3,2] row_mask:0xf bank_mask:0xf
    ds_read_b128 v[232:235], v30 offset:1024
    s_nop 0
    v_add_f32_dpp v32, v32, v32 quad_perm:[2,3,0,1] row_mask:0xf bank_mask:0xf
    ds_read_b128 v[236:239], v31 offset:1024
    s_nop 0
    v_add_f32_dpp v32, v32, v32 row_half_mirror row_mask:0xf bank_mask:0xf
    v_mul_f32 v32, 0xbae38e39, v32
    v_dot2_f32_bf16 v20, v56, s36, v32
    v_dot2_f32_bf16 v21, v56, s37, v32
    v_dot2_f32_bf16 v22, v57, s36, v32
    v_dot2_f32_bf16 v23, v57, s37, v32
    v_dot2_f32_bf16 v24, v58, s36, v32
    v_dot2_f32_bf16 v25, v58, s37, v32
    v_dot2_f32_bf16 v26, v59, s36, v32
    v_dot2_f32_bf16 v27, v59, s37, v32
    v_cvt_pk_bf16_f32 v56, v20, v21
    v_cvt_pk_bf16_f32 v57, v22, v23
    v_cvt_pk_bf16_f32 v58, v24, v25
    v_cvt_pk_bf16_f32 v59, v26, v27
    ds_write_b128 v37, v[56:59] offset:0
    v_dot2_f32_bf16 v20, v60, s36, v32
    v_dot2_f32_bf16 v21, v60, s37, v32
    v_dot2_f32_bf16 v22, v61, s36, v32
    v_dot2_f32_bf16 v23, v61, s37, v32
    v_dot2_f32_bf16 v24, v62, s36, v32
    v_dot2_f32_bf16 v25, v62, s37, v32
    v_dot2_f32_bf16 v26, v63, s36, v32
    v_dot2_f32_bf16 v27, v63, s37, v32
    v_cvt_pk_bf16_f32 v60, v20, v21
    v_cvt_pk_bf16_f32 v61, v22, v23
    v_cvt_pk_bf16_f32 v62, v24, v25
    v_cvt_pk_bf16_f32 v63, v26, v27
    ds_write_b128 v37, v[60:63] offset:128
    s_waitcnt lgkmcnt(2)
    s_barrier
    s_mul_i32 s57, s40, 9216
    s_mul_i32 s56, s40, 663552
    s_add_u32 s56, s56, s49
    s_add_u32 m0, s57, 0
    s_add_u32 s56, s56, 0
    buffer_load_dwordx4 v4, s[12:15], s56 offen offset:0 lds
    buffer_load_dwordx4 v5, s[12:15], s56 offen offset:1024 lds
    buffer_load_dwordx4 v6, s[12:15], s56 offen offset:2048 lds
    s_add_u32 m0, s57, 3072
    s_add_u32 s56, s56, 221184
    buffer_load_dwordx4 v4, s[12:15], s56 offen offset:0 lds
    buffer_load_dwordx4 v5, s[12:15], s56 offen offset:1024 lds
    buffer_load_dwordx4 v6, s[12:15], s56 offen offset:2048 lds
    s_add_u32 m0, s57, 6144
    s_add_u32 s56, s56, 221184
    buffer_load_dwordx4 v4, s[12:15], s56 offen offset:0 lds
    buffer_load_dwordx4 v5, s[12:15], s56 offen offset:1024 lds
    buffer_load_dwordx4 v6, s[12:15], s56 offen offset:2048 lds
    v_dot2_f32_bf16 v20, v64, s36, v32
    v_dot2_f32_bf16 v21, v64, s37, v32
    v_dot2_f32_bf16 v22, v65, s36, v32
    v_dot2_f32_bf16 v23, v65, s37, v32
    v_dot2_f32_bf16 v24, v66, s36, v32
    v_dot2_f32_bf16 v25, v66, s37, v32
    v_dot2_f32_bf16 v26, v67, s36, v32
    v_dot2_f32_bf16 v27, v67, s37, v32
    v_cvt_pk_bf16_f32 v64, v20, v21
    v_cvt_pk_bf16_f32 v65, v22, v23
    v_cvt_pk_bf16_f32 v66, v24, v25
    v_cvt_pk_bf16_f32 v67, v26, v27
    ds_write_b128 v37, v[64:67] offset:256
    v_dot2_f32_bf16 v20, v68, s36, v32
    v_dot2_f32_bf16 v21, v68, s37, v32
    v_dot2_f32_bf16 v22, v69, s36, v32
    v_dot2_f32_bf16 v23, v69, s37, v32
    v_dot2_f32_bf16 v24, v70, s36, v32
    v_dot2_f32_bf16 v25, v70, s37, v32
    v_dot2_f32_bf16 v26, v71, s36, v32
    v_dot2_f32_bf16 v27, v71, s37, v32
    v_cvt_pk_bf16_f32 v68, v20, v21
    v_cvt_pk_bf16_f32 v69, v22, v23
    v_cvt_pk_bf16_f32 v70, v24, v25
    v_cvt_pk_bf16_f32 v71, v26, v27
    ds_write_b128 v37, v[68:71] offset:384
    v_dot2_f32_bf16 v20, v72, s36, v32
    v_dot2_f32_bf16 v21, v72, s37, v32
    v_dot2_f32_bf16 v22, v73, s36, v32
    v_dot2_f32_bf16 v23, v73, s37, v32
    v_dot2_f32_bf16 v24, v74, s36, v32
    v_dot2_f32_bf16 v25, v74, s37, v32
    v_dot2_f32_bf16 v26, v75, s36, v32
    v_dot2_f32_bf16 v27, v75, s37, v32
    v_cvt_pk_bf16_f32 v72, v20, v21
    v_cvt_pk_bf16_f32 v73, v22, v23
    v_cvt_pk_bf16_f32 v74, v24, v25
    v_cvt_pk_bf16_f32 v75, v26, v27
    ds_write_b128 v37, v[72:75] offset:512
    v_dot2_f32_bf16 v20, v76, s36, v32
    v_dot2_f32_bf16 v21, v76, s37, v32
    v_dot2_f32_bf16 v22, v77, s36, v32
    v_dot2_f32_bf16 v23, v77, s37, v32
    v_dot2_f32_bf16 v24, v78, s36, v32
    v_dot2_f32_bf16 v25, v78, s37, v32
    v_dot2_f32_bf16 v26, v79, s36, v32
    v_dot2_f32_bf16 v27, v79, s37, v32
    v_cvt_pk_bf16_f32 v76, v20, v21
    v_cvt_pk_bf16_f32 v77, v22, v23
    v_cvt_pk_bf16_f32 v78, v24, v25
    v_cvt_pk_bf16_f32 v79, v26, v27
    ds_write_b128 v37, v[76:79] offset:640
    v_dot2_f32_bf16 v20, v80, s36, v32
    v_dot2_f32_bf16 v21, v80, s37, v32
    v_dot2_f32_bf16 v22, v81, s36, v32
    v_dot2_f32_bf16 v23, v81, s37, v32
    v_dot2_f32_bf16 v24, v82, s36, v32
    v_dot2_f32_bf16 v25, v82, s37, v32
    v_dot2_f32_bf16 v26, v83, s36, v32
    v_dot2_f32_bf16 v27, v83, s37, v32
    v_cvt_pk_bf16_f32 v80, v20, v21
    v_cvt_pk_bf16_f32 v81, v22, v23
    v_cvt_pk_bf16_f32 v82, v24, v25
    v_cvt_pk_bf16_f32 v83, v26, v27
    ds_write_b128 v37, v[80:83] offset:768
    v_dot2_f32_bf16 v20, v84, s36, v32
    v_dot2_f32_bf16 v21, v84, s37, v32
    v_dot2_f32_bf16 v22, v85, s36, v32
    v_dot2_f32_bf16 v23, v85, s37, v32
    v_dot2_f32_bf16 v24, v86, s36, v32
    v_dot2_f32_bf16 v25, v86, s37, v32
    v_dot2_f32_bf16 v26, v87, s36, v32
    v_dot2_f32_bf16 v27, v87, s37, v32
    v_cvt_pk_bf16_f32 v84, v20, v21
    v_cvt_pk_bf16_f32 v85, v22, v23
    v_cvt_pk_bf16_f32 v86, v24, v25
    v_cvt_pk_bf16_f32 v87, v26, v27
    ds_write_b128 v37, v[84:87] offset:896
    v_dot2_f32_bf16 v20, v88, s36, v32
    v_dot2_f32_bf16 v21, v88, s37, v32
    v_dot2_f32_bf16 v22, v89, s36, v32
    v_dot2_f32_bf16 v23, v89, s37, v32
    v_dot2_f32_bf16 v24, v90, s36, v32
    v_dot2_f32_bf16 v25, v90, s37, v32
    v_dot2_f32_bf16 v26, v91, s36, v32
    v_dot2_f32_bf16 v27, v91, s37, v32
    v_cvt_pk_bf16_f32 v88, v20, v21
    v_cvt_pk_bf16_f32 v89, v22, v23
    v_cvt_pk_bf16_f32 v90, v24, v25
    v_cvt_pk_bf16_f32 v91, v26, v27
    ds_write_b128 v37, v[88:91] offset:1024
    s_mul_i32 s56, s40, 663552
    s_add_u32 s56, s56, s49
    s_add_u32 m0, s57, 36864
    s_add_u32 s56, s56, 2654208
    buffer_load_dwordx4 v4, s[12:15], s56 offen offset:0 lds
    buffer_load_dwordx4 v5, s[12:15], s56 offen offset:1024 lds
    buffer_load_dwordx4 v6, s[12:15], s56 offen offset:2048 lds
    s_add_u32 m0, s57, 39936
    s_add_u32 s56, s56, 221184
    buffer_load_dwordx4 v4, s[12:15], s56 offen offset:0 lds
    buffer_load_dwordx4 v5, s[12:15], s56 offen offset:1024 lds
    buffer_load_dwordx4 v6, s[12:15], s56 offen offset:2048 lds
    s_add_u32 m0, s57, 43008
    s_add_u32 s56, s56, 221184
    buffer_load_dwordx4 v4, s[12:15], s56 offen offset:0 lds
    buffer_load_dwordx4 v5, s[12:15], s56 offen offset:1024 lds
    buffer_load_dwordx4 v6, s[12:15], s56 offen offset:2048 lds
    s_lshl_b32 s43, s2, 2
    s_add_u32 s43, s43, s40
    s_mul_i32 s67, s43, 7282
    s_lshr_b32 s67, s67, 16
    s_mul_i32 s68, s67, 9
    s_sub_u32 s68, s43, s68
    s_add_u32 s43, s67, 32
    s_cmp_lt_u32 s67, 36
    s_cselect_b32 s43, s67, s43
    s_sub_u32 s69, s67, 40
    s_cmp_lt_u32 s67, 40
    s_cselect_b32 s43, s43, s69
    s_cselect_b32 s32, s12, s16
    s_cselect_b32 s33, s13, s17
    s_cselect_b32 s34, s14, s18
    s_mov_b32 s35, 0x20000
    s_mov_b32 s69, 3456
    s_cselect_b32 s69, 9216, s69
    s_lshl_b32 s43, s43, 7
    s_mul_i32 s68, s68, s69
    s_lshl_b32 s68, s68, 6
    s_add_u32 s43, s43, s68
    s_cmp_lt_u32 s67, 67
    s_cselect_b32 s43, s43, 0x7f000000
    v_mul_u32_u24 v2, s69, v1
    buffer_load_dword v3, v2, s[32:35], s43 offen
    v_mov_b32 v34, 0
    v_mov_b32 v35, 0
    v_dot2_f32_bf16 v34, v56, v56, v34
    v_dot2_f32_bf16 v35, v57, v57, v35
    v_dot2_f32_bf16 v34, v58, v58, v34
    v_dot2_f32_bf16 v35, v59, v59, v35
    v_dot2_f32_bf16 v34, v60, v60, v34
    v_dot2_f32_bf16 v35, v61, v61, v35
    v_dot2_f32_bf16 v34, v62, v62, v34
    v_dot2_f32_bf16 v35, v63, v63, v35
    v_dot2_f32_bf16 v34, v64, v64, v34
    v_dot2_f32_bf16 v35, v65, v65, v35
    v_dot2_f32_bf16 v34, v66, v66, v34
    v_dot2_f32_bf16 v35, v67, v67, v35
    v_dot2_f32_bf16 v34, v68, v68, v34
    v_dot2_f32_bf16 v35, v69, v69, v35
    v_dot2_f32_bf16 v34, v70, v70, v34
    v_dot2_f32_bf16 v35, v71, v71, v35
    v_dot2_f32_bf16 v34, v72, v72, v34
    v_dot2_f32_bf16 v35, v73, v73, v35
    v_dot2_f32_bf16 v34, v74, v74, v34
    v_dot2_f32_bf16 v35, v75, v75, v35
    v_dot2_f32_bf16 v34, v76, v76, v34
    v_dot2_f32_bf16 v35, v77, v77, v35
    v_dot2_f32_bf16 v34, v78, v78, v34
    v_dot2_f32_bf16 v35, v79, v79, v35
    v_dot2_f32_bf16 v34, v80, v80, v34
    v_dot2_f32_bf16 v35, v81, v81, v35
    v_dot2_f32_bf16 v34, v82, v82, v34
    v_dot2_f32_bf16 v35, v83, v83, v35
    v_dot2_f32_bf16 v34, v84, v84, v34
    v_dot2_f32_bf16 v35, v85, v85, v35
    v_dot2_f32_bf16 v34, v86, v86, v34
    v_dot2_f32_bf16 v35, v87, v87, v35
    v_dot2_f32_bf16 v34, v88, v88, v34
    v_dot2_f32_bf16 v35, v89, v89, v35
    v_dot2_f32_bf16 v34, v90, v90, v34
    v_dot2_f32_bf16 v35, v91, v91, v35
    s_nop 2
    v_add_f32 v34, v34, v35
    s_nop 1
    v_add_f32_dpp v34, v34, v34 quad_perm:[1,0,3,2] row_mask:0xf bank_mask:0xf
    s_nop 1
    v_add_f32_dpp v34, v34, v34 quad_perm:[2,3,0,1] row_mask:0xf bank_mask:0xf
    s_nop 1
    v_add_f32_dpp v34, v34, v34 row_half_mirror row_mask:0xf bank_mask:0xf
    v_mul_f32 v34, s45, v34
    v_add_f32 v34, 0x3727c5ac, v34
    v_sqrt_f32 v34, v34
    s_nop 0
    ds_write_b32 v38, v34 offset:256
    s_waitcnt vmcnt(10) lgkmcnt(0)
    s_barrier
    ds_read_b32 v2, v39
    s_setprio 1
    v_add_u32 v13, 0, v11
    ds_read_b64_tr_b16 v[40:41], v13 offset:0
    ds_read_b64_tr_b16 v[42:43], v13 offset:512
    ds_read_b64_tr_b16 v[44:45], v13 offset:2048
    ds_read_b64_tr_b16 v[46:47], v13 offset:2560
    ds_read_b64_tr_b16 v[48:49], v13 offset:4096
    ds_read_b64_tr_b16 v[50:51], v13 offset:4608
    s_waitcnt lgkmcnt(4)
    v_mfma_f32_32x32x16_bf16 v[80:95], v[40:43], v[96:99], 0
    ds_read_b64_tr_b16 v[52:53], v13 offset:6144
    ds_read_b64_tr_b16 v[54:55], v13 offset:6656
    s_waitcnt lgkmcnt(4)
    v_mfma_f32_32x32x16_bf16 v[80:95], v[44:47], v[100:103], v[80:95]
    ds_read_b64_tr_b16 v[40:41], v13 offset:8192
    ds_read_b64_tr_b16 v[42:43], v13 offset:8704
    s_waitcnt lgkmcnt(4)
    v_mfma_f32_32x32x16_bf16 v[80:95], v[48:51], v[104:107], v[80:95]
    ds_read_b64_tr_b16 v[44:45], v13 offset:10240
    ds_read_b64_tr_b16 v[46:47], v13 offset:10752
    s_waitcnt lgkmcnt(4)
    v_mfma_f32_32x32x16_bf16 v[80:95], v[52:55], v[108:111], v[80:95]
    ds_read_b64_tr_b16 v[48:49], v13 offset:12288
    ds_read_b64_tr_b16 v[50:51], v13 offset:12800
    s_waitcnt lgkmcnt(4)
    v_mfma_f32_32x32x16_bf16 v[80:95], v[40:43], v[112:115], v[80:95]
    ds_read_b64_tr_b16 v[52:53], v13 offset:14336
    ds_read_b64_tr_b16 v[54:55], v13 offset:14848
    s_waitcnt lgkmcnt(4)
    v_mfma_f32_32x32x16_bf16 v[80:95], v[44:47], v[116:119], v[80:95]
    ds_read_b64_tr_b16 v[40:41], v13 offset:16384
    ds_read_b64_tr_b16 v[42:43], v13 offset:16896
    s_waitcnt lgkmcnt(4)
    v_mfma_f32_32x32x16_bf16 v[80:95], v[48:51], v[120:123], v[80:95]
    ds_read_b64_tr_b16 v[44:45], v13 offset:18432
    ds_read_b64_tr_b16 v[46:47], v13 offset:18944
    s_waitcnt lgkmcnt(4)
    v_mfma_f32_32x32x16_bf16 v[80:95], v[52:55], v[124:127], v[80:95]
    ds_read_b64_tr_b16 v[48:49], v13 offset:20480
    ds_read_b64_tr_b16 v[50:51], v13 offset:20992
    s_waitcnt lgkmcnt(4)
    v_mfma_f32_32x32x16_bf16 v[80:95], v[40:43], v[128:131], v[80:95]
    ds_read_b64_tr_b16 v[52:53], v13 offset:22528
    ds_read_b64_tr_b16 v[54:55], v13 offset:23040
    s_waitcnt lgkmcnt(4)
    v_mfma_f32_32x32x16_bf16 v[80:95], v[44:47], v[132:135], v[80:95]
    ds_read_b64_tr_b16 v[40:41], v13 offset:24576
    ds_read_b64_tr_b16 v[42:43], v13 offset:25088
    s_waitcnt lgkmcnt(4)
    v_mfma_f32_32x32x16_bf16 v[80:95], v[48:51], v[136:139], v[80:95]
    ds_read_b64_tr_b16 v[44:45], v13 offset:26624
    ds_read_b64_tr_b16 v[46:47], v13 offset:27136
    s_waitcnt lgkmcnt(4)
    v_mfma_f32_32x32x16_bf16 v[80:95], v[52:55], v[140:143], v[80:95]
    ds_read_b64_tr_b16 v[48:49], v13 offset:28672
    ds_read_b64_tr_b16 v[50:51], v13 offset:29184
    s_waitcnt lgkmcnt(4)
    v_mfma_f32_32x32x16_bf16 v[80:95], v[40:43], v[144:147], v[80:95]
    ds_read_b64_tr_b16 v[52:53], v13 offset:30720
    ds_read_b64_tr_b16 v[54:55], v13 offset:31232
    s_waitcnt lgkmcnt(4)
    v_mfma_f32_32x32x16_bf16 v[80:95], v[44:47], v[148:151], v[80:95]
    ds_read_b64_tr_b16 v[40:41], v13 offset:32768
    ds_read_b64_tr_b16 v[42:43], v13 offset:33280
    s_waitcnt lgkmcnt(4)
    v_mfma_f32_32x32x16_bf16 v[80:95], v[48:51], v[152:155], v[80:95]
    ds_read_b64_tr_b16 v[44:45], v13 offset:34816
    ds_read_b64_tr_b16 v[46:47], v13 offset:35328
    s_waitcnt lgkmcnt(4)
    v_mfma_f32_32x32x16_bf16 v[80:95], v[52:55], v[156:159], v[80:95]
    s_waitcnt vmcnt(1)
    s_barrier
    v_add_u32 v13, 36864, v11
    ds_read_b64_tr_b16 v[48:49], v13 offset:0
    ds_read_b64_tr_b16 v[50:51], v13 offset:512
    s_waitcnt lgkmcnt(4)
    v_mfma_f32_32x32x16_bf16 v[80:95], v[40:43], v[160:163], v[80:95]
    ds_read_b64_tr_b16 v[52:53], v13 offset:2048
    ds_read_b64_tr_b16 v[54:55], v13 offset:2560
    s_waitcnt lgkmcnt(4)
    v_mfma_f32_32x32x16_bf16 v[80:95], v[44:47], v[164:167], v[80:95]
    ds_read_b64_tr_b16 v[40:41], v13 offset:4096
    ds_read_b64_tr_b16 v[42:43], v13 offset:4608
    s_waitcnt lgkmcnt(4)
    v_mfma_f32_32x32x16_bf16 v[80:95], v[48:51], v[168:171], v[80:95]
    ds_read_b64_tr_b16 v[44:45], v13 offset:6144
    ds_read_b64_tr_b16 v[46:47], v13 offset:6656
    s_waitcnt lgkmcnt(4)
    v_mfma_f32_32x32x16_bf16 v[80:95], v[52:55], v[172:175], v[80:95]
    ds_read_b64_tr_b16 v[48:49], v13 offset:8192
    ds_read_b64_tr_b16 v[50:51], v13 offset:8704
    s_waitcnt lgkmcnt(4)
    v_mfma_f32_32x32x16_bf16 v[80:95], v[40:43], v[176:179], v[80:95]
    ds_read_b64_tr_b16 v[52:53], v13 offset:10240
    ds_read_b64_tr_b16 v[54:55], v13 offset:10752
    s_waitcnt lgkmcnt(4)
    v_mfma_f32_32x32x16_bf16 v[80:95], v[44:47], v[180:183], v[80:95]
    ds_read_b64_tr_b16 v[40:41], v13 offset:12288
    ds_read_b64_tr_b16 v[42:43], v13 offset:12800
    s_waitcnt lgkmcnt(4)
    v_mfma_f32_32x32x16_bf16 v[80:95], v[48:51], v[184:187], v[80:95]
    ds_read_b64_tr_b16 v[44:45], v13 offset:14336
    ds_read_b64_tr_b16 v[46:47], v13 offset:14848
    s_waitcnt lgkmcnt(4)
    v_mfma_f32_32x32x16_bf16 v[80:95], v[52:55], v[188:191], v[80:95]
    ds_read_b64_tr_b16 v[48:49], v13 offset:16384
    ds_read_b64_tr_b16 v[50:51], v13 offset:16896
    s_waitcnt lgkmcnt(4)
    v_mfma_f32_32x32x16_bf16 v[80:95], v[40:43], v[192:195], v[80:95]
    ds_read_b64_tr_b16 v[52:53], v13 offset:18432
    ds_read_b64_tr_b16 v[54:55], v13 offset:18944
    s_waitcnt lgkmcnt(4)
    v_mfma_f32_32x32x16_bf16 v[80:95], v[44:47], v[196:199], v[80:95]
    ds_read_b64_tr_b16 v[40:41], v13 offset:20480
    ds_read_b64_tr_b16 v[42:43], v13 offset:20992
    s_waitcnt lgkmcnt(4)
    v_mfma_f32_32x32x16_bf16 v[80:95], v[48:51], v[200:203], v[80:95]
    ds_read_b64_tr_b16 v[44:45], v13 offset:22528
    ds_read_b64_tr_b16 v[46:47], v13 offset:23040
    s_waitcnt lgkmcnt(4)
    v_mfma_f32_32x32x16_bf16 v[80:95], v[52:55], v[204:207], v[80:95]
    ds_read_b64_tr_b16 v[48:49], v13 offset:24576
    ds_read_b64_tr_b16 v[50:51], v13 offset:25088
    s_waitcnt lgkmcnt(4)
    v_mfma_f32_32x32x16_bf16 v[80:95], v[40:43], v[208:211], v[80:95]
    ds_read_b64_tr_b16 v[52:53], v13 offset:26624
    ds_read_b64_tr_b16 v[54:55], v13 offset:27136
    s_waitcnt lgkmcnt(4)
    v_mfma_f32_32x32x16_bf16 v[80:95], v[44:47], v[212:215], v[80:95]
    ds_read_b64_tr_b16 v[40:41], v13 offset:28672
    ds_read_b64_tr_b16 v[42:43], v13 offset:29184
    s_waitcnt lgkmcnt(4)
    v_mfma_f32_32x32x16_bf16 v[80:95], v[48:51], v[216:219], v[80:95]
    ds_read_b64_tr_b16 v[44:45], v13 offset:30720
    ds_read_b64_tr_b16 v[46:47], v13 offset:31232
    s_waitcnt lgkmcnt(4)
    v_mfma_f32_32x32x16_bf16 v[80:95], v[52:55], v[220:223], v[80:95]
    ds_read_b64_tr_b16 v[48:49], v13 offset:32768
    ds_read_b64_tr_b16 v[50:51], v13 offset:33280
    s_waitcnt lgkmcnt(4)
    v_mfma_f32_32x32x16_bf16 v[80:95], v[40:43], v[224:227], v[80:95]
    ds_read_b64_tr_b16 v[52:53], v13 offset:34816
    ds_read_b64_tr_b16 v[54:55], v13 offset:35328
    s_waitcnt lgkmcnt(0)
    s_barrier
    v_mfma_f32_32x32x16_bf16 v[80:95], v[44:47], v[228:231], v[80:95]
    v_mfma_f32_32x32x16_bf16 v[80:95], v[48:51], v[232:235], v[80:95]
    v_mfma_f32_32x32x16_bf16 v[80:95], v[52:55], v[236:239], v[80:95]
    s_setprio 0
    s_branch L1_fx0e
L1_fx0b:
    v_dot2_f32_bf16 v20, v204, s36, v32
    v_dot2_f32_bf16 v21, v204, s37, v32
    v_dot2_f32_bf16 v22, v205, s36, v32
    v_dot2_f32_bf16 v23, v205, s37, v32
    v_dot2_f32_bf16 v24, v206, s36, v32
    v_dot2_f32_bf16 v25, v206, s37, v32
    v_dot2_f32_bf16 v26, v207, s36, v32
    v_dot2_f32_bf16 v27, v207, s37, v32
    v_cvt_pk_bf16_f32 v204, v20, v21
    v_cvt_pk_bf16_f32 v205, v22, v23
    v_cvt_pk_bf16_f32 v206, v24, v25
    v_cvt_pk_bf16_f32 v207, v26, v27
    ds_write_b128 v36, v[204:207] offset:0
    v_dot2_f32_bf16 v20, v208, s36, v32
    v_dot2_f32_bf16 v21, v208, s37, v32
    v_dot2_f32_bf16 v22, v209, s36, v32
    v_dot2_f32_bf16 v23, v209, s37, v32
    v_dot2_f32_bf16 v24, v210, s36, v32
    v_dot2_f32_bf16 v25, v210, s37, v32
    v_dot2_f32_bf16 v26, v211, s36, v32
    v_dot2_f32_bf16 v27, v211, s37, v32
    v_cvt_pk_bf16_f32 v208, v20, v21
    v_cvt_pk_bf16_f32 v209, v22, v23
    v_cvt_pk_bf16_f32 v210, v24, v25
    v_cvt_pk_bf16_f32 v211, v26, v27
    ds_write_b128 v36, v[208:211] offset:128
    v_dot2_f32_bf16 v20, v212, s36, v32
    v_dot2_f32_bf16 v21, v212, s37, v32
    v_dot2_f32_bf16 v22, v213, s36, v32
    v_dot2_f32_bf16 v23, v213, s37, v32
    v_dot2_f32_bf16 v24, v214, s36, v32
    v_dot2_f32_bf16 v25, v214, s37, v32
    v_dot2_f32_bf16 v26, v215, s36, v32
    v_dot2_f32_bf16 v27, v215, s37, v32
    v_cvt_pk_bf16_f32 v212, v20, v21
    v_cvt_pk_bf16_f32 v213, v22, v23
    v_cvt_pk_bf16_f32 v214, v24, v25
    v_cvt_pk_bf16_f32 v215, v26, v27
    ds_write_b128 v36, v[212:215] offset:256
    v_dot2_f32_bf16 v20, v216, s36, v32
    v_dot2_f32_bf16 v21, v216, s37, v32
    v_dot2_f32_bf16 v22, v217, s36, v32
    v_dot2_f32_bf16 v23, v217, s37, v32
    v_dot2_f32_bf16 v24, v218, s36, v32
    v_dot2_f32_bf16 v25, v218, s37, v32
    v_dot2_f32_bf16 v26, v219, s36, v32
    v_dot2_f32_bf16 v27, v219, s37, v32
    v_cvt_pk_bf16_f32 v216, v20, v21
    v_cvt_pk_bf16_f32 v217, v22, v23
    v_cvt_pk_bf16_f32 v218, v24, v25
    v_cvt_pk_bf16_f32 v219, v26, v27
    ds_write_b128 v36, v[216:219] offset:384
    v_dot2_f32_bf16 v20, v220, s36, v32
    v_dot2_f32_bf16 v21, v220, s37, v32
    v_dot2_f32_bf16 v22, v221, s36, v32
    v_dot2_f32_bf16 v23, v221, s37, v32
    v_dot2_f32_bf16 v24, v222, s36, v32
    v_dot2_f32_bf16 v25, v222, s37, v32
    v_dot2_f32_bf16 v26, v223, s36, v32
    v_dot2_f32_bf16 v27, v223, s37, v32
    v_cvt_pk_bf16_f32 v220, v20, v21
    v_cvt_pk_bf16_f32 v221, v22, v23
    v_cvt_pk_bf16_f32 v222, v24, v25
    v_cvt_pk_bf16_f32 v223, v26, v27
    ds_write_b128 v36, v[220:223] offset:512
    v_dot2_f32_bf16 v20, v224, s36, v32
    v_dot2_f32_bf16 v21, v224, s37, v32
    v_dot2_f32_bf16 v22, v225, s36, v32
    v_dot2_f32_bf16 v23, v225, s37, v32
    v_dot2_f32_bf16 v24, v226, s36, v32
    v_dot2_f32_bf16 v25, v226, s37, v32
    v_dot2_f32_bf16 v26, v227, s36, v32
    v_dot2_f32_bf16 v27, v227, s37, v32
    v_cvt_pk_bf16_f32 v224, v20, v21
    v_cvt_pk_bf16_f32 v225, v22, v23
    v_cvt_pk_bf16_f32 v226, v24, v25
    v_cvt_pk_bf16_f32 v227, v26, v27
    ds_write_b128 v36, v[224:227] offset:640
    v_dot2_f32_bf16 v20, v228, s36, v32
    v_dot2_f32_bf16 v21, v228, s37, v32
    v_dot2_f32_bf16 v22, v229, s36, v32
    v_dot2_f32_bf16 v23, v229, s37, v32
    v_dot2_f32_bf16 v24, v230, s36, v32
    v_dot2_f32_bf16 v25, v230, s37, v32
    v_dot2_f32_bf16 v26, v231, s36, v32
    v_dot2_f32_bf16 v27, v231, s37, v32
    v_cvt_pk_bf16_f32 v228, v20, v21
    v_cvt_pk_bf16_f32 v229, v22, v23
    v_cvt_pk_bf16_f32 v230, v24, v25
    v_cvt_pk_bf16_f32 v231, v26, v27
    ds_write_b128 v36, v[228:231] offset:768
    v_dot2_f32_bf16 v20, v232, s36, v32
    v_dot2_f32_bf16 v21, v232, s37, v32
    v_dot2_f32_bf16 v22, v233, s36, v32
    v_dot2_f32_bf16 v23, v233, s37, v32
    v_dot2_f32_bf16 v24, v234, s36, v32
    v_dot2_f32_bf16 v25, v234, s37, v32
    v_dot2_f32_bf16 v26, v235, s36, v32
    v_dot2_f32_bf16 v27, v235, s37, v32
    v_cvt_pk_bf16_f32 v232, v20, v21
    v_cvt_pk_bf16_f32 v233, v22, v23
    v_cvt_pk_bf16_f32 v234, v24, v25
    v_cvt_pk_bf16_f32 v235, v26, v27
    ds_write_b128 v36, v[232:235] offset:896
    v_dot2_f32_bf16 v20, v236, s36, v32
    v_dot2_f32_bf16 v21, v236, s37, v32
    v_dot2_f32_bf16 v22, v237, s36, v32
    v_dot2_f32_bf16 v23, v237, s37, v32
    v_dot2_f32_bf16 v24, v238, s36, v32
    v_dot2_f32_bf16 v25, v238, s37, v32
    v_dot2_f32_bf16 v26, v239, s36, v32
    v_dot2_f32_bf16 v27, v239, s37, v32
    v_cvt_pk_bf16_f32 v236, v20, v21
    v_cvt_pk_bf16_f32 v237, v22, v23
    v_cvt_pk_bf16_f32 v238, v24, v25
    v_cvt_pk_bf16_f32 v239, v26, v27
    ds_write_b128 v36, v[236:239] offset:1024
    s_waitcnt lgkmcnt(0)
    s_barrier
    buffer_load_dwordx4 v[56:59], v240, s[8:11], s69 offen offset:0
    buffer_load_dwordx4 v[60:63], v240, s[8:11], s69 offen offset:128
    buffer_load_dwordx4 v[64:67], v240, s[8:11], s69 offen offset:256
    buffer_load_dwordx4 v[68:71], v240, s[8:11], s69 offen offset:384
    buffer_load_dwordx4 v[72:75], v240, s[8:11], s69 offen offset:512
    buffer_load_dwordx4 v[76:79], v240, s[8:11], s69 offen offset:640
    buffer_load_dwordx4 v[80:83], v240, s[8:11], s69 offen offset:768
    buffer_load_dwordx4 v[84:87], v240, s[8:11], s69 offen offset:896
    buffer_load_dwordx4 v[88:91], v240, s[8:11], s69 offen offset:1024
    v_mov_b32 v34, 0
    v_mov_b32 v35, 0
    v_dot2_f32_bf16 v34, v204, v204, v34
    v_dot2_f32_bf16 v35, v205, v205, v35
    v_dot2_f32_bf16 v34, v206, v206, v34
    v_dot2_f32_bf16 v35, v207, v207, v35
    v_dot2_f32_bf16 v34, v208, v208, v34
    v_dot2_f32_bf16 v35, v209, v209, v35
    v_dot2_f32_bf16 v34, v210, v210, v34
    v_dot2_f32_bf16 v35, v211, v211, v35
    v_dot2_f32_bf16 v34, v212, v212, v34
    v_dot2_f32_bf16 v35, v213, v213, v35
    v_dot2_f32_bf16 v34, v214, v214, v34
    v_dot2_f32_bf16 v35, v215, v215, v35
    v_dot2_f32_bf16 v34, v216, v216, v34
    v_dot2_f32_bf16 v35, v217, v217, v35
    v_dot2_f32_bf16 v34, v218, v218, v34
    v_dot2_f32_bf16 v35, v219, v219, v35
    v_dot2_f32_bf16 v34, v220, v220, v34
    v_dot2_f32_bf16 v35, v221, v221, v35
    v_dot2_f32_bf16 v34, v222, v222, v34
    v_dot2_f32_bf16 v35, v223, v223, v35
    v_dot2_f32_bf16 v34, v224, v224, v34
    v_dot2_f32_bf16 v35, v225, v225, v35
    v_dot2_f32_bf16 v34, v226, v226, v34
    v_dot2_f32_bf16 v35, v227, v227, v35
    v_dot2_f32_bf16 v34, v228, v228, v34
    v_dot2_f32_bf16 v35, v229, v229, v35
    v_dot2_f32_bf16 v34, v230, v230, v34
    v_dot2_f32_bf16 v35, v231, v231, v35
    v_dot2_f32_bf16 v34, v232, v232, v34
    v_dot2_f32_bf16 v35, v233, v233, v35
    v_dot2_f32_bf16 v34, v234, v234, v34
    v_dot2_f32_bf16 v35, v235, v235, v35
    v_dot2_f32_bf16 v34, v236, v236, v34
    v_dot2_f32_bf16 v35, v237, v237, v35
    v_dot2_f32_bf16 v34, v238, v238, v34
    v_dot2_f32_bf16 v35, v239, v239, v35
    s_nop 2
    v_add_f32 v34, v34, v35
    s_nop 1
    v_add_f32_dpp v34, v34, v34 quad_perm:[1,0,3,2] row_mask:0xf bank_mask:0xf
    s_nop 1
    v_add_f32_dpp v34, v34, v34 quad_perm:[2,3,0,1] row_mask:0xf bank_mask:0xf
    s_nop 1
    v_add_f32_dpp v34, v34, v34 row_half_mirror row_mask:0xf bank_mask:0xf
    v_mul_f32 v34, s45, v34
    v_add_f32 v34, 0x3727c5ac, v34
    v_sqrt_f32 v34, v34
    s_nop 0
    ds_write_b32 v38, v34 offset:0
    v_mov_b32 v32, 0
    v_mov_b32 v33, 0
    s_waitcnt vmcnt(8)
    v_dot2_f32_bf16 v32, v56, s44, v32
    v_dot2_f32_bf16 v33, v57, s44, v33
    v_dot2_f32_bf16 v32, v58, s44, v32
    v_dot2_f32_bf16 v33, v59, s44, v33
    s_waitcnt vmcnt(7)
    v_dot2_f32_bf16 v32, v60, s44, v32
    v_dot2_f32_bf16 v33, v61, s44, v33
    v_dot2_f32_bf16 v32, v62, s44, v32
    v_dot2_f32_bf16 v33, v63, s44, v33
    s_waitcnt vmcnt(6)
    v_dot2_f32_bf16 v32, v64, s44, v32
    v_dot2_f32_bf16 v33, v65, s44, v33
    v_dot2_f32_bf16 v32, v66, s44, v32
    v_dot2_f32_bf16 v33, v67, s44, v33
    s_waitcnt vmcnt(5)
    v_dot2_f32_bf16 v32, v68, s44, v32
    v_dot2_f32_bf16 v33, v69, s44, v33
    v_dot2_f32_bf16 v32, v70, s44, v32
    v_dot2_f32_bf16 v33, v71, s44, v33
    s_waitcnt vmcnt(4)
    v_dot2_f32_bf16 v32, v72, s44, v32
    v_dot2_f32_bf16 v33, v73, s44, v33
    v_dot2_f32_bf16 v32, v74, s44, v32
    v_dot2_f32_bf16 v33, v75, s44, v33
    s_waitcnt vmcnt(3)
    v_dot2_f32_bf16 v32, v76, s44, v32
    v_dot2_f32_bf16 v33, v77, s44, v33
    v_dot2_f32_bf16 v32, v78, s44, v32
    v_dot2_f32_bf16 v33, v79, s44, v33
    s_waitcnt vmcnt(2)
    v_dot2_f32_bf16 v32, v80, s44, v32
    v_dot2_f32_bf16 v33, v81, s44, v33
    v_dot2_f32_bf16 v32, v82, s44, v32
    v_dot2_f32_bf16 v33, v83, s44, v33
    s_waitcnt vmcnt(1)
    v_dot2_f32_bf16 v32, v84, s44, v32
    v_dot2_f32_bf16 v33, v85, s44, v33
    v_dot2_f32_bf16 v32, v86, s44, v32
    v_dot2_f32_bf16 v33, v87, s44, v33
    s_waitcnt vmcnt(0)
    v_dot2_f32_bf16 v32, v88, s44, v32
    v_dot2_f32_bf16 v33, v89, s44, v33
    v_dot2_f32_bf16 v32, v90, s44, v32
    v_dot2_f32_bf16 v33, v91, s44, v33
    s_nop 2
    v_add_f32 v32, v32, v33
    s_nop 1
    v_add_f32_dpp v32, v32, v32 quad_perm:[1,0,3,2] row_mask:0xf bank_mask:0xf
    s_nop 1
    v_add_f32_dpp v32, v32, v32 quad_perm:[2,3,0,1] row_mask:0xf bank_mask:0xf
    s_nop 1
    v_add_f32_dpp v32, v32, v32 row_half_mirror row_mask:0xf bank_mask:0xf
    v_mul_f32 v32, 0xbae38e39, v32
    v_dot2_f32_bf16 v20, v56, s36, v32
    v_dot2_f32_bf16 v21, v56, s37, v32
    v_dot2_f32_bf16 v22, v57, s36, v32
    v_dot2_f32_bf16 v23, v57, s37, v32
    v_dot2_f32_bf16 v24, v58, s36, v32
    v_dot2_f32_bf16 v25, v58, s37, v32
    v_dot2_f32_bf16 v26, v59, s36, v32
    v_dot2_f32_bf16 v27, v59, s37, v32
    v_cvt_pk_bf16_f32 v56, v20, v21
    v_cvt_pk_bf16_f32 v57, v22, v23
    v_cvt_pk_bf16_f32 v58, v24, v25
    v_cvt_pk_bf16_f32 v59, v26, v27
    ds_write_b128 v37, v[56:59] offset:0
    v_dot2_f32_bf16 v20, v60, s36, v32
    v_dot2_f32_bf16 v21, v60, s37, v32
    v_dot2_f32_bf16 v22, v61, s36, v32
    v_dot2_f32_bf16 v23, v61, s37, v32
    v_dot2_f32_bf16 v24, v62, s36, v32
    v_dot2_f32_bf16 v25, v62, s37, v32
    v_dot2_f32_bf16 v26, v63, s36, v32
    v_dot2_f32_bf16 v27, v63, s37, v32
    v_cvt_pk_bf16_f32 v60, v20, v21
    v_cvt_pk_bf16_f32 v61, v22, v23
    v_cvt_pk_bf16_f32 v62, v24, v25
    v_cvt_pk_bf16_f32 v63, v26, v27
    ds_write_b128 v37, v[60:63] offset:128
    s_barrier
    v_dot2_f32_bf16 v20, v64, s36, v32
    v_dot2_f32_bf16 v21, v64, s37, v32
    v_dot2_f32_bf16 v22, v65, s36, v32
    v_dot2_f32_bf16 v23, v65, s37, v32
    v_dot2_f32_bf16 v24, v66, s36, v32
    v_dot2_f32_bf16 v25, v66, s37, v32
    v_dot2_f32_bf16 v26, v67, s36, v32
    v_dot2_f32_bf16 v27, v67, s37, v32
    v_cvt_pk_bf16_f32 v64, v20, v21
    v_cvt_pk_bf16_f32 v65, v22, v23
    v_cvt_pk_bf16_f32 v66, v24, v25
    v_cvt_pk_bf16_f32 v67, v26, v27
    ds_write_b128 v37, v[64:67] offset:256
    v_dot2_f32_bf16 v20, v68, s36, v32
    v_dot2_f32_bf16 v21, v68, s37, v32
    v_dot2_f32_bf16 v22, v69, s36, v32
    v_dot2_f32_bf16 v23, v69, s37, v32
    v_dot2_f32_bf16 v24, v70, s36, v32
    v_dot2_f32_bf16 v25, v70, s37, v32
    v_dot2_f32_bf16 v26, v71, s36, v32
    v_dot2_f32_bf16 v27, v71, s37, v32
    v_cvt_pk_bf16_f32 v68, v20, v21
    v_cvt_pk_bf16_f32 v69, v22, v23
    v_cvt_pk_bf16_f32 v70, v24, v25
    v_cvt_pk_bf16_f32 v71, v26, v27
    ds_write_b128 v37, v[68:71] offset:384
    v_dot2_f32_bf16 v20, v72, s36, v32
    v_dot2_f32_bf16 v21, v72, s37, v32
    v_dot2_f32_bf16 v22, v73, s36, v32
    v_dot2_f32_bf16 v23, v73, s37, v32
    v_dot2_f32_bf16 v24, v74, s36, v32
    v_dot2_f32_bf16 v25, v74, s37, v32
    v_dot2_f32_bf16 v26, v75, s36, v32
    v_dot2_f32_bf16 v27, v75, s37, v32
    v_cvt_pk_bf16_f32 v72, v20, v21
    v_cvt_pk_bf16_f32 v73, v22, v23
    v_cvt_pk_bf16_f32 v74, v24, v25
    v_cvt_pk_bf16_f32 v75, v26, v27
    ds_write_b128 v37, v[72:75] offset:512
    v_dot2_f32_bf16 v20, v76, s36, v32
    v_dot2_f32_bf16 v21, v76, s37, v32
    v_dot2_f32_bf16 v22, v77, s36, v32
    v_dot2_f32_bf16 v23, v77, s37, v32
    v_dot2_f32_bf16 v24, v78, s36, v32
    v_dot2_f32_bf16 v25, v78, s37, v32
    v_dot2_f32_bf16 v26, v79, s36, v32
    v_dot2_f32_bf16 v27, v79, s37, v32
    v_cvt_pk_bf16_f32 v76, v20, v21
    v_cvt_pk_bf16_f32 v77, v22, v23
    v_cvt_pk_bf16_f32 v78, v24, v25
    v_cvt_pk_bf16_f32 v79, v26, v27
    ds_write_b128 v37, v[76:79] offset:640
    v_dot2_f32_bf16 v20, v80, s36, v32
    v_dot2_f32_bf16 v21, v80, s37, v32
    v_dot2_f32_bf16 v22, v81, s36, v32
    v_dot2_f32_bf16 v23, v81, s37, v32
    v_dot2_f32_bf16 v24, v82, s36, v32
    v_dot2_f32_bf16 v25, v82, s37, v32
    v_dot2_f32_bf16 v26, v83, s36, v32
    v_dot2_f32_bf16 v27, v83, s37, v32
    v_cvt_pk_bf16_f32 v80, v20, v21
    v_cvt_pk_bf16_f32 v81, v22, v23
    v_cvt_pk_bf16_f32 v82, v24, v25
    v_cvt_pk_bf16_f32 v83, v26, v27
    ds_write_b128 v37, v[80:83] offset:768
    v_dot2_f32_bf16 v20, v84, s36, v32
    v_dot2_f32_bf16 v21, v84, s37, v32
    v_dot2_f32_bf16 v22, v85, s36, v32
    v_dot2_f32_bf16 v23, v85, s37, v32
    v_dot2_f32_bf16 v24, v86, s36, v32
    v_dot2_f32_bf16 v25, v86, s37, v32
    v_dot2_f32_bf16 v26, v87, s36, v32
    v_dot2_f32_bf16 v27, v87, s37, v32
    v_cvt_pk_bf16_f32 v84, v20, v21
    v_cvt_pk_bf16_f32 v85, v22, v23
    v_cvt_pk_bf16_f32 v86, v24, v25
    v_cvt_pk_bf16_f32 v87, v26, v27
    ds_write_b128 v37, v[84:87] offset:896
    v_dot2_f32_bf16 v20, v88, s36, v32
    v_dot2_f32_bf16 v21, v88, s37, v32
    v_dot2_f32_bf16 v22, v89, s36, v32
    v_dot2_f32_bf16 v23, v89, s37, v32
    v_dot2_f32_bf16 v24, v90, s36, v32
    v_dot2_f32_bf16 v25, v90, s37, v32
    v_dot2_f32_bf16 v26, v91, s36, v32
    v_dot2_f32_bf16 v27, v91, s37, v32
    v_cvt_pk_bf16_f32 v88, v20, v21
    v_cvt_pk_bf16_f32 v89, v22, v23
    v_cvt_pk_bf16_f32 v90, v24, v25
    v_cvt_pk_bf16_f32 v91, v26, v27
    ds_write_b128 v37, v[88:91] offset:1024
    v_mov_b32 v34, 0
    v_mov_b32 v35, 0
    v_dot2_f32_bf16 v34, v56, v56, v34
    v_dot2_f32_bf16 v35, v57, v57, v35
    v_dot2_f32_bf16 v34, v58, v58, v34
    v_dot2_f32_bf16 v35, v59, v59, v35
    v_dot2_f32_bf16 v34, v60, v60, v34
    v_dot2_f32_bf16 v35, v61, v61, v35
    v_dot2_f32_bf16 v34, v62, v62, v34
    v_dot2_f32_bf16 v35, v63, v63, v35
    v_dot2_f32_bf16 v34, v64, v64, v34
    v_dot2_f32_bf16 v35, v65, v65, v35
    v_dot2_f32_bf16 v34, v66, v66, v34
    v_dot2_f32_bf16 v35, v67, v67, v35
    v_dot2_f32_bf16 v34, v68, v68, v34
    v_dot2_f32_bf16 v35, v69, v69, v35
    v_dot2_f32_bf16 v34, v70, v70, v34
    v_dot2_f32_bf16 v35, v71, v71, v35
    v_dot2_f32_bf16 v34, v72, v72, v34
    v_dot2_f32_bf16 v35, v73, v73, v35
    v_dot2_f32_bf16 v34, v74, v74, v34
    v_dot2_f32_bf16 v35, v75, v75, v35
    v_dot2_f32_bf16 v34, v76, v76, v34
    v_dot2_f32_bf16 v35, v77, v77, v35
    v_dot2_f32_bf16 v34, v78, v78, v34
    v_dot2_f32_bf16 v35, v79, v79, v35
    v_dot2_f32_bf16 v34, v80, v80, v34
    v_dot2_f32_bf16 v35, v81, v81, v35
    v_dot2_f32_bf16 v34, v82, v82, v34
    v_dot2_f32_bf16 v35, v83, v83, v35
    v_dot2_f32_bf16 v34, v84, v84, v34
    v_dot2_f32_bf16 v35, v85, v85, v35
    v_dot2_f32_bf16 v34, v86, v86, v34
    v_dot2_f32_bf16 v35, v87, v87, v35
    v_dot2_f32_bf16 v34, v88, v88, v34
    v_dot2_f32_bf16 v35, v89, v89, v35
    v_dot2_f32_bf16 v34, v90, v90, v34
    v_dot2_f32_bf16 v35, v91, v91, v35
    s_nop 2
    v_add_f32 v34, v34, v35
    s_nop 1
    v_add_f32_dpp v34, v34, v34 quad_perm:[1,0,3,2] row_mask:0xf bank_mask:0xf
    s_nop 1
    v_add_f32_dpp v34, v34, v34 quad_perm:[2,3,0,1] row_mask:0xf bank_mask:0xf
    s_nop 1
    v_add_f32_dpp v34, v34, v34 row_half_mirror row_mask:0xf bank_mask:0xf
    v_mul_f32 v34, s45, v34
    v_add_f32 v34, 0x3727c5ac, v34
    v_sqrt_f32 v34, v34
    s_nop 0
    ds_write_b32 v38, v34 offset:256
    s_waitcnt lgkmcnt(0)
    s_barrier
    ds_read_b32 v2, v39
    s_setprio 1
    ds_read_b128 v[96:99], v28 offset:0
    v_add_u32 v13, 0, v11
    ds_read_b64_tr_b16 v[40:41], v13 offset:0
    ds_read_b64_tr_b16 v[42:43], v13 offset:512
    ds_read_b128 v[100:103], v29 offset:0
    ds_read_b64_tr_b16 v[44:45], v13 offset:2048
    ds_read_b64_tr_b16 v[46:47], v13 offset:2560
    ds_read_b128 v[104:107], v30 offset:0
    ds_read_b64_tr_b16 v[48:49], v13 offset:4096
    ds_read_b64_tr_b16 v[50:51], v13 offset:4608
    s_waitcnt lgkmcnt(6)
    v_mfma_f32_32x32x16_bf16 v[80:95], v[40:43], v[96:99], 0
    ds_read_b64_tr_b16 v[52:53], v13 offset:6144
    ds_read_b64_tr_b16 v[54:55], v13 offset:6656
    ds_read_b128 v[108:111], v31 offset:0
    ds_read_b128 v[112:115], v28 offset:128
    ds_read_b128 v[116:119], v29 offset:128
    s_waitcnt lgkmcnt(8)
    v_mfma_f32_32x32x16_bf16 v[80:95], v[44:47], v[100:103], v[80:95]
    ds_read_b64_tr_b16 v[40:41], v13 offset:8192
    ds_read_b64_tr_b16 v[42:43], v13 offset:8704
    ds_read_b128 v[120:123], v30 offset:128
    ds_read_b128 v[124:127], v31 offset:128
    ds_read_b128 v[128:131], v28 offset:256
    s_waitcnt lgkmcnt(10)
    v_mfma_f32_32x32x16_bf16 v[80:95], v[48:51], v[104:107], v[80:95]
    ds_read_b64_tr_b16 v[44:45], v13 offset:10240
    ds_read_b64_tr_b16 v[46:47], v13 offset:10752
    ds_read_b128 v[132:135], v29 offset:256
    ds_read_b128 v[136:139], v30 offset:256
    ds_read_b128 v[140:143], v31 offset:256
    s_waitcnt lgkmcnt(12)
    v_mfma_f32_32x32x16_bf16 v[80:95], v[52:55], v[108:111], v[80:95]
    ds_read_b64_tr_b16 v[48:49], v13 offset:12288
    ds_read_b64_tr_b16 v[50:51], v13 offset:12800
    ds_read_b128 v[144:147], v28 offset:384
    ds_read_b128 v[148:151], v29 offset:384
    ds_read_b128 v[152:155], v30 offset:384
    s_waitcnt lgkmcnt(13)
    v_mfma_f32_32x32x16_bf16 v[80:95], v[40:43], v[112:115], v[80:95]
    ds_read_b64_tr_b16 v[52:53], v13 offset:14336
    ds_read_b64_tr_b16 v[54:55], v13 offset:14848
    ds_read_b128 v[156:159], v31 offset:384
    ds_read_b128 v[160:163], v28 offset:512
    ds_read_b128 v[164:167], v29 offset:512
    s_waitcnt lgkmcnt(13)
    v_mfma_f32_32x32x16_bf16 v[80:95], v[44:47], v[116:119], v[80:95]
    ds_read_b64_tr_b16 v[40:41], v13 offset:16384
    ds_read_b64_tr_b16 v[42:43], v13 offset:16896
    ds_read_b128 v[168:171], v30 offset:512
    ds_read_b128 v[172:175], v31 offset:512
    ds_read_b128 v[176:179], v28 offset:640
    s_waitcnt lgkmcnt(13)
    v_mfma_f32_32x32x16_bf16 v[80:95], v[48:51], v[120:123], v[80:95]
    ds_read_b64_tr_b16 v[44:45], v13 offset:18432
    ds_read_b64_tr_b16 v[46:47], v13 offset:18944
    ds_read_b128 v[180:183], v29 offset:640
    ds_read_b128 v[184:187], v30 offset:640
    ds_read_b128 v[188:191], v31 offset:640
    s_waitcnt lgkmcnt(13)
    v_mfma_f32_32x32x16_bf16 v[80:95], v[52:55], v[124:127], v[80:95]
    ds_read_b64_tr_b16 v[48:49], v13 offset:20480
    ds_read_b64_tr_b16 v[50:51], v13 offset:20992
    ds_read_b128 v[192:195], v28 offset:768
    ds_read_b128 v[196:199], v29 offset:768
    ds_read_b128 v[200:203], v30 offset:768
    s_waitcnt lgkmcnt(13)
    v_mfma_f32_32x32x16_bf16 v[80:95], v[40:43], v[128:131], v[80:95]
    ds_read_b64_tr_b16 v[52:53], v13 offset:22528
    ds_read_b64_tr_b16 v[54:55], v13 offset:23040
    ds_read_b128 v[204:207], v31 offset:768
    ds_read_b128 v[208:211], v28 offset:896
    ds_read_b128 v[212:215], v29 offset:896
    s_waitcnt lgkmcnt(13)
    v_mfma_f32_32x32x16_bf16 v[80:95], v[44:47], v[132:135], v[80:95]
    ds_read_b64_tr_b16 v[40:41], v13 offset:24576
    ds_read_b64_tr_b16 v[42:43], v13 offset:25088
    ds_read_b128 v[216:219], v30 offset:896
    ds_read_b128 v[220:223], v31 offset:896
    ds_read_b128 v[224:227], v28 offset:1024
    s_waitcnt lgkmcnt(13)
    v_mfma_f32_32x32x16_bf16 v[80:95], v[48:51], v[136:139], v[80:95]
    ds_read_b64_tr_b16 v[44:45], v13 offset:26624
    ds_read_b64_tr_b16 v[46:47], v13 offset:27136
    ds_read_b128 v[228:231], v29 offset:1024
    ds_read_b128 v[232:235], v30 offset:1024
    ds_read_b128 v[236:239], v31 offset:1024
    s_waitcnt lgkmcnt(13)
    v_mfma_f32_32x32x16_bf16 v[80:95], v[52:55], v[140:143], v[80:95]
    ds_read_b64_tr_b16 v[48:49], v13 offset:28672
    ds_read_b64_tr_b16 v[50:51], v13 offset:29184
    s_waitcnt lgkmcnt(10)
    v_mfma_f32_32x32x16_bf16 v[80:95], v[40:43], v[144:147], v[80:95]
    ds_read_b64_tr_b16 v[52:53], v13 offset:30720
    ds_read_b64_tr_b16 v[54:55], v13 offset:31232
    s_waitcnt lgkmcnt(7)
    v_mfma_f32_32x32x16_bf16 v[80:95], v[44:47], v[148:151], v[80:95]
    ds_read_b64_tr_b16 v[40:41], v13 offset:32768
    ds_read_b64_tr_b16 v[42:43], v13 offset:33280
    s_waitcnt lgkmcnt(4)
    v_mfma_f32_32x32x16_bf16 v[80:95], v[48:51], v[152:155], v[80:95]
    ds_read_b64_tr_b16 v[44:45], v13 offset:34816
    ds_read_b64_tr_b16 v[46:47], v13 offset:35328
    s_waitcnt lgkmcnt(4)
    v_mfma_f32_32x32x16_bf16 v[80:95], v[52:55], v[156:159], v[80:95]
    s_waitcnt lgkmcnt(8)
    s_barrier
    v_add_u32 v13, 36864, v11
    ds_read_b64_tr_b16 v[48:49], v13 offset:0
    ds_read_b64_tr_b16 v[50:51], v13 offset:512
    s_waitcnt lgkmcnt(4)
    v_mfma_f32_32x32x16_bf16 v[80:95], v[40:43], v[160:163], v[80:95]
    ds_read_b64_tr_b16 v[52:53], v13 offset:2048
    ds_read_b64_tr_b16 v[54:55], v13 offset:2560
    s_waitcnt lgkmcnt(4)
    v_mfma_f32_32x32x16_bf16 v[80:95], v[44:47], v[164:167], v[80:95]
    ds_read_b64_tr_b16 v[40:41], v13 offset:4096
    ds_read_b64_tr_b16 v[42:43], v13 offset:4608
    s_waitcnt lgkmcnt(4)
    v_mfma_f32_32x32x16_bf16 v[80:95], v[48:51], v[168:171], v[80:95]
    ds_read_b64_tr_b16 v[44:45], v13 offset:6144
    ds_read_b64_tr_b16 v[46:47], v13 offset:6656
    s_waitcnt lgkmcnt(4)
    v_mfma_f32_32x32x16_bf16 v[80:95], v[52:55], v[172:175], v[80:95]
    ds_read_b64_tr_b16 v[48:49], v13 offset:8192
    ds_read_b64_tr_b16 v[50:51], v13 offset:8704
    s_waitcnt lgkmcnt(4)
    v_mfma_f32_32x32x16_bf16 v[80:95], v[40:43], v[176:179], v[80:95]
    ds_read_b64_tr_b16 v[52:53], v13 offset:10240
    ds_read_b64_tr_b16 v[54:55], v13 offset:10752
    s_waitcnt lgkmcnt(4)
    v_mfma_f32_32x32x16_bf16 v[80:95], v[44:47], v[180:183], v[80:95]
    ds_read_b64_tr_b16 v[40:41], v13 offset:12288
    ds_read_b64_tr_b16 v[42:43], v13 offset:12800
    s_waitcnt lgkmcnt(4)
    v_mfma_f32_32x32x16_bf16 v[80:95], v[48:51], v[184:187], v[80:95]
    ds_read_b64_tr_b16 v[44:45], v13 offset:14336
    ds_read_b64_tr_b16 v[46:47], v13 offset:14848
    s_waitcnt lgkmcnt(4)
    v_mfma_f32_32x32x16_bf16 v[80:95], v[52:55], v[188:191], v[80:95]
    ds_read_b64_tr_b16 v[48:49], v13 offset:16384
    ds_read_b64_tr_b16 v[50:51], v13 offset:16896
    s_waitcnt lgkmcnt(4)
    v_mfma_f32_32x32x16_bf16 v[80:95], v[40:43], v[192:195], v[80:95]
    ds_read_b64_tr_b16 v[52:53], v13 offset:18432
    ds_read_b64_tr_b16 v[54:55], v13 offset:18944
    s_waitcnt lgkmcnt(4)
    v_mfma_f32_32x32x16_bf16 v[80:95], v[44:47], v[196:199], v[80:95]
    ds_read_b64_tr_b16 v[40:41], v13 offset:20480
    ds_read_b64_tr_b16 v[42:43], v13 offset:20992
    s_waitcnt lgkmcnt(4)
    v_mfma_f32_32x32x16_bf16 v[80:95], v[48:51], v[200:203], v[80:95]
    ds_read_b64_tr_b16 v[44:45], v13 offset:22528
    ds_read_b64_tr_b16 v[46:47], v13 offset:23040
    s_waitcnt lgkmcnt(4)
    v_mfma_f32_32x32x16_bf16 v[80:95], v[52:55], v[204:207], v[80:95]
    ds_read_b64_tr_b16 v[48:49], v13 offset:24576
    ds_read_b64_tr_b16 v[50:51], v13 offset:25088
    s_waitcnt lgkmcnt(4)
    v_mfma_f32_32x32x16_bf16 v[80:95], v[40:43], v[208:211], v[80:95]
    ds_read_b64_tr_b16 v[52:53], v13 offset:26624
    ds_read_b64_tr_b16 v[54:55], v13 offset:27136
    s_waitcnt lgkmcnt(4)
    v_mfma_f32_32x32x16_bf16 v[80:95], v[44:47], v[212:215], v[80:95]
    ds_read_b64_tr_b16 v[40:41], v13 offset:28672
    ds_read_b64_tr_b16 v[42:43], v13 offset:29184
    s_waitcnt lgkmcnt(4)
    v_mfma_f32_32x32x16_bf16 v[80:95], v[48:51], v[216:219], v[80:95]
    ds_read_b64_tr_b16 v[44:45], v13 offset:30720
    ds_read_b64_tr_b16 v[46:47], v13 offset:31232
    s_waitcnt lgkmcnt(4)
    v_mfma_f32_32x32x16_bf16 v[80:95], v[52:55], v[220:223], v[80:95]
    ds_read_b64_tr_b16 v[48:49], v13 offset:32768
    ds_read_b64_tr_b16 v[50:51], v13 offset:33280
    s_waitcnt lgkmcnt(4)
    v_mfma_f32_32x32x16_bf16 v[80:95], v[40:43], v[224:227], v[80:95]
    ds_read_b64_tr_b16 v[52:53], v13 offset:34816
    ds_read_b64_tr_b16 v[54:55], v13 offset:35328
    s_waitcnt lgkmcnt(0)
    s_barrier
    v_mfma_f32_32x32x16_bf16 v[80:95], v[44:47], v[228:231], v[80:95]
    v_mfma_f32_32x32x16_bf16 v[80:95], v[48:51], v[232:235], v[80:95]
    v_mfma_f32_32x32x16_bf16 v[80:95], v[52:55], v[236:239], v[80:95]
    s_setprio 0
L1_fx0e:
    s_nop 1
    s_mov_b32 s71, 0xe0c0
    s_bitcmp1_b32 s71, s42
    s_cselect_b32 s71, 0x7f000000, 0
    s_add_u32 s70, s71, s51
    s_waitcnt lgkmcnt(15)
    v_rcp_f32 v0, v2
    s_nop 0
    v_mul_f32 v17, 0xc0135761, v0
    v_mul_f32 v20, v0, v0
    v_mul_f32 v0, v0, v20
    v_mul_f32 v0, 0xbdd2d3e8, v0
    v_mul_f32 v20, v80, v80
    v_mul_f32 v21, v81, v81
    v_mul_f32 v22, v82, v82
    v_mul_f32 v23, v83, v83
    v_fma_f32 v20, v20, v0, v17
    v_fma_f32 v21, v21, v0, v17
    v_fma_f32 v22, v22, v0, v17
    v_fma_f32 v23, v23, v0, v17
    v_mul_f32 v20, v20, v80
    v_mul_f32 v21, v21, v81
    v_mul_f32 v22, v22, v82
    v_mul_f32 v23, v23, v83
    v_exp_f32 v20, v20
    v_exp_f32 v21, v21
    v_exp_f32 v22, v22
    v_exp_f32 v23, v23
    v_fma_f32 v20, v20, v2, v2
    v_fma_f32 v21, v21, v2, v2
    v_fma_f32 v22, v22, v2, v2
    s_mul_i32 s56, s46, 663552
    s_add_u32 s56, s56, s49
    s_add_u32 m0, s53, 110592
    s_add_u32 s56, s56, 2654336
    buffer_load_dwordx4 v4, s[12:15], s56 offen offset:0 lds
    v_fma_f32 v23, v23, v2, v2
    v_rcp_f32 v20, v20
    v_rcp_f32 v21, v21
    v_rcp_f32 v22, v22
    v_rcp_f32 v23, v23
    v_mul_f32 v80, v80, v20
    v_mul_f32 v81, v81, v21
    v_mul_f32 v82, v82, v22
    v_mul_f32 v83, v83, v23
    v_add_f32 v18, v18, v80
    v_fmac_f32 v19, v80, v80
    v_add_f32 v18, v18, v81
    v_fmac_f32 v19, v81, v81
    v_add_f32 v18, v18, v82
    v_fmac_f32 v19, v82, v82
    buffer_load_dwordx4 v5, s[12:15], s56 offen offset:1024 lds
    v_add_f32 v18, v18, v83
    v_fmac_f32 v19, v83, v83
    v_cvt_pk_bf16_f32 v56, v80, v81
    v_cvt_pk_bf16_f32 v57, v82, v83
    v_mul_f32 v24, v84, v84
    v_mul_f32 v25, v85, v85
    v_mul_f32 v26, v86, v86
    v_mul_f32 v27, v87, v87
    v_fma_f32 v24, v24, v0, v17
    v_fma_f32 v25, v25, v0, v17
    v_fma_f32 v26, v26, v0, v17
    v_fma_f32 v27, v27, v0, v17
    v_mul_f32 v24, v24, v84
    v_mul_f32 v25, v25, v85
    buffer_load_dwordx4 v6, s[12:15], s56 offen offset:2048 lds
    v_mul_f32 v26, v26, v86
    v_mul_f32 v27, v27, v87
    v_exp_f32 v24, v24
    v_exp_f32 v25, v25
    v_exp_f32 v26, v26
    v_exp_f32 v27, v27
    v_fma_f32 v24, v24, v2, v2
    v_fma_f32 v25, v25, v2, v2
    v_fma_f32 v26, v26, v2, v2
    v_fma_f32 v27, v27, v2, v2
    v_rcp_f32 v24, v24
    v_rcp_f32 v25, v25
    v_rcp_f32 v26, v26
    v_rcp_f32 v27, v27
    v_mul_f32 v84, v84, v24
    s_add_u32 m0, s53, 113664
    s_add_u32 s56, s56, 221184
    buffer_load_dwordx4 v4, s[12:15], s56 offen offset:0 lds
    v_mul_f32 v85, v85, v25
    v_mul_f32 v86, v86, v26
    v_mul_f32 v87, v87, v27
    v_add_f32 v18, v18, v84
    v_fmac_f32 v19, v84, v84
    v_add_f32 v18, v18, v85
    v_fmac_f32 v19, v85, v85
    v_add_f32 v18, v18, v86
    v_fmac_f32 v19, v86, v86
    v_add_f32 v18, v18, v87
    v_fmac_f32 v19, v87, v87
    v_cvt_pk_bf16_f32 v58, v84, v85
    v_cvt_pk_bf16_f32 v59, v86, v87
    v_mul_f32 v20, v88, v88
    v_mul_f32 v21, v89, v89
    buffer_load_dwordx4 v5, s[12:15], s56 offen offset:1024 lds
    v_mul_f32 v22, v90, v90
    v_mul_f32 v23, v91, v91
    v_fma_f32 v20, v20, v0, v17
    v_fma_f32 v21, v21, v0, v17
    v_fma_f32 v22, v22, v0, v17
    v_fma_f32 v23, v23, v0, v17
    v_mul_f32 v20, v20, v88
    v_mul_f32 v21, v21, v89
    v_mul_f32 v22, v22, v90
    v_mul_f32 v23, v23, v91
    v_exp_f32 v20, v20
    v_exp_f32 v21, v21
    v_exp_f32 v22, v22
    v_exp_f32 v23, v23
    buffer_load_dwordx4 v6, s[12:15], s56 offen offset:2048 lds
    v_fma_f32 v20, v20, v2, v2
    v_fma_f32 v21, v21, v2, v2
    v_fma_f32 v22, v22, v2, v2
    v_fma_f32 v23, v23, v2, v2
    v_rcp_f32 v20, v20
    v_rcp_f32 v21, v21
    v_rcp_f32 v22, v22
    v_rcp_f32 v23, v23
    v_mul_f32 v88, v88, v20
    v_mul_f32 v89, v89, v21
    v_mul_f32 v90, v90, v22
    v_mul_f32 v91, v91, v23
    v_add_f32 v18, v18, v88
    v_fmac_f32 v19, v88, v88
    v_add_f32 v18, v18, v89
    s_add_u32 m0, s53, 116736
    s_add_u32 s56, s56, 221184
    buffer_load_dwordx4 v4, s[12:15], s56 offen offset:0 lds
    v_fmac_f32 v19, v89, v89
    v_add_f32 v18, v18, v90
    v_fmac_f32 v19, v90, v90
    v_add_f32 v18, v18, v91
    v_fmac_f32 v19, v91, v91
    v_cvt_pk_bf16_f32 v60, v88, v89
    v_cvt_pk_bf16_f32 v61, v90, v91
    v_mul_f32 v24, v92, v92
    v_mul_f32 v25, v93, v93
    v_mul_f32 v26, v94, v94
    v_mul_f32 v27, v95, v95
    v_fma_f32 v24, v24, v0, v17
    v_fma_f32 v25, v25, v0, v17
    v_fma_f32 v26, v26, v0, v17
    v_fma_f32 v27, v27, v0, v17
    buffer_load_dwordx4 v5, s[12:15], s56 offen offset:1024 lds
    v_mul_f32 v24, v24, v92
    v_mul_f32 v25, v25, v93
    v_mul_f32 v26, v26, v94
    v_mul_f32 v27, v27, v95
    v_exp_f32 v24, v24
    v_exp_f32 v25, v25
    v_exp_f32 v26, v26
    v_exp_f32 v27, v27
    v_fma_f32 v24, v24, v2, v2
    v_fma_f32 v25, v25, v2, v2
    v_fma_f32 v26, v26, v2, v2
    v_fma_f32 v27, v27, v2, v2
    v_rcp_f32 v24, v24
    v_rcp_f32 v25, v25
    buffer_load_dwordx4 v6, s[12:15], s56 offen offset:2048 lds
    v_rcp_f32 v26, v26
    v_rcp_f32 v27, v27
    v_mul_f32 v92, v92, v24
    v_mul_f32 v93, v93, v25
    v_mul_f32 v94, v94, v26
    v_mul_f32 v95, v95, v27
    v_add_f32 v18, v18, v92
    v_fmac_f32 v19, v92, v92
    v_add_f32 v18, v18, v93
    v_fmac_f32 v19, v93, v93
    v_add_f32 v18, v18, v94
    v_fmac_f32 v19, v94, v94
    v_add_f32 v18, v18, v95
    v_fmac_f32 v19, v95, v95
    v_cvt_pk_bf16_f32 v62, v92, v93
    v_cvt_pk_bf16_f32 v63, v94, v95
    s_waitcnt lgkmcnt(0)
    s_barrier
    s_setprio 1
    v_add_u32 v13, 73728, v11
    ds_read_b64_tr_b16 v[40:41], v13 offset:0
    ds_read_b64_tr_b16 v[42:43], v13 offset:512
    ds_read_b64_tr_b16 v[44:45], v13 offset:2048
    ds_read_b64_tr_b16 v[46:47], v13 offset:2560
    ds_read_b64_tr_b16 v[48:49], v13 offset:4096
    ds_read_b64_tr_b16 v[50:51], v13 offset:4608
    s_waitcnt lgkmcnt(4)
    v_mfma_f32_32x32x16_bf16 v[80:95], v[40:43], v[96:99], 0
    ds_read_b64_tr_b16 v[52:53], v13 offset:6144
    ds_read_b64_tr_b16 v[54:55], v13 offset:6656
    s_waitcnt lgkmcnt(4)
    v_mfma_f32_32x32x16_bf16 v[80:95], v[44:47], v[100:103], v[80:95]
    ds_read_b64_tr_b16 v[40:41], v13 offset:8192
    ds_read_b64_tr_b16 v[42:43], v13 offset:8704
    s_waitcnt lgkmcnt(4)
    v_mfma_f32_32x32x16_bf16 v[80:95], v[48:51], v[104:107], v[80:95]
    ds_read_b64_tr_b16 v[44:45], v13 offset:10240
    ds_read_b64_tr_b16 v[46:47], v13 offset:10752
    s_waitcnt lgkmcnt(4)
    v_mfma_f32_32x32x16_bf16 v[80:95], v[52:55], v[108:111], v[80:95]
    ds_read_b64_tr_b16 v[48:49], v13 offset:12288
    ds_read_b64_tr_b16 v[50:51], v13 offset:12800
    s_waitcnt lgkmcnt(4)
    v_mfma_f32_32x32x16_bf16 v[80:95], v[40:43], v[112:115], v[80:95]
    ds_read_b64_tr_b16 v[52:53], v13 offset:14336
    ds_read_b64_tr_b16 v[54:55], v13 offset:14848
    s_waitcnt lgkmcnt(4)
    v_mfma_f32_32x32x16_bf16 v[80:95], v[44:47], v[116:119], v[80:95]
    ds_read_b64_tr_b16 v[40:41], v13 offset:16384
    ds_read_b64_tr_b16 v[42:43], v13 offset:16896
    s_waitcnt lgkmcnt(4)
    v_mfma_f32_32x32x16_bf16 v[80:95], v[48:51], v[120:123], v[80:95]
    ds_read_b64_tr_b16 v[44:45], v13 offset:18432
    ds_read_b64_tr_b16 v[46:47], v13 offset:18944
    s_waitcnt lgkmcnt(4)
    v_mfma_f32_32x32x16_bf16 v[80:95], v[52:55], v[124:127], v[80:95]
    ds_read_b64_tr_b16 v[48:49], v13 offset:20480
    ds_read_b64_tr_b16 v[50:51], v13 offset:20992
    s_waitcnt lgkmcnt(4)
    v_mfma_f32_32x32x16_bf16 v[80:95], v[40:43], v[128:131], v[80:95]
    ds_read_b64_tr_b16 v[52:53], v13 offset:22528
    ds_read_b64_tr_b16 v[54:55], v13 offset:23040
    s_waitcnt lgkmcnt(4)
    v_mfma_f32_32x32x16_bf16 v[80:95], v[44:47], v[132:135], v[80:95]
    ds_read_b64_tr_b16 v[40:41], v13 offset:24576
    ds_read_b64_tr_b16 v[42:43], v13 offset:25088
    s_waitcnt lgkmcnt(4)
    v_mfma_f32_32x32x16_bf16 v[80:95], v[48:51], v[136:139], v[80:95]
    ds_read_b64_tr_b16 v[44:45], v13 offset:26624
    ds_read_b64_tr_b16 v[46:47], v13 offset:27136
    s_waitcnt lgkmcnt(4)
    v_mfma_f32_32x32x16_bf16 v[80:95], v[52:55], v[140:143], v[80:95]
    ds_read_b64_tr_b16 v[48:49], v13 offset:28672
    ds_read_b64_tr_b16 v[50:51], v13 offset:29184
    s_waitcnt lgkmcnt(4)
    v_mfma_f32_32x32x16_bf16 v[80:95], v[40:43], v[144:147], v[80:95]
    ds_read_b64_tr_b16 v[52:53], v13 offset:30720
    ds_read_b64_tr_b16 v[54:55], v13 offset:31232
    s_waitcnt lgkmcnt(4)
    v_mfma_f32_32x32x16_bf16 v[80:95], v[44:47], v[148:151], v[80:95]
    ds_read_b64_tr_b16 v[40:41], v13 offset:32768
    ds_read_b64_tr_b16 v[42:43], v13 offset:33280
    s_waitcnt lgkmcnt(4)
    v_mfma_f32_32x32x16_bf16 v[80:95], v[48:51], v[152:155], v[80:95]
    ds_read_b64_tr_b16 v[44:45], v13 offset:34816
    ds_read_b64_tr_b16 v[46:47], v13 offset:35328
    s_waitcnt lgkmcnt(4)
    v_mfma_f32_32x32x16_bf16 v[80:95], v[52:55], v[156:159], v[80:95]
    s_waitcnt vmcnt(0)
    s_barrier
    v_add_u32 v13, 110592, v11
    ds_read_b64_tr_b16 v[48:49], v13 offset:0
    ds_read_b64_tr_b16 v[50:51], v13 offset:512
    s_waitcnt lgkmcnt(4)
    v_mfma_f32_32x32x16_bf16 v[80:95], v[40:43], v[160:163], v[80:95]
    ds_read_b64_tr_b16 v[52:53], v13 offset:2048
    ds_read_b64_tr_b16 v[54:55], v13 offset:2560
    s_waitcnt lgkmcnt(4)
    v_mfma_f32_32x32x16_bf16 v[80:95], v[44:47], v[164:167], v[80:95]
    ds_read_b64_tr_b16 v[40:41], v13 offset:4096
    ds_read_b64_tr_b16 v[42:43], v13 offset:4608
    s_waitcnt lgkmcnt(4)
    v_mfma_f32_32x32x16_bf16 v[80:95], v[48:51], v[168:171], v[80:95]
    ds_read_b64_tr_b16 v[44:45], v13 offset:6144
    ds_read_b64_tr_b16 v[46:47], v13 offset:6656
    s_waitcnt lgkmcnt(4)
    v_mfma_f32_32x32x16_bf16 v[80:95], v[52:55], v[172:175], v[80:95]
    ds_read_b64_tr_b16 v[48:49], v13 offset:8192
    ds_read_b64_tr_b16 v[50:51], v13 offset:8704
    s_waitcnt lgkmcnt(4)
    v_mfma_f32_32x32x16_bf16 v[80:95], v[40:43], v[176:179], v[80:95]
    ds_read_b64_tr_b16 v[52:53], v13 offset:10240
    ds_read_b64_tr_b16 v[54:55], v13 offset:10752
    s_waitcnt lgkmcnt(4)
    v_mfma_f32_32x32x16_bf16 v[80:95], v[44:47], v[180:183], v[80:95]
    ds_read_b64_tr_b16 v[40:41], v13 offset:12288
    ds_read_b64_tr_b16 v[42:43], v13 offset:12800
    s_waitcnt lgkmcnt(4)
    v_mfma_f32_32x32x16_bf16 v[80:95], v[48:51], v[184:187], v[80:95]
    ds_read_b64_tr_b16 v[44:45], v13 offset:14336
    ds_read_b64_tr_b16 v[46:47], v13 offset:14848
    s_waitcnt lgkmcnt(4)
    v_mfma_f32_32x32x16_bf16 v[80:95], v[52:55], v[188:191], v[80:95]
    ds_read_b64_tr_b16 v[48:49], v13 offset:16384
    ds_read_b64_tr_b16 v[50:51], v13 offset:16896
    s_waitcnt lgkmcnt(4)
    v_mfma_f32_32x32x16_bf16 v[80:95], v[40:43], v[192:195], v[80:95]
    ds_read_b64_tr_b16 v[52:53], v13 offset:18432
    ds_read_b64_tr_b16 v[54:55], v13 offset:18944
    s_waitcnt lgkmcnt(4)
    v_mfma_f32_32x32x16_bf16 v[80:95], v[44:47], v[196:199], v[80:95]
    ds_read_b64_tr_b16 v[40:41], v13 offset:20480
    ds_read_b64_tr_b16 v[42:43], v13 offset:20992
    s_waitcnt lgkmcnt(4)
    v_mfma_f32_32x32x16_bf16 v[80:95], v[48:51], v[200:203], v[80:95]
    ds_read_b64_tr_b16 v[44:45], v13 offset:22528
    ds_read_b64_tr_b16 v[46:47], v13 offset:23040
    s_waitcnt lgkmcnt(4)
    v_mfma_f32_32x32x16_bf16 v[80:95], v[52:55], v[204:207], v[80:95]
    ds_read_b64_tr_b16 v[48:49], v13 offset:24576
    ds_read_b64_tr_b16 v[50:51], v13 offset:25088
    s_waitcnt lgkmcnt(4)
    v_mfma_f32_32x32x16_bf16 v[80:95], v[40:43], v[208:211], v[80:95]
    ds_read_b64_tr_b16 v[52:53], v13 offset:26624
    ds_read_b64_tr_b16 v[54:55], v13 offset:27136
    s_waitcnt lgkmcnt(4)
    v_mfma_f32_32x32x16_bf16 v[80:95], v[44:47], v[212:215], v[80:95]
    ds_read_b64_tr_b16 v[40:41], v13 offset:28672
    ds_read_b64_tr_b16 v[42:43], v13 offset:29184
    s_waitcnt lgkmcnt(4)
    v_mfma_f32_32x32x16_bf16 v[80:95], v[48:51], v[216:219], v[80:95]
    ds_read_b64_tr_b16 v[44:45], v13 offset:30720
    ds_read_b64_tr_b16 v[46:47], v13 offset:31232
    s_waitcnt lgkmcnt(4)
    v_mfma_f32_32x32x16_bf16 v[80:95], v[52:55], v[220:223], v[80:95]
    ds_read_b64_tr_b16 v[48:49], v13 offset:32768
    ds_read_b64_tr_b16 v[50:51], v13 offset:33280
    s_waitcnt lgkmcnt(4)
    v_mfma_f32_32x32x16_bf16 v[80:95], v[40:43], v[224:227], v[80:95]
    ds_read_b64_tr_b16 v[52:53], v13 offset:34816
    ds_read_b64_tr_b16 v[54:55], v13 offset:35328
    s_waitcnt lgkmcnt(0)
    s_barrier
    v_mfma_f32_32x32x16_bf16 v[80:95], v[44:47], v[228:231], v[80:95]
    v_mfma_f32_32x32x16_bf16 v[80:95], v[48:51], v[232:235], v[80:95]
    v_mfma_f32_32x32x16_bf16 v[80:95], v[52:55], v[236:239], v[80:95]
    s_setprio 0
    s_nop 10
    v_mul_f32 v20, v80, v80
    v_mul_f32 v21, v81, v81
    v_mul_f32 v22, v82, v82
    v_mul_f32 v23, v83, v83
    v_fma_f32 v20, v20, v0, v17
    v_fma_f32 v21, v21, v0, v17
    v_fma_f32 v22, v22, v0, v17
    v_fma_f32 v23, v23, v0, v17
    v_mul_f32 v20, v20, v80
    v_mul_f32 v21, v21, v81
    v_mul_f32 v22, v22, v82
    v_mul_f32 v23, v23, v83
    v_exp_f32 v20, v20
    v_exp_f32 v21, v21
    v_exp_f32 v22, v22
    v_exp_f32 v23, v23
    v_fma_f32 v20, v20, v2, v2
    v_fma_f32 v21, v21, v2, v2
    v_fma_f32 v22, v22, v2, v2
    s_mul_i32 s56, s46, 248832
    s_add_u32 s56, s56, s51
    s_add_u32 m0, s53, 36864
    s_add_u32 s56, s56, 0
    buffer_load_dwordx4 v7, s[16:19], s56 offen offset:0 lds
    v_fma_f32 v23, v23, v2, v2
    v_rcp_f32 v20, v20
    v_rcp_f32 v21, v21
    v_rcp_f32 v22, v22
    v_rcp_f32 v23, v23
    v_mul_f32 v80, v80, v20
    v_mul_f32 v81, v81, v21
    v_mul_f32 v82, v82, v22
    v_mul_f32 v83, v83, v23
    v_add_f32 v18, v18, v80
    v_fmac_f32 v19, v80, v80
    v_add_f32 v18, v18, v81
    v_fmac_f32 v19, v81, v81
    v_add_f32 v18, v18, v82
    v_fmac_f32 v19, v82, v82
    buffer_load_dwordx4 v8, s[16:19], s56 offen offset:1024 lds
    v_add_f32 v18, v18, v83
    v_fmac_f32 v19, v83, v83
    v_cvt_pk_bf16_f32 v64, v80, v81
    v_cvt_pk_bf16_f32 v65, v82, v83
    v_mul_f32 v24, v84, v84
    v_mul_f32 v25, v85, v85
    v_mul_f32 v26, v86, v86
    v_mul_f32 v27, v87, v87
    v_fma_f32 v24, v24, v0, v17
    v_fma_f32 v25, v25, v0, v17
    v_fma_f32 v26, v26, v0, v17
    v_fma_f32 v27, v27, v0, v17
    v_mul_f32 v24, v24, v84
    v_mul_f32 v25, v25, v85
    buffer_load_dwordx4 v9, s[16:19], s56 offen offset:2048 lds
    v_mul_f32 v26, v26, v86
    v_mul_f32 v27, v27, v87
    v_exp_f32 v24, v24
    v_exp_f32 v25, v25
    v_exp_f32 v26, v26
    v_exp_f32 v27, v27
    v_fma_f32 v24, v24, v2, v2
    v_fma_f32 v25, v25, v2, v2
    v_fma_f32 v26, v26, v2, v2
    v_fma_f32 v27, v27, v2, v2
    v_rcp_f32 v24, v24
    v_rcp_f32 v25, v25
    v_rcp_f32 v26, v26
    v_rcp_f32 v27, v27
    v_mul_f32 v84, v84, v24
    s_add_u32 m0, s53, 39936
    s_add_u32 s56, s56, 82944
    buffer_load_dwordx4 v7, s[16:19], s56 offen offset:0 lds
    v_mul_f32 v85, v85, v25
    v_mul_f32 v86, v86, v26
    v_mul_f32 v87, v87, v27
    v_add_f32 v18, v18, v84
    v_fmac_f32 v19, v84, v84
    v_add_f32 v18, v18, v85
    v_fmac_f32 v19, v85, v85
    v_add_f32 v18, v18, v86
    v_fmac_f32 v19, v86, v86
    v_add_f32 v18, v18, v87
    v_fmac_f32 v19, v87, v87
    v_cvt_pk_bf16_f32 v66, v84, v85
    v_cvt_pk_bf16_f32 v67, v86, v87
    v_mul_f32 v20, v88, v88
    v_mul_f32 v21, v89, v89
    buffer_load_dwordx4 v8, s[16:19], s56 offen offset:1024 lds
    v_mul_f32 v22, v90, v90
    v_mul_f32 v23, v91, v91
    v_fma_f32 v20, v20, v0, v17
    v_fma_f32 v21, v21, v0, v17
    v_fma_f32 v22, v22, v0, v17
    v_fma_f32 v23, v23, v0, v17
    v_mul_f32 v20, v20, v88
    v_mul_f32 v21, v21, v89
    v_mul_f32 v22, v22, v90
    v_mul_f32 v23, v23, v91
    v_exp_f32 v20, v20
    v_exp_f32 v21, v21
    v_exp_f32 v22, v22
    v_exp_f32 v23, v23
    buffer_load_dwordx4 v9, s[16:19], s56 offen offset:2048 lds
    v_fma_f32 v20, v20, v2, v2
    v_fma_f32 v21, v21, v2, v2
    v_fma_f32 v22, v22, v2, v2
    v_fma_f32 v23, v23, v2, v2
    v_rcp_f32 v20, v20
    v_rcp_f32 v21, v21
    v_rcp_f32 v22, v22
    v_rcp_f32 v23, v23
    v_mul_f32 v88, v88, v20
    v_mul_f32 v89, v89, v21
    v_mul_f32 v90, v90, v22
    v_mul_f32 v91, v91, v23
    v_add_f32 v18, v18, v88
    v_fmac_f32 v19, v88, v88
    v_add_f32 v18, v18, v89
    s_add_u32 m0, s53, 43008
    s_add_u32 s56, s56, 82944
    buffer_load_dwordx4 v7, s[16:19], s56 offen offset:0 lds
    v_fmac_f32 v19, v89, v89
    v_add_f32 v18, v18, v90
    v_fmac_f32 v19, v90, v90
    v_add_f32 v18, v18, v91
    v_fmac_f32 v19, v91, v91
    v_cvt_pk_bf16_f32 v68, v88, v89
    v_cvt_pk_bf16_f32 v69, v90, v91
    v_mul_f32 v24, v92, v92
    v_mul_f32 v25, v93, v93
    v_mul_f32 v26, v94, v94
    v_mul_f32 v27, v95, v95
    v_fma_f32 v24, v24, v0, v17
    v_fma_f32 v25, v25, v0, v17
    v_fma_f32 v26, v26, v0, v17
    v_fma_f32 v27, v27, v0, v17
    buffer_load_dwordx4 v8, s[16:19], s56 offen offset:1024 lds
    v_mul_f32 v24, v24, v92
    v_mul_f32 v25, v25, v93
    v_mul_f32 v26, v26, v94
    v_mul_f32 v27, v27, v95
    v_exp_f32 v24, v24
    v_exp_f32 v25, v25
    v_exp_f32 v26, v26
    v_exp_f32 v27, v27
    v_fma_f32 v24, v24, v2, v2
    v_fma_f32 v25, v25, v2, v2
    v_fma_f32 v26, v26, v2, v2
    v_fma_f32 v27, v27, v2, v2
    v_rcp_f32 v24, v24
    v_rcp_f32 v25, v25
    buffer_load_dwordx4 v9, s[16:19], s56 offen offset:2048 lds
    v_rcp_f32 v26, v26
    v_rcp_f32 v27, v27
    v_mul_f32 v92, v92, v24
    v_mul_f32 v93, v93, v25
    v_mul_f32 v94, v94, v26
    v_mul_f32 v95, v95, v27
    v_add_f32 v18, v18, v92
    v_fmac_f32 v19, v92, v92
    v_add_f32 v18, v18, v93
    v_fmac_f32 v19, v93, v93
    v_add_f32 v18, v18, v94
    v_fmac_f32 v19, v94, v94
    v_add_f32 v18, v18, v95
    v_fmac_f32 v19, v95, v95
    v_cvt_pk_bf16_f32 v70, v92, v93
    v_cvt_pk_bf16_f32 v71, v94, v95
    s_waitcnt lgkmcnt(0)
    s_barrier
    s_setprio 1
    v_add_u32 v13, 0, v12
    ds_read_b64_tr_b16 v[40:41], v13 offset:0
    ds_read_b64_tr_b16 v[42:43], v13 offset:256
    ds_read_b64_tr_b16 v[44:45], v13 offset:1024
    ds_read_b64_tr_b16 v[46:47], v13 offset:1280
    ds_read_b64_tr_b16 v[48:49], v13 offset:2048
    ds_read_b64_tr_b16 v[50:51], v13 offset:2304
    s_waitcnt lgkmcnt(4)
    v_mfma_f32_32x32x16_bf16 v[80:95], v[40:43], v[96:99], 0
    ds_read_b64_tr_b16 v[52:53], v13 offset:3072
    ds_read_b64_tr_b16 v[54:55], v13 offset:3328
    s_waitcnt lgkmcnt(4)
    v_mfma_f32_32x32x16_bf16 v[80:95], v[44:47], v[100:103], v[80:95]
    ds_read_b64_tr_b16 v[40:41], v13 offset:4096
    ds_read_b64_tr_b16 v[42:43], v13 offset:4352
    s_waitcnt lgkmcnt(4)
    v_mfma_f32_32x32x16_bf16 v[80:95], v[48:51], v[104:107], v[80:95]
    ds_read_b64_tr_b16 v[44:45], v13 offset:5120
    ds_read_b64_tr_b16 v[46:47], v13 offset:5376
    s_waitcnt lgkmcnt(4)
    v_mfma_f32_32x32x16_bf16 v[80:95], v[52:55], v[108:111], v[80:95]
    ds_read_b64_tr_b16 v[48:49], v13 offset:6144
    ds_read_b64_tr_b16 v[50:51], v13 offset:6400
    s_waitcnt lgkmcnt(4)
    v_mfma_f32_32x32x16_bf16 v[80:95], v[40:43], v[112:115], v[80:95]
    ds_read_b64_tr_b16 v[52:53], v13 offset:7168
    ds_read_b64_tr_b16 v[54:55], v13 offset:7424
    s_waitcnt lgkmcnt(4)
    v_mfma_f32_32x32x16_bf16 v[80:95], v[44:47], v[116:119], v[80:95]
    ds_read_b64_tr_b16 v[40:41], v13 offset:8192
    ds_read_b64_tr_b16 v[42:43], v13 offset:8448
    s_waitcnt lgkmcnt(4)
    v_mfma_f32_32x32x16_bf16 v[80:95], v[48:51], v[120:123], v[80:95]
    ds_read_b64_tr_b16 v[44:45], v13 offset:9216
    ds_read_b64_tr_b16 v[46:47], v13 offset:9472
    s_waitcnt lgkmcnt(4)
    v_mfma_f32_32x32x16_bf16 v[80:95], v[52:55], v[124:127], v[80:95]
    ds_read_b64_tr_b16 v[48:49], v13 offset:10240
    ds_read_b64_tr_b16 v[50:51], v13 offset:10496
    s_waitcnt lgkmcnt(4)
    v_mfma_f32_32x32x16_bf16 v[80:95], v[40:43], v[128:131], v[80:95]
    ds_read_b64_tr_b16 v[52:53], v13 offset:11264
    ds_read_b64_tr_b16 v[54:55], v13 offset:11520
    s_waitcnt lgkmcnt(4)
    v_mfma_f32_32x32x16_bf16 v[80:95], v[44:47], v[132:135], v[80:95]
    ds_read_b64_tr_b16 v[40:41], v13 offset:12288
    ds_read_b64_tr_b16 v[42:43], v13 offset:12544
    s_waitcnt lgkmcnt(4)
    v_mfma_f32_32x32x16_bf16 v[80:95], v[48:51], v[136:139], v[80:95]
    ds_read_b64_tr_b16 v[44:45], v13 offset:13312
    ds_read_b64_tr_b16 v[46:47], v13 offset:13568
    s_waitcnt lgkmcnt(4)
    v_mfma_f32_32x32x16_bf16 v[80:95], v[52:55], v[140:143], v[80:95]
    ds_read_b64_tr_b16 v[48:49], v13 offset:14336
    ds_read_b64_tr_b16 v[50:51], v13 offset:14592
    s_waitcnt lgkmcnt(4)
    v_mfma_f32_32x32x16_bf16 v[80:95], v[40:43], v[144:147], v[80:95]
    ds_read_b64_tr_b16 v[52:53], v13 offset:15360
    ds_read_b64_tr_b16 v[54:55], v13 offset:15616
    s_waitcnt lgkmcnt(4)
    v_mfma_f32_32x32x16_bf16 v[80:95], v[44:47], v[148:151], v[80:95]
    ds_read_b64_tr_b16 v[40:41], v13 offset:16384
    ds_read_b64_tr_b16 v[42:43], v13 offset:16640
    s_waitcnt lgkmcnt(4)
    v_mfma_f32_32x32x16_bf16 v[80:95], v[48:51], v[152:155], v[80:95]
    ds_read_b64_tr_b16 v[44:45], v13 offset:17408
    ds_read_b64_tr_b16 v[46:47], v13 offset:17664
    s_waitcnt lgkmcnt(4)
    v_mfma_f32_32x32x16_bf16 v[80:95], v[52:55], v[156:159], v[80:95]
    ds_read_b64_tr_b16 v[48:49], v13 offset:18432
    ds_read_b64_tr_b16 v[50:51], v13 offset:18688
    s_waitcnt lgkmcnt(4)
    v_mfma_f32_32x32x16_bf16 v[80:95], v[40:43], v[160:163], v[80:95]
    ds_read_b64_tr_b16 v[52:53], v13 offset:19456
    ds_read_b64_tr_b16 v[54:55], v13 offset:19712
    s_waitcnt lgkmcnt(4)
    v_mfma_f32_32x32x16_bf16 v[80:95], v[44:47], v[164:167], v[80:95]
    ds_read_b64_tr_b16 v[40:41], v13 offset:20480
    ds_read_b64_tr_b16 v[42:43], v13 offset:20736
    s_waitcnt lgkmcnt(4)
    v_mfma_f32_32x32x16_bf16 v[80:95], v[48:51], v[168:171], v[80:95]
    ds_read_b64_tr_b16 v[44:45], v13 offset:21504
    ds_read_b64_tr_b16 v[46:47], v13 offset:21760
    s_waitcnt lgkmcnt(4)
    v_mfma_f32_32x32x16_bf16 v[80:95], v[52:55], v[172:175], v[80:95]
    ds_read_b64_tr_b16 v[48:49], v13 offset:22528
    ds_read_b64_tr_b16 v[50:51], v13 offset:22784
    s_waitcnt lgkmcnt(4)
    v_mfma_f32_32x32x16_bf16 v[80:95], v[40:43], v[176:179], v[80:95]
    ds_read_b64_tr_b16 v[52:53], v13 offset:23552
    ds_read_b64_tr_b16 v[54:55], v13 offset:23808
    s_waitcnt lgkmcnt(4)
    v_mfma_f32_32x32x16_bf16 v[80:95], v[44:47], v[180:183], v[80:95]
    ds_read_b64_tr_b16 v[40:41], v13 offset:24576
    ds_read_b64_tr_b16 v[42:43], v13 offset:24832
    s_waitcnt lgkmcnt(4)
    v_mfma_f32_32x32x16_bf16 v[80:95], v[48:51], v[184:187], v[80:95]
    ds_read_b64_tr_b16 v[44:45], v13 offset:25600
    ds_read_b64_tr_b16 v[46:47], v13 offset:25856
    s_waitcnt lgkmcnt(4)
    v_mfma_f32_32x32x16_bf16 v[80:95], v[52:55], v[188:191], v[80:95]
    ds_read_b64_tr_b16 v[48:49], v13 offset:26624
    ds_read_b64_tr_b16 v[50:51], v13 offset:26880
    s_waitcnt lgkmcnt(4)
    v_mfma_f32_32x32x16_bf16 v[80:95], v[40:43], v[192:195], v[80:95]
    ds_read_b64_tr_b16 v[52:53], v13 offset:27648
    ds_read_b64_tr_b16 v[54:55], v13 offset:27904
    s_waitcnt lgkmcnt(4)
    v_mfma_f32_32x32x16_bf16 v[80:95], v[44:47], v[196:199], v[80:95]
    ds_read_b64_tr_b16 v[40:41], v13 offset:28672
    ds_read_b64_tr_b16 v[42:43], v13 offset:28928
    s_waitcnt lgkmcnt(4)
    v_mfma_f32_32x32x16_bf16 v[80:95], v[48:51], v[200:203], v[80:95]
    ds_read_b64_tr_b16 v[44:45], v13 offset:29696
    ds_read_b64_tr_b16 v[46:47], v13 offset:29952
    s_waitcnt lgkmcnt(4)
    v_mfma_f32_32x32x16_bf16 v[80:95], v[52:55], v[204:207], v[80:95]
    ds_read_b64_tr_b16 v[48:49], v13 offset:30720
    ds_read_b64_tr_b16 v[50:51], v13 offset:30976
    s_waitcnt lgkmcnt(4)
    v_mfma_f32_32x32x16_bf16 v[80:95], v[40:43], v[208:211], v[80:95]
    ds_read_b64_tr_b16 v[52:53], v13 offset:31744
    ds_read_b64_tr_b16 v[54:55], v13 offset:32000
    s_waitcnt lgkmcnt(4)
    v_mfma_f32_32x32x16_bf16 v[80:95], v[44:47], v[212:215], v[80:95]
    ds_read_b64_tr_b16 v[40:41], v13 offset:32768
    ds_read_b64_tr_b16 v[42:43], v13 offset:33024
    s_waitcnt lgkmcnt(4)
    v_mfma_f32_32x32x16_bf16 v[80:95], v[48:51], v[216:219], v[80:95]
    ds_read_b64_tr_b16 v[44:45], v13 offset:33792
    ds_read_b64_tr_b16 v[46:47], v13 offset:34048
    s_waitcnt lgkmcnt(4)
    v_mfma_f32_32x32x16_bf16 v[80:95], v[52:55], v[220:223], v[80:95]
    ds_read_b64_tr_b16 v[48:49], v13 offset:34816
    ds_read_b64_tr_b16 v[50:51], v13 offset:35072
    s_waitcnt lgkmcnt(4)
    v_mfma_f32_32x32x16_bf16 v[80:95], v[40:43], v[224:227], v[80:95]
    ds_read_b64_tr_b16 v[52:53], v13 offset:35840
    ds_read_b64_tr_b16 v[54:55], v13 offset:36096
    s_waitcnt vmcnt(0) lgkmcnt(0)
    s_barrier
    v_mfma_f32_32x32x16_bf16 v[80:95], v[44:47], v[228:231], v[80:95]
    v_mfma_f32_32x32x16_bf16 v[80:95], v[48:51], v[232:235], v[80:95]
    v_mfma_f32_32x32x16_bf16 v[80:95], v[52:55], v[236:239], v[80:95]
    s_setprio 0
    s_bitcmp1_b32 s42, 0
    s_cbranch_scc1 L1_feb
    s_nop 10
    v_mul_f32 v20, v80, v80
    v_mul_f32 v21, v81, v81
    v_mul_f32 v22, v82, v82
    v_mul_f32 v23, v83, v83
    v_fma_f32 v20, v20, v0, v17
    v_fma_f32 v21, v21, v0, v17
    v_fma_f32 v22, v22, v0, v17
    v_fma_f32 v23, v23, v0, v17
    v_mul_f32 v20, v20, v80
    v_mul_f32 v21, v21, v81
    v_mul_f32 v22, v22, v82
    v_mul_f32 v23, v23, v83
    v_exp_f32 v20, v20
    v_exp_f32 v21, v21
    v_exp_f32 v22, v22
    v_exp_f32 v23, v23
    v_fma_f32 v20, v20, v2, v2
    v_fma_f32 v21, v21, v2, v2
    s_mul_i32 s56, s46, 248832
    s_add_u32 s56, s56, s70
    s_add_u32 m0, s53, 110592
    s_add_u32 s56, s56, 128
    buffer_load_dwordx4 v7, s[16:19], s56 offen offset:0 lds
    v_fma_f32 v22, v22, v2, v2
    v_fma_f32 v23, v23, v2, v2
    v_rcp_f32 v20, v20
    v_rcp_f32 v21, v21
    v_rcp_f32 v22, v22
    v_rcp_f32 v23, v23
    v_mul_f32 v80, v80, v20
    v_mul_f32 v81, v81, v21
    v_mul_f32 v82, v82, v22
    v_mul_f32 v83, v83, v23
    v_add_f32 v18, v18, v80
    v_fmac_f32 v19, v80, v80
    v_add_f32 v18, v18, v81
    buffer_load_dwordx4 v8, s[16:19], s56 offen offset:1024 lds
    v_fmac_f32 v19, v81, v81
    v_add_f32 v18, v18, v82
    v_fmac_f32 v19, v82, v82
    v_add_f32 v18, v18, v83
    v_fmac_f32 v19, v83, v83
    v_cvt_pk_bf16_f32 v72, v80, v81
    v_cvt_pk_bf16_f32 v73, v82, v83
    s_barrier
    v_mul_f32 v24, v84, v84
    v_mul_f32 v25, v85, v85
    v_mul_f32 v26, v86, v86
    v_mul_f32 v27, v87, v87
    v_fma_f32 v24, v24, v0, v17
    v_fma_f32 v25, v25, v0, v17
    buffer_load_dwordx4 v9, s[16:19], s56 offen offset:2048 lds
    v_fma_f32 v26, v26, v0, v17
    v_fma_f32 v27, v27, v0, v17
    v_mul_f32 v24, v24, v84
    v_mul_f32 v25, v25, v85
    v_mul_f32 v26, v26, v86
    v_mul_f32 v27, v27, v87
    v_exp_f32 v24, v24
    v_exp_f32 v25, v25
    v_exp_f32 v26, v26
    v_exp_f32 v27, v27
    v_fma_f32 v24, v24, v2, v2
    v_fma_f32 v25, v25, v2, v2
    v_fma_f32 v26, v26, v2, v2
    v_fma_f32 v27, v27, v2, v2
    s_add_u32 m0, s53, 113664
    s_add_u32 s56, s56, 82944
    buffer_load_dwordx4 v7, s[16:19], s56 offen offset:0 lds
    v_rcp_f32 v24, v24
    v_rcp_f32 v25, v25
    v_rcp_f32 v26, v26
    v_rcp_f32 v27, v27
    v_mul_f32 v84, v84, v24
    v_mul_f32 v85, v85, v25
    v_mul_f32 v86, v86, v26
    v_mul_f32 v87, v87, v27
    v_add_f32 v18, v18, v84
    v_fmac_f32 v19, v84, v84
    v_add_f32 v18, v18, v85
    v_fmac_f32 v19, v85, v85
    v_add_f32 v18, v18, v86
    buffer_load_dwordx4 v8, s[16:19], s56 offen offset:1024 lds
    v_fmac_f32 v19, v86, v86
    v_add_f32 v18, v18, v87
    v_fmac_f32 v19, v87, v87
    v_cvt_pk_bf16_f32 v74, v84, v85
    v_cvt_pk_bf16_f32 v75, v86, v87
    v_mul_f32 v20, v88, v88
    v_mul_f32 v21, v89, v89
    v_mul_f32 v22, v90, v90
    v_mul_f32 v23, v91, v91
    v_fma_f32 v20, v20, v0, v17
    v_fma_f32 v21, v21, v0, v17
    v_fma_f32 v22, v22, v0, v17
    v_fma_f32 v23, v23, v0, v17
    buffer_load_dwordx4 v9, s[16:19], s56 offen offset:2048 lds
    v_mul_f32 v20, v20, v88
    v_mul_f32 v21, v21, v89
    v_mul_f32 v22, v22, v90
    v_mul_f32 v23, v23, v91
    v_exp_f32 v20, v20
    v_exp_f32 v21, v21
    v_exp_f32 v22, v22
    v_exp_f32 v23, v23
    v_fma_f32 v20, v20, v2, v2
    v_fma_f32 v21, v21, v2, v2
    v_fma_f32 v22, v22, v2, v2
    v_fma_f32 v23, v23, v2, v2
    v_rcp_f32 v20, v20
    v_rcp_f32 v21, v21
    s_add_u32 m0, s53, 116736
    s_add_u32 s56, s56, 82944
    buffer_load_dwordx4 v7, s[16:19], s56 offen offset:0 lds
    v_rcp_f32 v22, v22
    v_rcp_f32 v23, v23
    v_mul_f32 v88, v88, v20
    v_mul_f32 v89, v89, v21
    v_mul_f32 v90, v90, v22
    v_mul_f32 v91, v91, v23
    v_add_f32 v18, v18, v88
    v_fmac_f32 v19, v88, v88
    v_add_f32 v18, v18, v89
    v_fmac_f32 v19, v89, v89
    v_add_f32 v18, v18, v90
    v_fmac_f32 v19, v90, v90
    v_add_f32 v18, v18, v91
    buffer_load_dwordx4 v8, s[16:19], s56 offen offset:1024 lds
    v_fmac_f32 v19, v91, v91
    v_cvt_pk_bf16_f32 v76, v88, v89
    v_cvt_pk_bf16_f32 v77, v90, v91
    v_mul_f32 v24, v92, v92
    v_mul_f32 v25, v93, v93
    v_mul_f32 v26, v94, v94
    v_mul_f32 v27, v95, v95
    v_fma_f32 v24, v24, v0, v17
    v_fma_f32 v25, v25, v0, v17
    v_fma_f32 v26, v26, v0, v17
    v_fma_f32 v27, v27, v0, v17
    v_mul_f32 v24, v24, v92
    v_mul_f32 v25, v25, v93
    buffer_load_dwordx4 v9, s[16:19], s56 offen offset:2048 lds
    v_mul_f32 v26, v26, v94
    v_mul_f32 v27, v27, v95
    v_exp_f32 v24, v24
    v_exp_f32 v25, v25
    v_exp_f32 v26, v26
    v_exp_f32 v27, v27
    v_fma_f32 v24, v24, v2, v2
    v_fma_f32 v25, v25, v2, v2
    v_fma_f32 v26, v26, v2, v2
    v_fma_f32 v27, v27, v2, v2
    v_rcp_f32 v24, v24
    v_rcp_f32 v25, v25
    v_rcp_f32 v26, v26
    s_mul_i32 s43, s51, 32
    s_lshr_b32 s43, s43, 6
    s_add_u32 s43, s43, 32
    s_min_u32 s43, s43, 1696
    v_lshrrev_b32 v36, 5, v1
    v_lshlrev_b32 v36, 4, v36
    v_add_u32 v36, s43, v36
    global_load_dwordx4 v[36:39], v36, s[54:55]
    v_rcp_f32 v27, v27
    v_mul_f32 v92, v92, v24
    v_mul_f32 v93, v93, v25
    v_mul_f32 v94, v94, v26
    v_mul_f32 v95, v95, v27
    v_add_f32 v18, v18, v92
    v_fmac_f32 v19, v92, v92
    v_add_f32 v18, v18, v93
    v_fmac_f32 v19, v93, v93
    v_add_f32 v18, v18, v94
    v_fmac_f32 v19, v94, v94
    v_add_f32 v18, v18, v95
    v_fmac_f32 v19, v95, v95
    v_cvt_pk_bf16_f32 v78, v92, v93
    v_cvt_pk_bf16_f32 v79, v94, v95
    v_mov_b32 v20, v18
    v_mov_b32 v21, v19
    v_and_b32 v22, 31, v1
    v_lshlrev_b32 v22, 3, v22
    v_permlane32_swap_b32 v20, v18
    v_permlane32_swap_b32 v21, v19
    s_lshl_b32 s43, s46, 8
    s_add_u32 s43, s43, 147456
    v_add_u32 v22, s43, v22
    v_add_f32 v20, v20, v18
    v_add_f32 v21, v21, v19
    ds_write_b64 v22, v[20:21]
    s_waitcnt lgkmcnt(0)
    s_barrier
    s_branch L1_fee
L1_feb:
    s_nop 10
    v_mul_f32 v20, v80, v80
    v_mul_f32 v21, v81, v81
    v_mul_f32 v22, v82, v82
    v_mul_f32 v23, v83, v83
    v_fma_f32 v20, v20, v0, v17
    v_fma_f32 v21, v21, v0, v17
    v_fma_f32 v22, v22, v0, v17
    v_fma_f32 v23, v23, v0, v17
    v_mul_f32 v20, v20, v80
    v_mul_f32 v21, v21, v81
    v_mul_f32 v22, v22, v82
    v_mul_f32 v23, v23, v83
    v_exp_f32 v20, v20
    v_exp_f32 v21, v21
    v_exp_f32 v22, v22
    s_mul_i32 s56, s46, 248832
    s_add_u32 s56, s56, s70
    s_add_u32 m0, s53, 110592
    s_add_u32 s56, s56, 128
    buffer_load_dwordx4 v7, s[16:19], s56 offen offset:0 lds
    v_exp_f32 v23, v23
    v_fma_f32 v20, v20, v2, v2
    v_fma_f32 v21, v21, v2, v2
    v_fma_f32 v22, v22, v2, v2
    v_fma_f32 v23, v23, v2, v2
    v_rcp_f32 v20, v20
    v_rcp_f32 v21, v21
    v_rcp_f32 v22, v22
    v_rcp_f32 v23, v23
    v_mul_f32 v80, v80, v20
    v_mul_f32 v81, v81, v21
    buffer_load_dwordx4 v8, s[16:19], s56 offen offset:1024 lds
    v_mul_f32 v82, v82, v22
    v_mul_f32 v83, v83, v23
    v_cvt_pk_bf16_f32 v28, v80, v81
    v_cvt_pk_bf16_f32 v29, v82, v83
    v_mul_f32 v24, v88, v88
    s_barrier
    v_mul_f32 v25, v89, v89
    v_mul_f32 v26, v90, v90
    v_mul_f32 v27, v91, v91
    v_fma_f32 v24, v24, v0, v17
    v_fma_f32 v25, v25, v0, v17
    buffer_load_dwordx4 v9, s[16:19], s56 offen offset:2048 lds
    v_fma_f32 v26, v26, v0, v17
    v_fma_f32 v27, v27, v0, v17
    v_mul_f32 v24, v24, v88
    v_mul_f32 v25, v25, v89
    v_mul_f32 v26, v26, v90
    v_mul_f32 v27, v27, v91
    v_exp_f32 v24, v24
    v_exp_f32 v25, v25
    v_exp_f32 v26, v26
    v_exp_f32 v27, v27
    v_fma_f32 v24, v24, v2, v2
    s_add_u32 m0, s53, 113664
    s_add_u32 s56, s56, 82944
    buffer_load_dwordx4 v7, s[16:19], s56 offen offset:0 lds
    v_fma_f32 v25, v25, v2, v2
    v_fma_f32 v26, v26, v2, v2
    v_fma_f32 v27, v27, v2, v2
    v_rcp_f32 v24, v24
    v_rcp_f32 v25, v25
    v_rcp_f32 v26, v26
    v_rcp_f32 v27, v27
    v_mul_f32 v88, v88, v24
    v_mul_f32 v89, v89, v25
    v_mul_f32 v90, v90, v26
    buffer_load_dwordx4 v8, s[16:19], s56 offen offset:1024 lds
    v_mul_f32 v91, v91, v27
    v_cvt_pk_bf16_f32 v30, v88, v89
    v_cvt_pk_bf16_f32 v31, v90, v91
    buffer_store_dwordx4 v[28:31], v15, s[20:23], s66 offen offset:0 sc1
    v_mul_f32 v20, v84, v84
    v_mul_f32 v21, v85, v85
    v_mul_f32 v22, v86, v86
    v_mul_f32 v23, v87, v87
    v_fma_f32 v20, v20, v0, v17
    v_fma_f32 v21, v21, v0, v17
    v_fma_f32 v22, v22, v0, v17
    buffer_load_dwordx4 v9, s[16:19], s56 offen offset:2048 lds
    v_fma_f32 v23, v23, v0, v17
    v_mul_f32 v20, v20, v84
    v_mul_f32 v21, v21, v85
    v_mul_f32 v22, v22, v86
    v_mul_f32 v23, v23, v87
    v_exp_f32 v20, v20
    v_exp_f32 v21, v21
    v_exp_f32 v22, v22
    v_exp_f32 v23, v23
    v_fma_f32 v20, v20, v2, v2
    v_fma_f32 v21, v21, v2, v2
    s_add_u32 m0, s53, 116736
    s_add_u32 s56, s56, 82944
    buffer_load_dwordx4 v7, s[16:19], s56 offen offset:0 lds
    v_fma_f32 v22, v22, v2, v2
    v_fma_f32 v23, v23, v2, v2
    v_rcp_f32 v20, v20
    v_rcp_f32 v21, v21
    v_rcp_f32 v22, v22
    v_rcp_f32 v23, v23
    v_mul_f32 v84, v84, v20
    v_mul_f32 v85, v85, v21
    v_mul_f32 v86, v86, v22
    v_mul_f32 v87, v87, v23
    buffer_load_dwordx4 v8, s[16:19], s56 offen offset:1024 lds
    v_cvt_pk_bf16_f32 v32, v84, v85
    v_cvt_pk_bf16_f32 v33, v86, v87
    v_mul_f32 v24, v92, v92
    v_mul_f32 v25, v93, v93
    v_mul_f32 v26, v94, v94
    v_mul_f32 v27, v95, v95
    v_fma_f32 v24, v24, v0, v17
    v_fma_f32 v25, v25, v0, v17
    v_fma_f32 v26, v26, v0, v17
    v_fma_f32 v27, v27, v0, v17
    v_mul_f32 v24, v24, v92
    buffer_load_dwordx4 v9, s[16:19], s56 offen offset:2048 lds
    v_mul_f32 v25, v25, v93
    v_mul_f32 v26, v26, v94
    v_mul_f32 v27, v27, v95
    v_exp_f32 v24, v24
    v_exp_f32 v25, v25
    v_exp_f32 v26, v26
    v_exp_f32 v27, v27
    v_fma_f32 v24, v24, v2, v2
    v_fma_f32 v25, v25, v2, v2
    v_fma_f32 v26, v26, v2, v2
    s_mul_i32 s43, s51, 32
    s_lshr_b32 s43, s43, 6
    s_add_u32 s43, s43, 32
    s_min_u32 s43, s43, 1696
    v_lshrrev_b32 v36, 5, v1
    v_lshlrev_b32 v36, 4, v36
    v_add_u32 v36, s43, v36
    global_load_dwordx4 v[36:39], v36, s[54:55]
    v_fma_f32 v27, v27, v2, v2
    v_rcp_f32 v24, v24
    v_rcp_f32 v25, v25
    v_rcp_f32 v26, v26
    v_rcp_f32 v27, v27
    v_mul_f32 v92, v92, v24
    v_mul_f32 v93, v93, v25
    v_mul_f32 v94, v94, v26
    v_mul_f32 v95, v95, v27
    v_cvt_pk_bf16_f32 v34, v92, v93
    v_cvt_pk_bf16_f32 v35, v94, v95
    buffer_store_dwordx4 v[32:35], v15, s[20:23], s66 offen offset:512 sc1
    v_mov_b32 v20, v18
    v_mov_b32 v21, v19
    v_and_b32 v22, 31, v1
    v_lshlrev_b32 v22, 3, v22
    v_permlane32_swap_b32 v20, v18
    v_permlane32_swap_b32 v21, v19
    s_lshl_b32 s43, s46, 8
    s_add_u32 s43, s43, 147456
    v_add_u32 v22, s43, v22
    v_add_f32 v20, v20, v18
    v_add_f32 v21, v21, v19
    ds_write_b64 v22, v[20:21]
    s_waitcnt lgkmcnt(0)
    s_barrier
L1_fee:
    s_nop 1
    s_setprio 1
    v_add_u32 v13, 36864, v10
    ds_read_b64_tr_b16 v[40:41], v13 offset:0
    ds_read_b64_tr_b16 v[42:43], v13 offset:512
    ds_read_b64_tr_b16 v[44:45], v13 offset:2048
    ds_read_b64_tr_b16 v[46:47], v13 offset:2560
    ds_read_b64_tr_b16 v[48:49], v13 offset:4096
    ds_read_b64_tr_b16 v[50:51], v13 offset:4608
    s_waitcnt lgkmcnt(4)
    v_mfma_f32_32x32x16_bf16 v[80:95], v[40:43], v[96:99], 0
    ds_read_b64_tr_b16 v[52:53], v13 offset:6144
    ds_read_b64_tr_b16 v[54:55], v13 offset:6656
    s_waitcnt lgkmcnt(4)
    v_mfma_f32_32x32x16_bf16 v[80:95], v[44:47], v[100:103], v[80:95]
    ds_read_b64_tr_b16 v[40:41], v13 offset:8192
    ds_read_b64_tr_b16 v[42:43], v13 offset:8704
    s_waitcnt lgkmcnt(4)
    v_mfma_f32_32x32x16_bf16 v[80:95], v[48:51], v[104:107], v[80:95]
    ds_read_b64_tr_b16 v[44:45], v13 offset:10240
    ds_read_b64_tr_b16 v[46:47], v13 offset:10752
    s_waitcnt lgkmcnt(4)
    v_mfma_f32_32x32x16_bf16 v[80:95], v[52:55], v[108:111], v[80:95]
    ds_read_b64_tr_b16 v[48:49], v13 offset:12288
    ds_read_b64_tr_b16 v[50:51], v13 offset:12800
    s_waitcnt lgkmcnt(4)
    v_mfma_f32_32x32x16_bf16 v[80:95], v[40:43], v[112:115], v[80:95]
    ds_read_b64_tr_b16 v[52:53], v13 offset:14336
    ds_read_b64_tr_b16 v[54:55], v13 offset:14848
    s_waitcnt lgkmcnt(4)
    v_mfma_f32_32x32x16_bf16 v[80:95], v[44:47], v[116:119], v[80:95]
    ds_read_b64_tr_b16 v[40:41], v13 offset:16384
    ds_read_b64_tr_b16 v[42:43], v13 offset:16896
    s_waitcnt lgkmcnt(4)
    v_mfma_f32_32x32x16_bf16 v[80:95], v[48:51], v[120:123], v[80:95]
    ds_read_b64_tr_b16 v[44:45], v13 offset:18432
    ds_read_b64_tr_b16 v[46:47], v13 offset:18944
    s_waitcnt lgkmcnt(4)
    v_mfma_f32_32x32x16_bf16 v[80:95], v[52:55], v[124:127], v[80:95]
    ds_read_b64_tr_b16 v[48:49], v13 offset:20480
    ds_read_b64_tr_b16 v[50:51], v13 offset:20992
    s_waitcnt lgkmcnt(4)
    v_mfma_f32_32x32x16_bf16 v[80:95], v[40:43], v[128:131], v[80:95]
    ds_read_b64_tr_b16 v[52:53], v13 offset:22528
    ds_read_b64_tr_b16 v[54:55], v13 offset:23040
    s_waitcnt lgkmcnt(4)
    v_mfma_f32_32x32x16_bf16 v[80:95], v[44:47], v[132:135], v[80:95]
    ds_read_b64_tr_b16 v[40:41], v13 offset:24576
    ds_read_b64_tr_b16 v[42:43], v13 offset:25088
    s_waitcnt lgkmcnt(4)
    v_mfma_f32_32x32x16_bf16 v[80:95], v[48:51], v[136:139], v[80:95]
    ds_read_b64_tr_b16 v[44:45], v13 offset:26624
    ds_read_b64_tr_b16 v[46:47], v13 offset:27136
    s_waitcnt lgkmcnt(4)
    v_mfma_f32_32x32x16_bf16 v[80:95], v[52:55], v[140:143], v[80:95]
    ds_read_b64_tr_b16 v[48:49], v13 offset:28672
    ds_read_b64_tr_b16 v[50:51], v13 offset:29184
    s_waitcnt lgkmcnt(4)
    v_mfma_f32_32x32x16_bf16 v[80:95], v[40:43], v[144:147], v[80:95]
    ds_read_b64_tr_b16 v[52:53], v13 offset:30720
    ds_read_b64_tr_b16 v[54:55], v13 offset:31232
    s_waitcnt lgkmcnt(4)
    v_mfma_f32_32x32x16_bf16 v[80:95], v[44:47], v[148:151], v[80:95]
    ds_read_b64_tr_b16 v[40:41], v13 offset:32768
    ds_read_b64_tr_b16 v[42:43], v13 offset:33280
    s_waitcnt lgkmcnt(4)
    v_mfma_f32_32x32x16_bf16 v[80:95], v[48:51], v[152:155], v[80:95]
    ds_read_b64_tr_b16 v[44:45], v13 offset:34816
    ds_read_b64_tr_b16 v[46:47], v13 offset:35328
    s_waitcnt lgkmcnt(4)
    v_mfma_f32_32x32x16_bf16 v[80:95], v[52:55], v[156:159], v[80:95]
    v_add_u32 v13, 73728, v10
    ds_read_b64_tr_b16 v[48:49], v13 offset:0
    ds_read_b64_tr_b16 v[50:51], v13 offset:512
    s_waitcnt lgkmcnt(4)
    v_mfma_f32_32x32x16_bf16 v[80:95], v[40:43], v[160:163], v[80:95]
    ds_read_b64_tr_b16 v[52:53], v13 offset:2048
    ds_read_b64_tr_b16 v[54:55], v13 offset:2560
    s_waitcnt lgkmcnt(4)
    v_mfma_f32_32x32x16_bf16 v[80:95], v[44:47], v[164:167], v[80:95]
    ds_read_b64_tr_b16 v[40:41], v13 offset:4096
    ds_read_b64_tr_b16 v[42:43], v13 offset:4608
    s_waitcnt lgkmcnt(4)
    v_mfma_f32_32x32x16_bf16 v[80:95], v[48:51], v[168:171], v[80:95]
    ds_read_b64_tr_b16 v[44:45], v13 offset:6144
    ds_read_b64_tr_b16 v[46:47], v13 offset:6656
    s_waitcnt lgkmcnt(4)
    v_mfma_f32_32x32x16_bf16 v[80:95], v[52:55], v[172:175], v[80:95]
    ds_read_b64_tr_b16 v[48:49], v13 offset:8192
    ds_read_b64_tr_b16 v[50:51], v13 offset:8704
    s_waitcnt lgkmcnt(4)
    v_mfma_f32_32x32x16_bf16 v[80:95], v[40:43], v[176:179], v[80:95]
    ds_read_b64_tr_b16 v[52:53], v13 offset:10240
    ds_read_b64_tr_b16 v[54:55], v13 offset:10752
    s_waitcnt lgkmcnt(4)
    v_mfma_f32_32x32x16_bf16 v[80:95], v[44:47], v[180:183], v[80:95]
    ds_read_b64_tr_b16 v[40:41], v13 offset:12288
    ds_read_b64_tr_b16 v[42:43], v13 offset:12800
    s_waitcnt lgkmcnt(4)
    v_mfma_f32_32x32x16_bf16 v[80:95], v[48:51], v[184:187], v[80:95]
    ds_read_b64_tr_b16 v[44:45], v13 offset:14336
    ds_read_b64_tr_b16 v[46:47], v13 offset:14848
    s_waitcnt lgkmcnt(4)
    v_mfma_f32_32x32x16_bf16 v[80:95], v[52:55], v[188:191], v[80:95]
    ds_read_b64_tr_b16 v[48:49], v13 offset:16384
    ds_read_b64_tr_b16 v[50:51], v13 offset:16896
    s_waitcnt lgkmcnt(4)
    v_mfma_f32_32x32x16_bf16 v[80:95], v[40:43], v[192:195], v[80:95]
    ds_read_b64_tr_b16 v[52:53], v13 offset:18432
    ds_read_b64_tr_b16 v[54:55], v13 offset:18944
    s_waitcnt lgkmcnt(4)
    v_mfma_f32_32x32x16_bf16 v[80:95], v[44:47], v[196:199], v[80:95]
    ds_read_b64_tr_b16 v[40:41], v13 offset:20480
    ds_read_b64_tr_b16 v[42:43], v13 offset:20992
    s_waitcnt lgkmcnt(4)
    v_mfma_f32_32x32x16_bf16 v[80:95], v[48:51], v[200:203], v[80:95]
    ds_read_b64_tr_b16 v[44:45], v13 offset:22528
    ds_read_b64_tr_b16 v[46:47], v13 offset:23040
    s_waitcnt lgkmcnt(4)
    v_mfma_f32_32x32x16_bf16 v[80:95], v[52:55], v[204:207], v[80:95]
    ds_read_b64_tr_b16 v[48:49], v13 offset:24576
    ds_read_b64_tr_b16 v[50:51], v13 offset:25088
    s_waitcnt lgkmcnt(4)
    v_mfma_f32_32x32x16_bf16 v[80:95], v[40:43], v[208:211], v[80:95]
    ds_read_b64_tr_b16 v[52:53], v13 offset:26624
    ds_read_b64_tr_b16 v[54:55], v13 offset:27136
    s_waitcnt lgkmcnt(4)
    v_mfma_f32_32x32x16_bf16 v[80:95], v[44:47], v[212:215], v[80:95]
    ds_read_b64_tr_b16 v[40:41], v13 offset:28672
    ds_read_b64_tr_b16 v[42:43], v13 offset:29184
    s_waitcnt lgkmcnt(4)
    v_mfma_f32_32x32x16_bf16 v[80:95], v[48:51], v[216:219], v[80:95]
    ds_read_b64_tr_b16 v[44:45], v13 offset:30720
    ds_read_b64_tr_b16 v[46:47], v13 offset:31232
    s_waitcnt lgkmcnt(4)
    v_mfma_f32_32x32x16_bf16 v[80:95], v[52:55], v[220:223], v[80:95]
    ds_read_b64_tr_b16 v[48:49], v13 offset:32768
    ds_read_b64_tr_b16 v[50:51], v13 offset:33280
    s_waitcnt lgkmcnt(4)
    v_mfma_f32_32x32x16_bf16 v[80:95], v[40:43], v[224:227], v[80:95]
    ds_read_b64_tr_b16 v[52:53], v13 offset:34816
    ds_read_b64_tr_b16 v[54:55], v13 offset:35328
    s_waitcnt vmcnt(1) lgkmcnt(0)
    s_barrier
    v_mfma_f32_32x32x16_bf16 v[80:95], v[44:47], v[228:231], v[80:95]
    v_mfma_f32_32x32x16_bf16 v[80:95], v[48:51], v[232:235], v[80:95]
    v_mfma_f32_32x32x16_bf16 v[80:95], v[52:55], v[236:239], v[80:95]
    s_setprio 0
    s_mul_i32 s56, s46, 663552
    s_add_u32 s56, s56, s50
    s_add_u32 m0, s53, 36864
    s_add_u32 s56, s56, 0
    buffer_load_dwordx4 v4, s[12:15], s56 offen offset:0 lds
    buffer_load_dwordx4 v5, s[12:15], s56 offen offset:1024 lds
    buffer_load_dwordx4 v6, s[12:15], s56 offen offset:2048 lds
    s_add_u32 m0, s53, 39936
    s_add_u32 s56, s56, 221184
    buffer_load_dwordx4 v4, s[12:15], s56 offen offset:0 lds
    buffer_load_dwordx4 v5, s[12:15], s56 offen offset:1024 lds
    buffer_load_dwordx4 v6, s[12:15], s56 offen offset:2048 lds
    s_add_u32 m0, s53, 43008
    s_add_u32 s56, s56, 221184
    buffer_load_dwordx4 v4, s[12:15], s56 offen offset:0 lds
    buffer_load_dwordx4 v5, s[12:15], s56 offen offset:1024 lds
    buffer_load_dwordx4 v6, s[12:15], s56 offen offset:2048 lds
    s_cmp_lg_u32 s40, 0
    s_cbranch_scc1 L1_nonx
    s_lshr_b32 s43, s2, 3
    s_mul_i32 s43, s43, 1024
    s_add_u32 s43, s43, L1_codeend-k1_proj_kernel
    v_lshlrev_b32 v246, 7, v1
    v_add_u32 v246, s43, v246
    v_min_u32 v246, L2_codeend-k1_proj_kernel-4, v246
    s_mov_b64 exec, 0xff
    global_load_dword v3, v246, s[38:39]
    s_mov_b64 exec, -1
L1_nonx:
    s_barrier
    s_add_u32 s43, s51, 64
    s_cmp_lt_u32 s43, 1152
    s_cselect_b32 s43, 0xbe173fd8, s52
    s_waitcnt vmcnt(9)
    v_mul_f32 v32, s43, v17
    v_add_u32 v28, v16, v36
    v_add_u32 v29, v16, v37
    v_add_u32 v30, v16, v38
    v_add_u32 v31, v16, v39
    s_mul_i32 s43, s51, 32
    s_lshr_b32 s43, s43, 6
    s_add_u32 s43, s43, 96
    s_min_u32 s43, s43, 1696
    v_lshrrev_b32 v36, 5, v1
    v_lshlrev_b32 v36, 4, v36
    v_add_u32 v36, s43, v36
    global_load_dwordx4 v[36:39], v36, s[54:55]
    v_mul_f32 v80, v32, v80
    v_mul_f32 v81, v32, v81
    v_mul_f32 v82, v32, v82
    v_mul_f32 v83, v32, v83
    v_cvt_pk_bf16_f32 v20, v80, v81
    v_cvt_pk_bf16_f32 v21, v82, v83
    buffer_store_dwordx2 v[20:21], v28, s[20:23], 0 offen sc1
    v_mul_f32 v84, v32, v84
    v_mul_f32 v85, v32, v85
    v_mul_f32 v86, v32, v86
    v_mul_f32 v87, v32, v87
    v_cvt_pk_bf16_f32 v22, v84, v85
    v_cvt_pk_bf16_f32 v23, v86, v87
    buffer_store_dwordx2 v[22:23], v29, s[20:23], 0 offen sc1
    v_mul_f32 v88, v32, v88
    v_mul_f32 v89, v32, v89
    v_mul_f32 v90, v32, v90
    v_mul_f32 v91, v32, v91
    v_cvt_pk_bf16_f32 v24, v88, v89
    v_cvt_pk_bf16_f32 v25, v90, v91
    buffer_store_dwordx2 v[24:25], v30, s[20:23], 0 offen sc1
    v_mul_f32 v92, v32, v92
    v_mul_f32 v93, v32, v93
    v_mul_f32 v94, v32, v94
    v_mul_f32 v95, v32, v95
    v_cvt_pk_bf16_f32 v26, v92, v93
    v_cvt_pk_bf16_f32 v27, v94, v95
    buffer_store_dwordx2 v[26:27], v31, s[20:23], 0 offen sc1
    s_waitcnt lgkmcnt(0)
    s_barrier
    s_setprio 1
    v_add_u32 v13, 110592, v10
    ds_read_b64_tr_b16 v[40:41], v13 offset:0
    ds_read_b64_tr_b16 v[42:43], v13 offset:512
    ds_read_b64_tr_b16 v[44:45], v13 offset:2048
    ds_read_b64_tr_b16 v[46:47], v13 offset:2560
    ds_read_b64_tr_b16 v[48:49], v13 offset:4096
    ds_read_b64_tr_b16 v[50:51], v13 offset:4608
    s_waitcnt lgkmcnt(4)
    v_mfma_f32_32x32x16_bf16 v[80:95], v[40:43], v[96:99], 0
    ds_read_b64_tr_b16 v[52:53], v13 offset:6144
    ds_read_b64_tr_b16 v[54:55], v13 offset:6656
    s_waitcnt lgkmcnt(4)
    v_mfma_f32_32x32x16_bf16 v[80:95], v[44:47], v[100:103], v[80:95]
    ds_read_b64_tr_b16 v[40:41], v13 offset:8192
    ds_read_b64_tr_b16 v[42:43], v13 offset:8704
    s_waitcnt lgkmcnt(4)
    v_mfma_f32_32x32x16_bf16 v[80:95], v[48:51], v[104:107], v[80:95]
    ds_read_b64_tr_b16 v[44:45], v13 offset:10240
    ds_read_b64_tr_b16 v[46:47], v13 offset:10752
    s_waitcnt lgkmcnt(4)
    v_mfma_f32_32x32x16_bf16 v[80:95], v[52:55], v[108:111], v[80:95]
    ds_read_b64_tr_b16 v[48:49], v13 offset:12288
    ds_read_b64_tr_b16 v[50:51], v13 offset:12800
    s_mul_i32 s56, s46, 663552
    s_add_u32 s56, s56, s50
    s_add_u32 m0, s53, 73728
    s_add_u32 s56, s56, 2654208
    buffer_load_dwordx4 v4, s[12:15], s56 offen offset:0 lds
    s_waitcnt lgkmcnt(4)
    v_mfma_f32_32x32x16_bf16 v[80:95], v[40:43], v[112:115], v[80:95]
    ds_read_b64_tr_b16 v[52:53], v13 offset:14336
    ds_read_b64_tr_b16 v[54:55], v13 offset:14848
    s_waitcnt lgkmcnt(4)
    v_mfma_f32_32x32x16_bf16 v[80:95], v[44:47], v[116:119], v[80:95]
    ds_read_b64_tr_b16 v[40:41], v13 offset:16384
    ds_read_b64_tr_b16 v[42:43], v13 offset:16896
    s_waitcnt lgkmcnt(4)
    v_mfma_f32_32x32x16_bf16 v[80:95], v[48:51], v[120:123], v[80:95]
    ds_read_b64_tr_b16 v[44:45], v13 offset:18432
    ds_read_b64_tr_b16 v[46:47], v13 offset:18944
    buffer_load_dwordx4 v5, s[12:15], s56 offen offset:1024 lds
    s_waitcnt lgkmcnt(4)
    v_mfma_f32_32x32x16_bf16 v[80:95], v[52:55], v[124:127], v[80:95]
    ds_read_b64_tr_b16 v[48:49], v13 offset:20480
    ds_read_b64_tr_b16 v[50:51], v13 offset:20992
    s_waitcnt lgkmcnt(4)
    v_mfma_f32_32x32x16_bf16 v[80:95], v[40:43], v[128:131], v[80:95]
    ds_read_b64_tr_b16 v[52:53], v13 offset:22528
    ds_read_b64_tr_b16 v[54:55], v13 offset:23040
    s_waitcnt lgkmcnt(4)
    v_mfma_f32_32x32x16_bf16 v[80:95], v[44:47], v[132:135], v[80:95]
    ds_read_b64_tr_b16 v[40:41], v13 offset:24576
    ds_read_b64_tr_b16 v[42:43], v13 offset:25088
    buffer_load_dwordx4 v6, s[12:15], s56 offen offset:2048 lds
    s_waitcnt lgkmcnt(4)
    v_mfma_f32_32x32x16_bf16 v[80:95], v[48:51], v[136:139], v[80:95]
    ds_read_b64_tr_b16 v[44:45], v13 offset:26624
    ds_read_b64_tr_b16 v[46:47], v13 offset:27136
    s_waitcnt lgkmcnt(4)
    v_mfma_f32_32x32x16_bf16 v[80:95], v[52:55], v[140:143], v[80:95]
    ds_read_b64_tr_b16 v[48:49], v13 offset:28672
    ds_read_b64_tr_b16 v[50:51], v13 offset:29184
    s_waitcnt lgkmcnt(4)
    v_mfma_f32_32x32x16_bf16 v[80:95], v[40:43], v[144:147], v[80:95]
    ds_read_b64_tr_b16 v[52:53], v13 offset:30720
    ds_read_b64_tr_b16 v[54:55], v13 offset:31232
    s_add_u32 m0, s53, 76800
    s_add_u32 s56, s56, 221184
    buffer_load_dwordx4 v4, s[12:15], s56 offen offset:0 lds
    s_waitcnt lgkmcnt(4)
    v_mfma_f32_32x32x16_bf16 v[80:95], v[44:47], v[148:151], v[80:95]
    ds_read_b64_tr_b16 v[40:41], v13 offset:32768
    ds_read_b64_tr_b16 v[42:43], v13 offset:33280
    s_waitcnt lgkmcnt(4)
    v_mfma_f32_32x32x16_bf16 v[80:95], v[48:51], v[152:155], v[80:95]
    ds_read_b64_tr_b16 v[44:45], v13 offset:34816
    ds_read_b64_tr_b16 v[46:47], v13 offset:35328
    s_waitcnt lgkmcnt(4)
    v_mfma_f32_32x32x16_bf16 v[80:95], v[52:55], v[156:159], v[80:95]
    v_add_u32 v13, 0, v10
    ds_read_b64_tr_b16 v[48:49], v13 offset:0
    ds_read_b64_tr_b16 v[50:51], v13 offset:512
    buffer_load_dwordx4 v5, s[12:15], s56 offen offset:1024 lds
    s_waitcnt lgkmcnt(4)
    v_mfma_f32_32x32x16_bf16 v[80:95], v[40:43], v[160:163], v[80:95]
    ds_read_b64_tr_b16 v[52:53], v13 offset:2048
    ds_read_b64_tr_b16 v[54:55], v13 offset:2560
    s_waitcnt lgkmcnt(4)
    v_mfma_f32_32x32x16_bf16 v[80:95], v[44:47], v[164:167], v[80:95]
    ds_read_b64_tr_b16 v[40:41], v13 offset:4096
    ds_read_b64_tr_b16 v[42:43], v13 offset:4608
    s_waitcnt lgkmcnt(4)
    v_mfma_f32_32x32x16_bf16 v[80:95], v[48:51], v[168:171], v[80:95]
    ds_read_b64_tr_b16 v[44:45], v13 offset:6144
    ds_read_b64_tr_b16 v[46:47], v13 offset:6656
    buffer_load_dwordx4 v6, s[12:15], s56 offen offset:2048 lds
    s_waitcnt lgkmcnt(4)
    v_mfma_f32_32x32x16_bf16 v[80:95], v[52:55], v[172:175], v[80:95]
    ds_read_b64_tr_b16 v[48:49], v13 offset:8192
    ds_read_b64_tr_b16 v[50:51], v13 offset:8704
    s_waitcnt lgkmcnt(4)
    v_mfma_f32_32x32x16_bf16 v[80:95], v[40:43], v[176:179], v[80:95]
    ds_read_b64_tr_b16 v[52:53], v13 offset:10240
    ds_read_b64_tr_b16 v[54:55], v13 offset:10752
    s_waitcnt lgkmcnt(4)
    v_mfma_f32_32x32x16_bf16 v[80:95], v[44:47], v[180:183], v[80:95]
    ds_read_b64_tr_b16 v[40:41], v13 offset:12288
    ds_read_b64_tr_b16 v[42:43], v13 offset:12800
    s_add_u32 m0, s53, 79872
    s_add_u32 s56, s56, 221184
    buffer_load_dwordx4 v4, s[12:15], s56 offen offset:0 lds
    s_waitcnt lgkmcnt(4)
    v_mfma_f32_32x32x16_bf16 v[80:95], v[48:51], v[184:187], v[80:95]
    ds_read_b64_tr_b16 v[44:45], v13 offset:14336
    ds_read_b64_tr_b16 v[46:47], v13 offset:14848
    s_waitcnt lgkmcnt(4)
    v_mfma_f32_32x32x16_bf16 v[80:95], v[52:55], v[188:191], v[80:95]
    ds_read_b64_tr_b16 v[48:49], v13 offset:16384
    ds_read_b64_tr_b16 v[50:51], v13 offset:16896
    s_waitcnt lgkmcnt(4)
    v_mfma_f32_32x32x16_bf16 v[80:95], v[40:43], v[192:195], v[80:95]
    ds_read_b64_tr_b16 v[52:53], v13 offset:18432
    ds_read_b64_tr_b16 v[54:55], v13 offset:18944
    buffer_load_dwordx4 v5, s[12:15], s56 offen offset:1024 lds
    s_waitcnt lgkmcnt(4)
    v_mfma_f32_32x32x16_bf16 v[80:95], v[44:47], v[196:199], v[80:95]
    ds_read_b64_tr_b16 v[40:41], v13 offset:20480
    ds_read_b64_tr_b16 v[42:43], v13 offset:20992
    s_waitcnt lgkmcnt(4)
    v_mfma_f32_32x32x16_bf16 v[80:95], v[48:51], v[200:203], v[80:95]
    ds_read_b64_tr_b16 v[44:45], v13 offset:22528
    ds_read_b64_tr_b16 v[46:47], v13 offset:23040
    s_waitcnt lgkmcnt(4)
    v_mfma_f32_32x32x16_bf16 v[80:95], v[52:55], v[204:207], v[80:95]
    ds_read_b64_tr_b16 v[48:49], v13 offset:24576
    ds_read_b64_tr_b16 v[50:51], v13 offset:25088
    buffer_load_dwordx4 v6, s[12:15], s56 offen offset:2048 lds
    s_waitcnt lgkmcnt(4)
    v_mfma_f32_32x32x16_bf16 v[80:95], v[40:43], v[208:211], v[80:95]
    ds_read_b64_tr_b16 v[52:53], v13 offset:26624
    ds_read_b64_tr_b16 v[54:55], v13 offset:27136
    s_waitcnt lgkmcnt(4)
    v_mfma_f32_32x32x16_bf16 v[80:95], v[44:47], v[212:215], v[80:95]
    ds_read_b64_tr_b16 v[40:41], v13 offset:28672
    ds_read_b64_tr_b16 v[42:43], v13 offset:29184
    s_waitcnt lgkmcnt(4)
    v_mfma_f32_32x32x16_bf16 v[80:95], v[48:51], v[216:219], v[80:95]
    ds_read_b64_tr_b16 v[44:45], v13 offset:30720
    ds_read_b64_tr_b16 v[46:47], v13 offset:31232
    s_waitcnt lgkmcnt(4)
    v_mfma_f32_32x32x16_bf16 v[80:95], v[52:55], v[220:223], v[80:95]
    ds_read_b64_tr_b16 v[48:49], v13 offset:32768
    ds_read_b64_tr_b16 v[50:51], v13 offset:33280
    s_waitcnt lgkmcnt(4)
    v_mfma_f32_32x32x16_bf16 v[80:95], v[40:43], v[224:227], v[80:95]
    ds_read_b64_tr_b16 v[52:53], v13 offset:34816
    ds_read_b64_tr_b16 v[54:55], v13 offset:35328
    s_waitcnt vmcnt(14) lgkmcnt(0)
    s_barrier
    v_mfma_f32_32x32x16_bf16 v[80:95], v[44:47], v[228:231], v[80:95]
    v_mfma_f32_32x32x16_bf16 v[80:95], v[48:51], v[232:235], v[80:95]
    v_mfma_f32_32x32x16_bf16 v[80:95], v[52:55], v[236:239], v[80:95]
    s_setprio 0
    v_and_b32 v33, 31, v1
    v_lshlrev_b32 v33, 3, v33
    s_lshl_b32 s43, s46, 8
    s_add_u32 s43, s43, 147456
    v_add_u32 v33, s43, v33
    ds_read_b64 v[18:19], v33
    s_add_u32 s43, s51, 192
    s_cmp_lt_u32 s43, 1152
    s_cselect_b32 s43, 0xbe173fd8, s52
    s_waitcnt vmcnt(13)
    v_mul_f32 v32, s43, v17
    v_add_u32 v28, v16, v36
    v_add_u32 v29, v16, v37
    v_add_u32 v30, v16, v38
    v_add_u32 v31, v16, v39
    v_mul_f32 v80, v32, v80
    v_mul_f32 v81, v32, v81
    v_mul_f32 v82, v32, v82
    v_mul_f32 v83, v32, v83
    v_cvt_pk_bf16_f32 v20, v80, v81
    v_cvt_pk_bf16_f32 v21, v82, v83
    buffer_store_dwordx2 v[20:21], v28, s[20:23], s71 offen sc1
    s_waitcnt vmcnt(1)
    s_barrier
    v_mul_f32 v84, v32, v84
    v_mul_f32 v85, v32, v85
    v_mul_f32 v86, v32, v86
    v_mul_f32 v87, v32, v87
    v_cvt_pk_bf16_f32 v22, v84, v85
    v_cvt_pk_bf16_f32 v23, v86, v87
    buffer_store_dwordx2 v[22:23], v29, s[20:23], s71 offen sc1
    v_mul_f32 v88, v32, v88
    v_mul_f32 v89, v32, v89
    v_mul_f32 v90, v32, v90
    v_mul_f32 v91, v32, v91
    v_cvt_pk_bf16_f32 v24, v88, v89
    v_cvt_pk_bf16_f32 v25, v90, v91
    buffer_store_dwordx2 v[24:25], v30, s[20:23], s71 offen sc1
    v_mul_f32 v92, v32, v92
    v_mul_f32 v93, v32, v93
    v_mul_f32 v94, v32, v94
    v_mul_f32 v95, v32, v95
    v_cvt_pk_bf16_f32 v26, v92, v93
    v_cvt_pk_bf16_f32 v27, v94, v95
    buffer_store_dwordx2 v[26:27], v31, s[20:23], s71 offen sc1
    s_waitcnt lgkmcnt(0)
    v_lshlrev_b32 v20, 16, v56
    v_and_b32 v21, 0xffff0000, v56
    v_fma_f32 v20, v20, v18, -v19
    v_fma_f32 v21, v21, v18, -v19
    v_cvt_pk_bf16_f32 v56, v20, v21
    v_lshlrev_b32 v22, 16, v57
    v_and_b32 v23, 0xffff0000, v57
    v_fma_f32 v22, v22, v18, -v19
    v_fma_f32 v23, v23, v18, -v19
    v_cvt_pk_bf16_f32 v57, v22, v23
    v_lshlrev_b32 v24, 16, v58
    v_and_b32 v25, 0xffff0000, v58
    v_fma_f32 v24, v24, v18, -v19
    v_fma_f32 v25, v25, v18, -v19
    v_cvt_pk_bf16_f32 v58, v24, v25
    v_lshlrev_b32 v26, 16, v59
    v_and_b32 v27, 0xffff0000, v59
    v_fma_f32 v26, v26, v18, -v19
    v_fma_f32 v27, v27, v18, -v19
    v_cvt_pk_bf16_f32 v59, v26, v27
    buffer_store_dwordx4 v[56:59], v14, s[20:23], s58 offen sc1
    v_lshlrev_b32 v20, 16, v60
    v_and_b32 v21, 0xffff0000, v60
    v_fma_f32 v20, v20, v18, -v19
    v_fma_f32 v21, v21, v18, -v19
    v_cvt_pk_bf16_f32 v60, v20, v21
    v_lshlrev_b32 v22, 16, v61
    v_and_b32 v23, 0xffff0000, v61
    v_fma_f32 v22, v22, v18, -v19
    v_fma_f32 v23, v23, v18, -v19
    v_cvt_pk_bf16_f32 v61, v22, v23
    v_lshlrev_b32 v24, 16, v62
    v_and_b32 v25, 0xffff0000, v62
    v_fma_f32 v24, v24, v18, -v19
    v_fma_f32 v25, v25, v18, -v19
    v_cvt_pk_bf16_f32 v62, v24, v25
    v_lshlrev_b32 v26, 16, v63
    v_and_b32 v27, 0xffff0000, v63
    v_fma_f32 v26, v26, v18, -v19
    v_fma_f32 v27, v27, v18, -v19
    v_cvt_pk_bf16_f32 v63, v26, v27
    buffer_store_dwordx4 v[60:63], v14, s[20:23], s59 offen sc1
    v_lshlrev_b32 v20, 16, v64
    v_and_b32 v21, 0xffff0000, v64
    v_fma_f32 v20, v20, v18, -v19
    v_fma_f32 v21, v21, v18, -v19
    v_cvt_pk_bf16_f32 v64, v20, v21
    v_lshlrev_b32 v22, 16, v65
    v_and_b32 v23, 0xffff0000, v65
    v_fma_f32 v22, v22, v18, -v19
    v_fma_f32 v23, v23, v18, -v19
    v_cvt_pk_bf16_f32 v65, v22, v23
    v_lshlrev_b32 v24, 16, v66
    v_and_b32 v25, 0xffff0000, v66
    v_fma_f32 v24, v24, v18, -v19
    v_fma_f32 v25, v25, v18, -v19
    v_cvt_pk_bf16_f32 v66, v24, v25
    v_lshlrev_b32 v26, 16, v67
    v_and_b32 v27, 0xffff0000, v67
    v_fma_f32 v26, v26, v18, -v19
    v_fma_f32 v27, v27, v18, -v19
    v_cvt_pk_bf16_f32 v67, v26, v27
    buffer_store_dwordx4 v[64:67], v14, s[20:23], s60 offen sc1
    v_lshlrev_b32 v20, 16, v68
    v_and_b32 v21, 0xffff0000, v68
    v_fma_f32 v20, v20, v18, -v19
    v_fma_f32 v21, v21, v18, -v19
    v_cvt_pk_bf16_f32 v68, v20, v21
    v_lshlrev_b32 v22, 16, v69
    v_and_b32 v23, 0xffff0000, v69
    v_fma_f32 v22, v22, v18, -v19
    v_fma_f32 v23, v23, v18, -v19
    v_cvt_pk_bf16_f32 v69, v22, v23
    v_lshlrev_b32 v24, 16, v70
    v_and_b32 v25, 0xffff0000, v70
    v_fma_f32 v24, v24, v18, -v19
    v_fma_f32 v25, v25, v18, -v19
    v_cvt_pk_bf16_f32 v70, v24, v25
    v_lshlrev_b32 v26, 16, v71
    v_and_b32 v27, 0xffff0000, v71
    v_fma_f32 v26, v26, v18, -v19
    v_fma_f32 v27, v27, v18, -v19
    v_cvt_pk_bf16_f32 v71, v26, v27
    buffer_store_dwordx4 v[68:71], v14, s[20:23], s61 offen sc1
    s_bitcmp1_b32 s42, 0
    s_cbranch_scc1 L1_noex0
    v_lshlrev_b32 v20, 16, v72
    v_and_b32 v21, 0xffff0000, v72
    v_fma_f32 v20, v20, v18, -v19
    v_fma_f32 v21, v21, v18, -v19
    v_cvt_pk_bf16_f32 v72, v20, v21
    v_lshlrev_b32 v22, 16, v73
    v_and_b32 v23, 0xffff0000, v73
    v_fma_f32 v22, v22, v18, -v19
    v_fma_f32 v23, v23, v18, -v19
    v_cvt_pk_bf16_f32 v73, v22, v23
    v_lshlrev_b32 v24, 16, v74
    v_and_b32 v25, 0xffff0000, v74
    v_fma_f32 v24, v24, v18, -v19
    v_fma_f32 v25, v25, v18, -v19
    v_cvt_pk_bf16_f32 v74, v24, v25
    v_lshlrev_b32 v26, 16, v75
    v_and_b32 v27, 0xffff0000, v75
    v_fma_f32 v26, v26, v18, -v19
    v_fma_f32 v27, v27, v18, -v19
    v_cvt_pk_bf16_f32 v75, v26, v27
    buffer_store_dwordx4 v[72:75], v14, s[20:23], s62 offen sc1
    v_lshlrev_b32 v20, 16, v76
    v_and_b32 v21, 0xffff0000, v76
    v_fma_f32 v20, v20, v18, -v19
    v_fma_f32 v21, v21, v18, -v19
    v_cvt_pk_bf16_f32 v76, v20, v21
    v_lshlrev_b32 v22, 16, v77
    v_and_b32 v23, 0xffff0000, v77
    v_fma_f32 v22, v22, v18, -v19
    v_fma_f32 v23, v23, v18, -v19
    v_cvt_pk_bf16_f32 v77, v22, v23
    v_lshlrev_b32 v24, 16, v78
    v_and_b32 v25, 0xffff0000, v78
    v_fma_f32 v24, v24, v18, -v19
    v_fma_f32 v25, v25, v18, -v19
    v_cvt_pk_bf16_f32 v78, v24, v25
    v_lshlrev_b32 v26, 16, v79
    v_and_b32 v27, 0xffff0000, v79
    v_fma_f32 v26, v26, v18, -v19
    v_fma_f32 v27, v27, v18, -v19
    v_cvt_pk_bf16_f32 v79, v26, v27
    buffer_store_dwordx4 v[76:79], v14, s[20:23], s63 offen sc1
L1_noex0:
    s_waitcnt lgkmcnt(0)
    s_barrier
    s_setprio 1
    v_add_u32 v13, 36864, v10
    ds_read_b64_tr_b16 v[40:41], v13 offset:0
    ds_read_b64_tr_b16 v[42:43], v13 offset:512
    ds_read_b64_tr_b16 v[44:45], v13 offset:2048
    ds_read_b64_tr_b16 v[46:47], v13 offset:2560
    ds_read_b64_tr_b16 v[48:49], v13 offset:4096
    ds_read_b64_tr_b16 v[50:51], v13 offset:4608
    s_waitcnt lgkmcnt(4)
    v_mfma_f32_32x32x16_bf16 v[80:95], v[40:43], v[96:99], 0
    ds_read_b64_tr_b16 v[52:53], v13 offset:6144
    ds_read_b64_tr_b16 v[54:55], v13 offset:6656
    s_waitcnt lgkmcnt(4)
    v_mfma_f32_32x32x16_bf16 v[80:95], v[44:47], v[100:103], v[80:95]
    ds_read_b64_tr_b16 v[40:41], v13 offset:8192
    ds_read_b64_tr_b16 v[42:43], v13 offset:8704
    s_waitcnt lgkmcnt(4)
    v_mfma_f32_32x32x16_bf16 v[80:95], v[48:51], v[104:107], v[80:95]
    ds_read_b64_tr_b16 v[44:45], v13 offset:10240
    ds_read_b64_tr_b16 v[46:47], v13 offset:10752
    s_waitcnt lgkmcnt(4)
    v_mfma_f32_32x32x16_bf16 v[80:95], v[52:55], v[108:111], v[80:95]
    ds_read_b64_tr_b16 v[48:49], v13 offset:12288
    ds_read_b64_tr_b16 v[50:51], v13 offset:12800
    s_waitcnt lgkmcnt(4)
    v_mfma_f32_32x32x16_bf16 v[80:95], v[40:43], v[112:115], v[80:95]
    ds_read_b64_tr_b16 v[52:53], v13 offset:14336
    ds_read_b64_tr_b16 v[54:55], v13 offset:14848
    s_waitcnt lgkmcnt(4)
    v_mfma_f32_32x32x16_bf16 v[80:95], v[44:47], v[116:119], v[80:95]
    ds_read_b64_tr_b16 v[40:41], v13 offset:16384
    ds_read_b64_tr_b16 v[42:43], v13 offset:16896
    s_waitcnt lgkmcnt(4)
    v_mfma_f32_32x32x16_bf16 v[80:95], v[48:51], v[120:123], v[80:95]
    ds_read_b64_tr_b16 v[44:45], v13 offset:18432
    ds_read_b64_tr_b16 v[46:47], v13 offset:18944
    s_waitcnt lgkmcnt(4)
    v_mfma_f32_32x32x16_bf16 v[80:95], v[52:55], v[124:127], v[80:95]
    ds_read_b64_tr_b16 v[48:49], v13 offset:20480
    ds_read_b64_tr_b16 v[50:51], v13 offset:20992
    s_waitcnt lgkmcnt(4)
    v_mfma_f32_32x32x16_bf16 v[80:95], v[40:43], v[128:131], v[80:95]
    ds_read_b64_tr_b16 v[52:53], v13 offset:22528
    ds_read_b64_tr_b16 v[54:55], v13 offset:23040
    s_waitcnt lgkmcnt(4)
    v_mfma_f32_32x32x16_bf16 v[80:95], v[44:47], v[132:135], v[80:95]
    ds_read_b64_tr_b16 v[40:41], v13 offset:24576
    ds_read_b64_tr_b16 v[42:43], v13 offset:25088
    s_waitcnt lgkmcnt(4)
    v_mfma_f32_32x32x16_bf16 v[80:95], v[48:51], v[136:139], v[80:95]
    ds_read_b64_tr_b16 v[44:45], v13 offset:26624
    ds_read_b64_tr_b16 v[46:47], v13 offset:27136
    s_waitcnt lgkmcnt(4)
    v_mfma_f32_32x32x16_bf16 v[80:95], v[52:55], v[140:143], v[80:95]
    ds_read_b64_tr_b16 v[48:49], v13 offset:28672
    ds_read_b64_tr_b16 v[50:51], v13 offset:29184
    s_waitcnt lgkmcnt(4)
    v_mfma_f32_32x32x16_bf16 v[80:95], v[40:43], v[144:147], v[80:95]
    ds_read_b64_tr_b16 v[52:53], v13 offset:30720
    ds_read_b64_tr_b16 v[54:55], v13 offset:31232
    s_waitcnt lgkmcnt(4)
    v_mfma_f32_32x32x16_bf16 v[80:95], v[44:47], v[148:151], v[80:95]
    ds_read_b64_tr_b16 v[40:41], v13 offset:32768
    ds_read_b64_tr_b16 v[42:43], v13 offset:33280
    s_waitcnt lgkmcnt(4)
    v_mfma_f32_32x32x16_bf16 v[80:95], v[48:51], v[152:155], v[80:95]
    ds_read_b64_tr_b16 v[44:45], v13 offset:34816
    ds_read_b64_tr_b16 v[46:47], v13 offset:35328
    s_waitcnt lgkmcnt(4)
    v_mfma_f32_32x32x16_bf16 v[80:95], v[52:55], v[156:159], v[80:95]
    v_add_u32 v13, 73728, v10
    ds_read_b64_tr_b16 v[48:49], v13 offset:0
    ds_read_b64_tr_b16 v[50:51], v13 offset:512
    s_waitcnt lgkmcnt(4)
    v_mfma_f32_32x32x16_bf16 v[80:95], v[40:43], v[160:163], v[80:95]
    ds_read_b64_tr_b16 v[52:53], v13 offset:2048
    ds_read_b64_tr_b16 v[54:55], v13 offset:2560
    s_waitcnt lgkmcnt(4)
    v_mfma_f32_32x32x16_bf16 v[80:95], v[44:47], v[164:167], v[80:95]
    ds_read_b64_tr_b16 v[40:41], v13 offset:4096
    ds_read_b64_tr_b16 v[42:43], v13 offset:4608
    s_waitcnt lgkmcnt(4)
    v_mfma_f32_32x32x16_bf16 v[80:95], v[48:51], v[168:171], v[80:95]
    ds_read_b64_tr_b16 v[44:45], v13 offset:6144
    ds_read_b64_tr_b16 v[46:47], v13 offset:6656
    s_waitcnt lgkmcnt(4)
    v_mfma_f32_32x32x16_bf16 v[80:95], v[52:55], v[172:175], v[80:95]
    ds_read_b64_tr_b16 v[48:49], v13 offset:8192
    ds_read_b64_tr_b16 v[50:51], v13 offset:8704
    s_waitcnt lgkmcnt(4)
    v_mfma_f32_32x32x16_bf16 v[80:95], v[40:43], v[176:179], v[80:95]
    ds_read_b64_tr_b16 v[52:53], v13 offset:10240
    ds_read_b64_tr_b16 v[54:55], v13 offset:10752
    s_waitcnt lgkmcnt(4)
    v_mfma_f32_32x32x16_bf16 v[80:95], v[44:47], v[180:183], v[80:95]
    ds_read_b64_tr_b16 v[40:41], v13 offset:12288
    ds_read_b64_tr_b16 v[42:43], v13 offset:12800
    s_waitcnt lgkmcnt(4)
    v_mfma_f32_32x32x16_bf16 v[80:95], v[48:51], v[184:187], v[80:95]
    ds_read_b64_tr_b16 v[44:45], v13 offset:14336
    ds_read_b64_tr_b16 v[46:47], v13 offset:14848
    s_waitcnt lgkmcnt(4)
    v_mfma_f32_32x32x16_bf16 v[80:95], v[52:55], v[188:191], v[80:95]
    ds_read_b64_tr_b16 v[48:49], v13 offset:16384
    ds_read_b64_tr_b16 v[50:51], v13 offset:16896
    s_waitcnt lgkmcnt(4)
    v_mfma_f32_32x32x16_bf16 v[80:95], v[40:43], v[192:195], v[80:95]
    ds_read_b64_tr_b16 v[52:53], v13 offset:18432
    ds_read_b64_tr_b16 v[54:55], v13 offset:18944
    s_waitcnt lgkmcnt(4)
    v_mfma_f32_32x32x16_bf16 v[80:95], v[44:47], v[196:199], v[80:95]
    ds_read_b64_tr_b16 v[40:41], v13 offset:20480
    ds_read_b64_tr_b16 v[42:43], v13 offset:20992
    s_waitcnt lgkmcnt(4)
    v_mfma_f32_32x32x16_bf16 v[80:95], v[48:51], v[200:203], v[80:95]
    ds_read_b64_tr_b16 v[44:45], v13 offset:22528
    ds_read_b64_tr_b16 v[46:47], v13 offset:23040
    s_waitcnt lgkmcnt(4)
    v_mfma_f32_32x32x16_bf16 v[80:95], v[52:55], v[204:207], v[80:95]
    ds_read_b64_tr_b16 v[48:49], v13 offset:24576
    ds_read_b64_tr_b16 v[50:51], v13 offset:25088
    s_waitcnt lgkmcnt(4)
    v_mfma_f32_32x32x16_bf16 v[80:95], v[40:43], v[208:211], v[80:95]
    ds_read_b64_tr_b16 v[52:53], v13 offset:26624
    ds_read_b64_tr_b16 v[54:55], v13 offset:27136
    s_waitcnt lgkmcnt(4)
    v_mfma_f32_32x32x16_bf16 v[80:95], v[44:47], v[212:215], v[80:95]
    ds_read_b64_tr_b16 v[40:41], v13 offset:28672
    ds_read_b64_tr_b16 v[42:43], v13 offset:29184
    s_waitcnt lgkmcnt(4)
    v_mfma_f32_32x32x16_bf16 v[80:95], v[48:51], v[216:219], v[80:95]
    ds_read_b64_tr_b16 v[44:45], v13 offset:30720
    ds_read_b64_tr_b16 v[46:47], v13 offset:31232
    s_waitcnt lgkmcnt(4)
    v_mfma_f32_32x32x16_bf16 v[80:95], v[52:55], v[220:223], v[80:95]
    ds_read_b64_tr_b16 v[48:49], v13 offset:32768
    ds_read_b64_tr_b16 v[50:51], v13 offset:33280
    s_waitcnt lgkmcnt(4)
    v_mfma_f32_32x32x16_bf16 v[80:95], v[40:43], v[224:227], v[80:95]
    ds_read_b64_tr_b16 v[52:53], v13 offset:34816
    ds_read_b64_tr_b16 v[54:55], v13 offset:35328
    s_waitcnt vmcnt(0) lgkmcnt(0)
    s_barrier
    v_mfma_f32_32x32x16_bf16 v[80:95], v[44:47], v[228:231], v[80:95]
    v_mfma_f32_32x32x16_bf16 v[80:95], v[48:51], v[232:235], v[80:95]
    v_mfma_f32_32x32x16_bf16 v[80:95], v[52:55], v[236:239], v[80:95]
    s_setprio 0
    s_lshl_b32 s43, s2, 2
    s_add_u32 s43, s43, s46
    s_lshl_b32 s43, s43, 13
    v_lshrrev_b32 v246, 3, v1
    v_lshlrev_b32 v246, 12, v246
    v_and_b32 v247, 7, v1
    v_lshlrev_b32 v247, 7, v247
    v_add_u32 v246, v246, v247
    s_mov_b64 exec, 0x3f3f
    buffer_load_dword v3, v246, s[4:7], s43 offen
    s_mov_b64 exec, -1
    v_mul_f32 v20, v80, v80
    v_mul_f32 v21, v81, v81
    v_mul_f32 v22, v82, v82
    v_mul_f32 v23, v83, v83
    v_fma_f32 v20, v20, v0, v17
    v_fma_f32 v21, v21, v0, v17
    v_fma_f32 v22, v22, v0, v17
    v_fma_f32 v23, v23, v0, v17
    v_mul_f32 v20, v20, v80
    v_mul_f32 v21, v21, v81
    v_mul_f32 v22, v22, v82
    v_mul_f32 v23, v23, v83
    v_exp_f32 v20, v20
    v_exp_f32 v21, v21
    v_exp_f32 v22, v22
    v_exp_f32 v23, v23
    v_fma_f32 v20, v20, v2, v2
    v_fma_f32 v21, v21, v2, v2
    v_fma_f32 v22, v22, v2, v2
    v_fma_f32 v23, v23, v2, v2
    v_rcp_f32 v20, v20
    v_rcp_f32 v21, v21
    v_rcp_f32 v22, v22
    v_rcp_f32 v23, v23
    v_mul_f32 v80, v80, v20
    v_mul_f32 v81, v81, v21
    v_mul_f32 v82, v82, v22
    v_mul_f32 v83, v83, v23
    v_cvt_pk_bf16_f32 v28, v80, v81
    v_cvt_pk_bf16_f32 v29, v82, v83
    s_barrier
    v_mul_f32 v24, v88, v88
    v_mul_f32 v25, v89, v89
    v_mul_f32 v26, v90, v90
    v_mul_f32 v27, v91, v91
    v_fma_f32 v24, v24, v0, v17
    v_fma_f32 v25, v25, v0, v17
    v_fma_f32 v26, v26, v0, v17
    v_fma_f32 v27, v27, v0, v17
    v_mul_f32 v24, v24, v88
    v_mul_f32 v25, v25, v89
    v_mul_f32 v26, v26, v90
    v_mul_f32 v27, v27, v91
    v_exp_f32 v24, v24
    v_exp_f32 v25, v25
    v_exp_f32 v26, v26
    v_exp_f32 v27, v27
    v_fma_f32 v24, v24, v2, v2
    v_fma_f32 v25, v25, v2, v2
    v_fma_f32 v26, v26, v2, v2
    v_fma_f32 v27, v27, v2, v2
    v_rcp_f32 v24, v24
    v_rcp_f32 v25, v25
    v_rcp_f32 v26, v26
    v_rcp_f32 v27, v27
    v_mul_f32 v88, v88, v24
    v_mul_f32 v89, v89, v25
    v_mul_f32 v90, v90, v26
    v_mul_f32 v91, v91, v27
    v_cvt_pk_bf16_f32 v30, v88, v89
    v_cvt_pk_bf16_f32 v31, v90, v91
    buffer_store_dwordx4 v[28:31], v15, s[20:23], s64 offen offset:0
    v_mul_f32 v20, v84, v84
    v_mul_f32 v21, v85, v85
    v_mul_f32 v22, v86, v86
    v_mul_f32 v23, v87, v87
    v_fma_f32 v20, v20, v0, v17
    v_fma_f32 v21, v21, v0, v17
    v_fma_f32 v22, v22, v0, v17
    v_fma_f32 v23, v23, v0, v17
    v_mul_f32 v20, v20, v84
    v_mul_f32 v21, v21, v85
    v_mul_f32 v22, v22, v86
    v_mul_f32 v23, v23, v87
    v_exp_f32 v20, v20
    v_exp_f32 v21, v21
    v_exp_f32 v22, v22
    v_exp_f32 v23, v23
    v_fma_f32 v20, v20, v2, v2
    v_fma_f32 v21, v21, v2, v2
    v_fma_f32 v22, v22, v2, v2
    v_fma_f32 v23, v23, v2, v2
    v_rcp_f32 v20, v20
    v_rcp_f32 v21, v21
    v_rcp_f32 v22, v22
    v_rcp_f32 v23, v23
    v_mul_f32 v84, v84, v20
    v_mul_f32 v85, v85, v21
    v_mul_f32 v86, v86, v22
    v_mul_f32 v87, v87, v23
    v_cvt_pk_bf16_f32 v32, v84, v85
    v_cvt_pk_bf16_f32 v33, v86, v87
    v_mul_f32 v24, v92, v92
    v_mul_f32 v25, v93, v93
    v_mul_f32 v26, v94, v94
    v_mul_f32 v27, v95, v95
    v_fma_f32 v24, v24, v0, v17
    v_fma_f32 v25, v25, v0, v17
    v_fma_f32 v26, v26, v0, v17
    v_fma_f32 v27, v27, v0, v17
    v_mul_f32 v24, v24, v92
    v_mul_f32 v25, v25, v93
    v_mul_f32 v26, v26, v94
    v_mul_f32 v27, v27, v95
    v_exp_f32 v24, v24
    v_exp_f32 v25, v25
    v_exp_f32 v26, v26
    v_exp_f32 v27, v27
    v_fma_f32 v24, v24, v2, v2
    v_fma_f32 v25, v25, v2, v2
    v_fma_f32 v26, v26, v2, v2
    v_fma_f32 v27, v27, v2, v2
    v_rcp_f32 v24, v24
    v_rcp_f32 v25, v25
    v_rcp_f32 v26, v26
    v_rcp_f32 v27, v27
    v_mul_f32 v92, v92, v24
    v_mul_f32 v93, v93, v25
    v_mul_f32 v94, v94, v26
    v_mul_f32 v95, v95, v27
    v_cvt_pk_bf16_f32 v34, v92, v93
    v_cvt_pk_bf16_f32 v35, v94, v95
    buffer_store_dwordx4 v[32:35], v15, s[20:23], s64 offen offset:512
    s_load_dwordx4 s[32:35], s[0:1], 40
    s_load_dwordx2 s[36:37], s[0:1], 56
    s_load_dwordx2 s[38:39], s[0:1], 16
    s_waitcnt lgkmcnt(0)
    s_barrier
    s_mov_b32 s70, s65
    s_mov_b32 s49, s46
    s_setprio 1
    v_add_u32 v13, 110592, v10
    ds_read_b64_tr_b16 v[40:41], v13 offset:0
    ds_read_b64_tr_b16 v[42:43], v13 offset:512
    ds_read_b64_tr_b16 v[44:45], v13 offset:2048
    ds_read_b64_tr_b16 v[46:47], v13 offset:2560
    ds_read_b64_tr_b16 v[48:49], v13 offset:4096
    ds_read_b64_tr_b16 v[50:51], v13 offset:4608
    s_waitcnt lgkmcnt(4)
    v_mfma_f32_32x32x16_bf16 v[80:95], v[40:43], v[96:99], 0
    ds_read_b64_tr_b16 v[52:53], v13 offset:6144
    ds_read_b64_tr_b16 v[54:55], v13 offset:6656
    s_waitcnt lgkmcnt(4)
    v_mfma_f32_32x32x16_bf16 v[80:95], v[44:47], v[100:103], v[80:95]
    ds_read_b64_tr_b16 v[40:41], v13 offset:8192
    ds_read_b64_tr_b16 v[42:43], v13 offset:8704
    s_waitcnt lgkmcnt(4)
    v_mfma_f32_32x32x16_bf16 v[80:95], v[48:51], v[104:107], v[80:95]
    ds_read_b64_tr_b16 v[44:45], v13 offset:10240
    ds_read_b64_tr_b16 v[46:47], v13 offset:10752
    v_lshrrev_b32 v240, 4, v1
    v_and_b32 v241, 7, v1
    v_xor_b32 v240, v240, v241
    v_lshlrev_b32 v240, 4, v240
    v_lshrrev_b32 v241, 3, v1
    v_lshlrev_b32 v241, 12, v241
    s_waitcnt lgkmcnt(4)
    v_mfma_f32_32x32x16_bf16 v[80:95], v[52:55], v[108:111], v[80:95]
    ds_read_b64_tr_b16 v[48:49], v13 offset:12288
    ds_read_b64_tr_b16 v[50:51], v13 offset:12800
    v_add_u32 v244, v240, v241
    v_xor_b32 v245, 64, v244
    v_add_u32 v246, 63488, v244
    v_add_u32 v247, 95232, v245
    v_add_u32 v245, 31744, v245
    s_lshl_b32 s46, s41, 19
    s_waitcnt lgkmcnt(4)
    v_mfma_f32_32x32x16_bf16 v[80:95], v[40:43], v[112:115], v[80:95]
    ds_read_b64_tr_b16 v[52:53], v13 offset:14336
    ds_read_b64_tr_b16 v[54:55], v13 offset:14848
    s_lshl_b32 s43, s49, 17
    s_add_u32 s46, s46, s43
    s_lshl_b32 s53, s49, 12
    s_add_u32 s53, s53, 36864
    s_mov_b32 s12, s32
    s_and_b32 s13, s33, 0xffff
    s_waitcnt lgkmcnt(4)
    v_mfma_f32_32x32x16_bf16 v[80:95], v[44:47], v[116:119], v[80:95]
    ds_read_b64_tr_b16 v[40:41], v13 offset:16384
    ds_read_b64_tr_b16 v[42:43], v13 offset:16896
    s_mov_b32 s14, 8388608
    s_mov_b32 s15, 0x20000
    s_mov_b32 s8, s28
    s_and_b32 s9, s29, 0xffff
    s_mov_b32 s10, 51380224
    s_mov_b32 s11, 0x20000
    s_waitcnt lgkmcnt(4)
    v_mfma_f32_32x32x16_bf16 v[80:95], v[48:51], v[120:123], v[80:95]
    ds_read_b64_tr_b16 v[44:45], v13 offset:18432
    ds_read_b64_tr_b16 v[46:47], v13 offset:18944
    v_lshlrev_b32 v248, 4, v1
    v_add_u32 v249, 64512, v248
    s_lshl_b32 s45, s42, 3
    s_lshl_b32 s47, s49, 1
    s_add_u32 s47, s47, s45
    s_mul_i32 s47, s47, 66560
    s_waitcnt lgkmcnt(4)
    v_mfma_f32_32x32x16_bf16 v[80:95], v[52:55], v[124:127], v[80:95]
    ds_read_b64_tr_b16 v[48:49], v13 offset:20480
    ds_read_b64_tr_b16 v[50:51], v13 offset:20992
    s_add_u32 s54, s53, 16384
    v_bfe_u32 v241, v1, 4, 1
    v_lshlrev_b32 v241, 1, v241
    v_xor_b32 v251, v241, v1
    v_lshlrev_b32 v251, 4, v251
    v_lshrrev_b32 v241, 5, v1
    s_waitcnt lgkmcnt(4)
    v_mfma_f32_32x32x16_bf16 v[80:95], v[40:43], v[128:131], v[80:95]
    ds_read_b64_tr_b16 v[52:53], v13 offset:22528
    ds_read_b64_tr_b16 v[54:55], v13 offset:23040
    v_lshlrev_b32 v241, 30, v241
    v_lshlrev_b32 v240, 4, v1
    v_add_u32 v240, v240, v241
    s_add_u32 s43, s42, 128
    s_mul_i32 s43, s43, 66560
    s_mul_i32 s50, s42, 294912
    s_waitcnt lgkmcnt(4)
    v_mfma_f32_32x32x16_bf16 v[80:95], v[44:47], v[132:135], v[80:95]
    ds_read_b64_tr_b16 v[40:41], v13 offset:24576
    ds_read_b64_tr_b16 v[42:43], v13 offset:25088
    s_add_u32 s50, s50, 33554432
    s_and_b32 s44, s41, 1
    s_lshl_b32 s45, s44, 10
    s_mul_i32 s44, s44, 1024
    s_add_u32 s44, s44, 2048
    s_cmp_eq_u32 s49, 2
    s_cselect_b32 s45, s44, s45
    s_cselect_b64 vcc, -1, 0
    v_cndmask_b32 v250, v248, v251, vcc
    s_cmp_eq_u32 s49, 3
    s_cselect_b32 s45, 4096, s45
    s_cselect_b64 vcc, -1, 0
    v_cndmask_b32 v250, v250, v240, vcc
    s_waitcnt lgkmcnt(4)
    v_mfma_f32_32x32x16_bf16 v[80:95], v[48:51], v[136:139], v[80:95]
    ds_read_b64_tr_b16 v[44:45], v13 offset:26624
    ds_read_b64_tr_b16 v[46:47], v13 offset:27136
    s_add_u32 s50, s50, s45
    s_mov_b32 s52, 9216
    s_mov_b32 s45, 3584
    s_cmp_eq_u32 s49, 0
    s_cselect_b32 s50, s43, s50
    s_cselect_b32 s52, 2048, s52
    s_cselect_b32 s45, 0, s45
    s_waitcnt lgkmcnt(4)
    v_mfma_f32_32x32x16_bf16 v[80:95], v[52:55], v[140:143], v[80:95]
    ds_read_b64_tr_b16 v[48:49], v13 offset:28672
    ds_read_b64_tr_b16 v[50:51], v13 offset:29184
    v_add_u32 v251, s45, v250
    s_lshl_b32 s55, s49, 11
    s_add_u32 s55, s55, 69632
    s_add_u32 s45, s55, 128
    s_cmp_eq_u32 s49, 3
    s_cselect_b32 s55, s45, s55
    s_waitcnt lgkmcnt(4)
    v_mfma_f32_32x32x16_bf16 v[80:95], v[40:43], v[144:147], v[80:95]
    ds_read_b64_tr_b16 v[52:53], v13 offset:30720
    ds_read_b64_tr_b16 v[54:55], v13 offset:31232
    s_add_u32 s46, s46, 256
    s_add_u32 s47, s47, 4096
    s_lshl_b32 s43, s52, 1
    s_add_u32 s50, s50, s43
    s_mov_b32 s16, s34
    s_and_b32 s17, s35, 0xffff
    s_waitcnt lgkmcnt(4)
    v_mfma_f32_32x32x16_bf16 v[80:95], v[44:47], v[148:151], v[80:95]
    ds_read_b64_tr_b16 v[40:41], v13 offset:32768
    ds_read_b64_tr_b16 v[42:43], v13 offset:33280
    s_mov_b32 s18, 4096
    s_mov_b32 s19, 0x20000
    s_and_b32 s62, s49, 1
    s_lshr_b32 s63, s49, 1
    s_lshl_b32 s43, s41, 3
    s_lshl_b32 s44, s62, 2
    s_waitcnt lgkmcnt(4)
    v_mfma_f32_32x32x16_bf16 v[80:95], v[48:51], v[152:155], v[80:95]
    ds_read_b64_tr_b16 v[44:45], v13 offset:34816
    ds_read_b64_tr_b16 v[46:47], v13 offset:35328
    s_add_u32 s43, s43, s44
    s_lshl_b32 s44, s63, 1
    s_add_u32 s60, s43, s44
    s_sub_u32 s61, s43, s44
    s_add_u32 s61, s61, 2
    v_and_b32 v240, 15, v1
    s_waitcnt lgkmcnt(4)
    v_mfma_f32_32x32x16_bf16 v[80:95], v[52:55], v[156:159], v[80:95]
    v_add_u32 v13, 0, v10
    ds_read_b64_tr_b16 v[48:49], v13 offset:0
    ds_read_b64_tr_b16 v[50:51], v13 offset:512
    v_lshlrev_b32 v240, 1, v240
    s_lshl_b32 s43, s60, 5
    s_lshl_b32 s44, s61, 5
    buffer_load_ushort v252, v240, s[16:19], s43 offen offset:0
    buffer_load_ushort v253, v240, s[16:19], s43 offen offset:32
    buffer_load_ushort v254, v240, s[16:19], s44 offen offset:0
    s_waitcnt lgkmcnt(4)
    v_mfma_f32_32x32x16_bf16 v[80:95], v[40:43], v[160:163], v[80:95]
    ds_read_b64_tr_b16 v[52:53], v13 offset:2048
    ds_read_b64_tr_b16 v[54:55], v13 offset:2560
    buffer_load_ushort v255, v240, s[16:19], s44 offen offset:32
    v_and_b32 v240, 15, v1
    v_lshrrev_b32 v241, 1, v240
    v_lshrrev_b32 v242, 4, v1
    v_xor_b32 v241, v241, v242
    v_lshlrev_b32 v241, 4, v241
    s_waitcnt lgkmcnt(4)
    v_mfma_f32_32x32x16_bf16 v[80:95], v[44:47], v[164:167], v[80:95]
    ds_read_b64_tr_b16 v[40:41], v13 offset:4096
    ds_read_b64_tr_b16 v[42:43], v13 offset:4608
    v_lshlrev_b32 v240, 7, v240
    v_add_u32 v240, v240, v241
    s_lshl_b32 s43, s62, 13
    s_add_u32 s43, s43, 36864
    s_lshl_b32 s44, s63, 12
    s_add_u32 s45, s43, s44
    s_waitcnt lgkmcnt(4)
    v_mfma_f32_32x32x16_bf16 v[80:95], v[48:51], v[168:171], v[80:95]
    ds_read_b64_tr_b16 v[44:45], v13 offset:6144
    ds_read_b64_tr_b16 v[46:47], v13 offset:6656
    v_add_u32 v56, s45, v240
    s_sub_u32 s45, s43, s44
    s_add_u32 s45, s45, 4096
    v_add_u32 v57, s45, v240
    v_xor_b32 v58, 64, v56
    v_xor_b32 v59, 64, v57
    s_waitcnt lgkmcnt(4)
    v_mfma_f32_32x32x16_bf16 v[80:95], v[52:55], v[172:175], v[80:95]
    ds_read_b64_tr_b16 v[48:49], v13 offset:8192
    ds_read_b64_tr_b16 v[50:51], v13 offset:8704
    v_lshlrev_b32 v240, 3, v1
    s_lshl_b32 s43, s63, 13
    s_add_u32 s43, s43, 53248
    v_add_u32 v68, s43, v240
    v_add_u32 v69, 69632, v240
    v_add_u32 v60, 41216, v56
    s_waitcnt lgkmcnt(4)
    v_mfma_f32_32x32x16_bf16 v[80:95], v[40:43], v[176:179], v[80:95]
    ds_read_b64_tr_b16 v[52:53], v13 offset:10240
    ds_read_b64_tr_b16 v[54:55], v13 offset:10752
    v_add_u32 v61, 41216, v57
    v_add_u32 v62, 41216, v58
    v_add_u32 v63, 41216, v59
    v_add_u32 v70, 41216, v68
    v_add_u32 v71, 41216, v69
    v_add_u32 v64, 82432, v56
    s_waitcnt lgkmcnt(4)
    v_mfma_f32_32x32x16_bf16 v[80:95], v[44:47], v[180:183], v[80:95]
    ds_read_b64_tr_b16 v[40:41], v13 offset:12288
    ds_read_b64_tr_b16 v[42:43], v13 offset:12800
    v_add_u32 v65, 82432, v57
    v_add_u32 v66, 82432, v58
    v_add_u32 v67, 82432, v59
    v_add_u32 v72, 82432, v68
    v_add_u32 v73, 82432, v69
    s_lshl_b32 s45, s42, 2
    s_waitcnt lgkmcnt(4)
    v_mfma_f32_32x32x16_bf16 v[80:95], v[48:51], v[184:187], v[80:95]
    ds_read_b64_tr_b16 v[44:45], v13 offset:14336
    ds_read_b64_tr_b16 v[46:47], v13 offset:14848
    s_lshl_b32 s64, s63, 1
    s_add_u32 s45, s45, s64
    s_lshl_b32 s45, s45, 10
    v_lshlrev_b32 v240, 4, v1
    v_add_u32 v74, s45, v240
    s_and_b32 s64, s42, 1
    s_waitcnt lgkmcnt(4)
    v_mfma_f32_32x32x16_bf16 v[80:95], v[52:55], v[188:191], v[80:95]
    ds_read_b64_tr_b16 v[48:49], v13 offset:16384
    ds_read_b64_tr_b16 v[50:51], v13 offset:16896
    s_lshl_b32 s64, s64, 3
    s_lshr_b32 s43, s42, 1
    s_add_u32 s43, s43, 64
    s_lshl_b32 s43, s43, 10
    s_add_u32 s43, s43, s64
    v_add_u32 v75, s43, v240
    s_waitcnt lgkmcnt(4)
    v_mfma_f32_32x32x16_bf16 v[80:95], v[40:43], v[192:195], v[80:95]
    ds_read_b64_tr_b16 v[52:53], v13 offset:18432
    ds_read_b64_tr_b16 v[54:55], v13 offset:18944
    s_mul_i32 s64, s60, 73728
    s_add_u32 s64, s64, 10485760
    s_add_u32 s65, s64, 73728
    s_mul_i32 s66, s61, 73728
    s_add_u32 s66, s66, 10485760
    s_add_u32 s67, s66, 73728
    s_waitcnt lgkmcnt(4)
    v_mfma_f32_32x32x16_bf16 v[80:95], v[44:47], v[196:199], v[80:95]
    ds_read_b64_tr_b16 v[40:41], v13 offset:20480
    ds_read_b64_tr_b16 v[42:43], v13 offset:20992
    s_mul_i32 s68, s60, 92160
    s_add_u32 s68, s68, 20971520
    s_add_u32 s69, s68, 92160
    s_mul_i32 s56, s61, 92160
    s_add_u32 s56, s56, 20971520
    s_add_u32 s57, s56, 92160
    s_waitcnt lgkmcnt(4)
    v_mfma_f32_32x32x16_bf16 v[80:95], v[48:51], v[200:203], v[80:95]
    ds_read_b64_tr_b16 v[44:45], v13 offset:22528
    ds_read_b64_tr_b16 v[46:47], v13 offset:23040
    s_lshl_b32 s43, s41, 7
    s_lshl_b32 s44, s42, 3
    s_add_u32 s43, s43, s44
    s_lshl_b32 s44, s49, 1
    s_add_u32 s43, s43, s44
    v_and_b32 v240, 1, v1
    s_waitcnt lgkmcnt(4)
    v_mfma_f32_32x32x16_bf16 v[80:95], v[52:55], v[204:207], v[80:95]
    ds_read_b64_tr_b16 v[48:49], v13 offset:24576
    ds_read_b64_tr_b16 v[50:51], v13 offset:25088
    v_add_u32 v240, s43, v240
    v_lshlrev_b32 v240, 12, v240
    v_lshrrev_b32 v241, 1, v1
    v_lshlrev_b32 v241, 7, v241
    v_add_u32 v240, v240, v241
    v_mov_b32 v241, 0x7f000000
    v_cmp_gt_u32 vcc, 6, v1
    s_mov_b32 s58, 768
    s_nop 0
    v_cndmask_b32 v76, v241, v240, vcc
    s_waitcnt lgkmcnt(4)
    v_mfma_f32_32x32x16_bf16 v[80:95], v[40:43], v[208:211], v[80:95]
    ds_read_b64_tr_b16 v[52:53], v13 offset:26624
    ds_read_b64_tr_b16 v[54:55], v13 offset:27136
    s_waitcnt lgkmcnt(4)
    v_mfma_f32_32x32x16_bf16 v[80:95], v[44:47], v[212:215], v[80:95]
    ds_read_b64_tr_b16 v[40:41], v13 offset:28672
    ds_read_b64_tr_b16 v[42:43], v13 offset:29184
    s_waitcnt lgkmcnt(4)
    v_mfma_f32_32x32x16_bf16 v[80:95], v[48:51], v[216:219], v[80:95]
    ds_read_b64_tr_b16 v[44:45], v13 offset:30720
    ds_read_b64_tr_b16 v[46:47], v13 offset:31232
    s_waitcnt lgkmcnt(4)
    v_mfma_f32_32x32x16_bf16 v[80:95], v[52:55], v[220:223], v[80:95]
    ds_read_b64_tr_b16 v[48:49], v13 offset:32768
    ds_read_b64_tr_b16 v[50:51], v13 offset:33280
    s_waitcnt lgkmcnt(4)
    v_mfma_f32_32x32x16_bf16 v[80:95], v[40:43], v[224:227], v[80:95]
    ds_read_b64_tr_b16 v[52:53], v13 offset:34816
    ds_read_b64_tr_b16 v[54:55], v13 offset:35328
    s_waitcnt lgkmcnt(0)
    s_barrier
    v_mfma_f32_32x32x16_bf16 v[80:95], v[44:47], v[228:231], v[80:95]
    v_mfma_f32_32x32x16_bf16 v[80:95], v[48:51], v[232:235], v[80:95]
    v_mfma_f32_32x32x16_bf16 v[80:95], v[52:55], v[236:239], v[80:95]
    s_setprio 0
    s_nop 10
    v_mul_f32 v20, v80, v80
    v_mul_f32 v21, v81, v81
    v_mul_f32 v22, v82, v82
    v_mul_f32 v23, v83, v83
    v_fma_f32 v20, v20, v0, v17
    v_fma_f32 v21, v21, v0, v17
    v_fma_f32 v22, v22, v0, v17
    v_fma_f32 v23, v23, v0, v17
    v_mul_f32 v20, v20, v80
    v_mul_f32 v21, v21, v81
    v_mul_f32 v22, v22, v82
    v_mul_f32 v23, v23, v83
    v_exp_f32 v20, v20
    v_exp_f32 v21, v21
    v_exp_f32 v22, v22
    v_exp_f32 v23, v23
    v_fma_f32 v20, v20, v2, v2
    v_fma_f32 v21, v21, v2, v2
    v_fma_f32 v22, v22, v2, v2
    v_fma_f32 v23, v23, v2, v2
    v_rcp_f32 v20, v20
    v_rcp_f32 v21, v21
    v_rcp_f32 v22, v22
    v_rcp_f32 v23, v23
    v_mul_f32 v80, v80, v20
    v_mul_f32 v81, v81, v21
    v_mul_f32 v82, v82, v22
    v_mul_f32 v83, v83, v23
    v_cvt_pk_bf16_f32 v28, v80, v81
    v_cvt_pk_bf16_f32 v29, v82, v83
    v_mul_f32 v24, v88, v88
    v_mul_f32 v25, v89, v89
    v_mul_f32 v26, v90, v90
    v_mul_f32 v27, v91, v91
    v_fma_f32 v24, v24, v0, v17
    v_fma_f32 v25, v25, v0, v17
    v_fma_f32 v26, v26, v0, v17
    v_fma_f32 v27, v27, v0, v17
    v_mul_f32 v24, v24, v88
    v_mul_f32 v25, v25, v89
    v_mul_f32 v26, v26, v90
    v_mul_f32 v27, v27, v91
    v_exp_f32 v24, v24
    v_exp_f32 v25, v25
    v_exp_f32 v26, v26
    v_exp_f32 v27, v27
    v_fma_f32 v24, v24, v2, v2
    v_fma_f32 v25, v25, v2, v2
    v_fma_f32 v26, v26, v2, v2
    v_fma_f32 v27, v27, v2, v2
    v_rcp_f32 v24, v24
    v_rcp_f32 v25, v25
    v_rcp_f32 v26, v26
    v_rcp_f32 v27, v27
    v_mul_f32 v88, v88, v24
    v_mul_f32 v89, v89, v25
    v_mul_f32 v90, v90, v26
    v_mul_f32 v91, v91, v27
    v_cvt_pk_bf16_f32 v30, v88, v89
    v_cvt_pk_bf16_f32 v31, v90, v91
    buffer_store_dwordx4 v[28:31], v15, s[20:23], s70 offen offset:0
    v_mul_f32 v20, v84, v84
    v_mul_f32 v21, v85, v85
    v_mul_f32 v22, v86, v86
    v_mul_f32 v23, v87, v87
    v_fma_f32 v20, v20, v0, v17
    v_fma_f32 v21, v21, v0, v17
    v_fma_f32 v22, v22, v0, v17
    v_fma_f32 v23, v23, v0, v17
    v_mul_f32 v20, v20, v84
    v_mul_f32 v21, v21, v85
    v_mul_f32 v22, v22, v86
    v_mul_f32 v23, v23, v87
    v_exp_f32 v20, v20
    v_exp_f32 v21, v21
    v_exp_f32 v22, v22
    v_exp_f32 v23, v23
    v_fma_f32 v20, v20, v2, v2
    v_fma_f32 v21, v21, v2, v2
    v_fma_f32 v22, v22, v2, v2
    v_fma_f32 v23, v23, v2, v2
    v_rcp_f32 v20, v20
    v_rcp_f32 v21, v21
    v_rcp_f32 v22, v22
    v_rcp_f32 v23, v23
    v_mul_f32 v84, v84, v20
    v_mul_f32 v85, v85, v21
    v_mul_f32 v86, v86, v22
    v_mul_f32 v87, v87, v23
    v_cvt_pk_bf16_f32 v32, v84, v85
    v_cvt_pk_bf16_f32 v33, v86, v87
    v_mul_f32 v24, v92, v92
    v_mul_f32 v25, v93, v93
    v_mul_f32 v26, v94, v94
    v_mul_f32 v27, v95, v95
    v_fma_f32 v24, v24, v0, v17
    v_fma_f32 v25, v25, v0, v17
    v_fma_f32 v26, v26, v0, v17
    v_fma_f32 v27, v27, v0, v17
    v_mul_f32 v24, v24, v92
    v_mul_f32 v25, v25, v93
    v_mul_f32 v26, v26, v94
    v_mul_f32 v27, v27, v95
    v_exp_f32 v24, v24
    v_exp_f32 v25, v25
    v_exp_f32 v26, v26
    v_exp_f32 v27, v27
    v_fma_f32 v24, v24, v2, v2
    v_fma_f32 v25, v25, v2, v2
    v_fma_f32 v26, v26, v2, v2
    v_fma_f32 v27, v27, v2, v2
    v_rcp_f32 v24, v24
    v_rcp_f32 v25, v25
    v_rcp_f32 v26, v26
    v_rcp_f32 v27, v27
    v_mul_f32 v92, v92, v24
    v_mul_f32 v93, v93, v25
    v_mul_f32 v94, v94, v26
    v_mul_f32 v95, v95, v27
    v_cvt_pk_bf16_f32 v34, v92, v93
    v_cvt_pk_bf16_f32 v35, v94, v95
    buffer_store_dwordx4 v[32:35], v15, s[20:23], s70 offen offset:512
    s_branch L2_gemm
L1_B:
    v_lshrrev_b32 v20, 3, v1
    v_mul_u32_u24 v21, 1152, v20
    v_and_b32 v22, 7, v1
    v_lshlrev_b32 v23, 4, v22
    v_add_u32 v21, v21, v23
    s_add_u32 s70, s40, s42
    s_and_b32 s70, s70, 7
    s_lshl_b32 s43, s41, 7
    s_lshl_b32 s44, s70, 3
    s_add_u32 s43, s43, s44
    s_mul_i32 s43, s43, 1152
    s_add_u32 s44, s43, 73728
    s_mov_b32 s69, s44
    s_lshl_b32 s68, s2, 3
    s_or_b32 s68, s68, s40
    s_cmp_lg_u32 s68, 4
    s_cbranch_scc1 L1_lead0
    v_mov_b32 v244, 46727168
    buffer_load_dword v242, v244, s[20:23], 0 offen sc1
L1_lead0:
    v_mov_b32 v240, v21
    buffer_load_dwordx4 v[204:207], v240, s[8:11], s43 offen offset:0
    buffer_load_dwordx4 v[208:211], v240, s[8:11], s43 offen offset:128
    buffer_load_dwordx4 v[212:215], v240, s[8:11], s43 offen offset:256
    buffer_load_dwordx4 v[216:219], v240, s[8:11], s43 offen offset:384
    buffer_load_dwordx4 v[220:223], v240, s[8:11], s43 offen offset:512
    buffer_load_dwordx4 v[224:227], v240, s[8:11], s43 offen offset:640
    buffer_load_dwordx4 v[228:231], v240, s[8:11], s43 offen offset:768
    buffer_load_dwordx4 v[232:235], v240, s[8:11], s43 offen offset:896
    buffer_load_dwordx4 v[236:239], v240, s[8:11], s43 offen offset:1024
    s_sub_u32 s68, s40, 5
    s_cmp_gt_u32 s68, 0
    s_cbranch_scc1 L1_t0e1
    s_cmp_eq_u32 s68, 0
    s_cbranch_scc0 L1_t0w1
    v_lshlrev_b32 v2, 7, v1
    buffer_load_dword v3, v2, s[8:11], s69 offen
    s_branch L1_t0e1
L1_t0w1:
    s_sub_u32 s67, s68, 1
    s_lshl_b32 s67, s67, 8
    s_add_u32 s67, s67, s2
    s_cmp_lt_u32 s67, 288
    s_cbranch_scc0 L1_t0e1
    s_and_b32 s68, s67, 31
    s_lshr_b32 s67, s67, 5
    s_mul_i32 s67, s67, 589824
    s_lshl_b32 s68, s68, 7
    s_add_u32 s67, s67, s68
    s_add_u32 s67, s67, 4608
    v_mul_u32_u24 v2, 9216, v1
    buffer_load_dword v3, v2, s[12:15], s67 offen
L1_t0e1:
    v_lshrrev_b32 v23, 4, v1
    v_and_b32 v23, 1, v23
    v_lshlrev_b32 v23, 2, v23
    v_xor_b32 v23, v23, v22
    v_lshlrev_b32 v23, 4, v23
    v_mul_u32_u24 v4, 9216, v20
    v_add_u32 v4, v4, v23
    v_mul_u32_u24 v7, 3456, v20
    v_add_u32 v7, v7, v23
    v_lshrrev_b32 v248, 2, v1
    v_mul_u32_u24 v248, 9216, v248
    v_and_b32 v25, 3, v1
    v_lshlrev_b32 v25, 4, v25
    v_add_u32 v248, v248, v25
    s_mul_i32 s53, s46, 9216
    v_add_u32 v5, 72704, v4
    v_add_u32 v8, 26624, v7
    v_add_u32 v249, 146432, v248
    v_add_u32 v6, 145408, v4
    v_add_u32 v9, 53248, v7
    v_add_u32 v250, 292864, v248
    v_lshrrev_b32 v26, 5, v1
    v_bfe_u32 v27, v1, 2, 2
    v_lshlrev_b32 v28, 3, v26
    v_add_u32 v28, v28, v27
    v_bfe_u32 v29, v1, 4, 1
    v_lshlrev_b32 v29, 5, v29
    v_and_b32 v30, 3, v1
    v_lshlrev_b32 v31, 3, v30
    v_and_b32 v32, 1, v1
    v_lshlrev_b32 v32, 4, v32
    v_bfe_u32 v33, v1, 1, 1
    v_lshlrev_b32 v33, 3, v33
    v_add_u32 v32, v32, v33
    v_lshrrev_b32 v33, 1, v27
    v_xor_b32 v33, 0, v33
    v_lshlrev_b32 v33, 6, v33
    v_lshlrev_b32 v34, 7, v28
    v_add3_u32 v34, v34, v33, v29
    v_add_u32 v10, v34, v31
    v_add_u32 v11, v34, v32
    s_bitcmp1_b32 s42, 0
    s_cselect_b64 vcc, -1, 0
    v_cndmask_b32 v31, v32, v31, vcc
    v_lshlrev_b32 v34, 6, v28
    v_add3_u32 v12, v34, v29, v31
    v_and_b32 v27, 31, v1
    v_bfe_u32 v28, v1, 2, 1
    v_lshlrev_b32 v28, 9, v28
    v_bfe_u32 v29, v1, 3, 2
    v_lshlrev_b32 v29, 7, v29
    v_lshlrev_b32 v30, 5, v30
    v_lshlrev_b32 v31, 4, v26
    v_add3_u32 v14, v28, v29, v30
    v_add_u32 v14, v14, v31
    v_bfe_u32 v28, v1, 4, 1
    v_mul_u32_u24 v28, 73728, v28
    v_and_b32 v29, 15, v1
    v_lshlrev_b32 v29, 4, v29
    v_lshlrev_b32 v30, 8, v26
    v_add3_u32 v15, v28, v29, v30
    s_lshl_b32 s43, s41, 2
    s_add_u32 s43, s43, s46
    s_mul_i32 s44, s43, 4608
    v_lshlrev_b32 v28, 3, v27
    v_add_u32 v16, s44, v28
    v_mov_b32 v18, 0
    v_mov_b32 v19, 0
    s_mov_b32 s52, 0xbede652a
    s_lshl_b32 s43, s43, 10
    s_lshl_b32 s44, s42, 3
    s_add_u32 s44, s44, 0
    s_mul_i32 s44, s44, 66560
    s_add_u32 s58, s43, s44
    s_add_u32 s59, s58, 66560
    s_add_u32 s60, s58, 266240
    s_add_u32 s61, s58, 332800
    s_add_u32 s44, s42, 128
    s_mul_i32 s44, s44, 66560
    s_add_u32 s62, s43, s44
    s_add_u32 s63, s62, 66560
    s_lshl_b32 s43, s41, 3
    s_lshl_b32 s44, s46, 1
    s_add_u32 s43, s43, s44
    s_mul_i32 s43, s43, 73728
    s_add_u32 s43, s43, 10485760
    s_lshl_b32 s44, s42, 12
    s_add_u32 s64, s43, s44
    s_add_u32 s64, s64, 0
    s_add_u32 s65, s64, 2048
    s_lshr_b32 s44, s42, 1
    s_add_u32 s44, s44, 64
    s_lshl_b32 s44, s44, 10
    s_add_u32 s66, s43, s44
    s_lshl_b32 s43, s70, 3
    v_add_u32 v36, s43, v20
    v_lshlrev_b32 v38, 2, v36
    v_add_u32 v38, 149504, v38
    s_lshl_b32 s44, s46, 7
    s_add_u32 s44, s44, 149504
    v_lshlrev_b32 v39, 2, v27
    v_add_u32 v39, s44, v39
    v_lshrrev_b32 v37, 1, v36
    v_and_b32 v37, 7, v37
    v_xor_b32 v37, v37, v22
    v_lshlrev_b32 v37, 4, v37
    v_mul_u32_u24 v36, 1152, v36
    s_lshr_b32 s57, s40, 2
    s_mul_i32 s57, s57, 73728
    v_add_u32 v36, v36, v37
    v_add_u32 v37, 73728, v36
    s_and_b32 s43, s46, 1
    s_lshl_b32 s43, s43, 5
    v_add_u32 v28, s43, v27
    v_lshrrev_b32 v29, 1, v28
    v_and_b32 v29, 7, v29
    v_xor_b32 v29, v29, v26
    v_lshlrev_b32 v29, 4, v29
    v_mul_u32_u24 v28, 1152, v28
    v_add3_u32 v28, v28, v29, s57
    v_xor_b32 v29, 32, v28
    v_xor_b32 v30, 64, v28
    v_xor_b32 v31, 96, v28
    s_mov_b32 s45, 0x3ae38e39
    s_mov_b32 s44, 0x3f803f80
    s_mov_b32 s36, 0x3f80
    s_mov_b32 s37, 0x3f800000
    v_mov_b32 v32, 0
    v_mov_b32 v33, 0
    s_waitcnt vmcnt(8)
    v_dot2_f32_bf16 v32, v204, s44, v32
    v_dot2_f32_bf16 v33, v205, s44, v33
    v_dot2_f32_bf16 v32, v206, s44, v32
    v_dot2_f32_bf16 v33, v207, s44, v33
    s_waitcnt vmcnt(7)
    v_dot2_f32_bf16 v32, v208, s44, v32
    v_dot2_f32_bf16 v33, v209, s44, v33
    v_dot2_f32_bf16 v32, v210, s44, v32
    v_dot2_f32_bf16 v33, v211, s44, v33
    s_waitcnt vmcnt(6)
    v_dot2_f32_bf16 v32, v212, s44, v32
    v_dot2_f32_bf16 v33, v213, s44, v33
    v_dot2_f32_bf16 v32, v214, s44, v32
    v_dot2_f32_bf16 v33, v215, s44, v33
    s_waitcnt vmcnt(5)
    v_dot2_f32_bf16 v32, v216, s44, v32
    v_dot2_f32_bf16 v33, v217, s44, v33
    v_dot2_f32_bf16 v32, v218, s44, v32
    v_dot2_f32_bf16 v33, v219, s44, v33
    s_waitcnt vmcnt(4)
    v_dot2_f32_bf16 v32, v220, s44, v32
    v_dot2_f32_bf16 v33, v221, s44, v33
    v_dot2_f32_bf16 v32, v222, s44, v32
    v_dot2_f32_bf16 v33, v223, s44, v33
    s_waitcnt vmcnt(3)
    v_dot2_f32_bf16 v32, v224, s44, v32
    v_dot2_f32_bf16 v33, v225, s44, v33
    v_dot2_f32_bf16 v32, v226, s44, v32
    v_dot2_f32_bf16 v33, v227, s44, v33
    s_waitcnt vmcnt(2)
    v_dot2_f32_bf16 v32, v228, s44, v32
    v_dot2_f32_bf16 v33, v229, s44, v33
    v_dot2_f32_bf16 v32, v230, s44, v32
    v_dot2_f32_bf16 v33, v231, s44, v33
    s_waitcnt vmcnt(1)
    v_dot2_f32_bf16 v32, v232, s44, v32
    v_dot2_f32_bf16 v33, v233, s44, v33
    v_dot2_f32_bf16 v32, v234, s44, v32
    v_dot2_f32_bf16 v33, v235, s44, v33
    s_waitcnt vmcnt(0)
    v_dot2_f32_bf16 v32, v236, s44, v32
    v_dot2_f32_bf16 v33, v237, s44, v33
    v_dot2_f32_bf16 v32, v238, s44, v32
    v_dot2_f32_bf16 v33, v239, s44, v33
    s_nop 2
    v_add_f32 v32, v32, v33
    s_nop 1
    v_add_f32_dpp v32, v32, v32 quad_perm:[1,0,3,2] row_mask:0xf bank_mask:0xf
    s_nop 1
    v_add_f32_dpp v32, v32, v32 quad_perm:[2,3,0,1] row_mask:0xf bank_mask:0xf
    s_nop 1
    v_add_f32_dpp v32, v32, v32 row_half_mirror row_mask:0xf bank_mask:0xf
    v_mul_f32 v32, 0xbae38e39, v32
    s_lshl_b32 s68, s2, 3
    s_or_b32 s68, s68, s40
    s_cmp_lg_u32 s68, 4
    s_cbranch_scc1 L1_lead1
    v_mov_b32 v244, 46727168
    v_add_u32 v242, 1, v242
    v_mov_b32 v243, 1
    v_mov_b32 v245, 0
    s_mov_b64 exec, 1
    buffer_store_dword v242, v244, s[20:23], 0 offen sc1
    global_store_dwordx2 v245, v[242:243], s[30:31] sc1
    s_mov_b64 exec, -1
L1_lead1:
    s_cmp_ge_u32 s40, 4
    s_cbranch_scc1 L1_fx1b
    v_dot2_f32_bf16 v20, v204, s36, v32
    v_dot2_f32_bf16 v21, v204, s37, v32
    v_dot2_f32_bf16 v22, v205, s36, v32
    v_dot2_f32_bf16 v23, v205, s37, v32
    v_dot2_f32_bf16 v24, v206, s36, v32
    v_dot2_f32_bf16 v25, v206, s37, v32
    v_dot2_f32_bf16 v26, v207, s36, v32
    v_dot2_f32_bf16 v27, v207, s37, v32
    v_cvt_pk_bf16_f32 v204, v20, v21
    v_cvt_pk_bf16_f32 v205, v22, v23
    v_cvt_pk_bf16_f32 v206, v24, v25
    v_cvt_pk_bf16_f32 v207, v26, v27
    ds_write_b128 v36, v[204:207] offset:0
    v_dot2_f32_bf16 v20, v208, s36, v32
    v_dot2_f32_bf16 v21, v208, s37, v32
    v_dot2_f32_bf16 v22, v209, s36, v32
    v_dot2_f32_bf16 v23, v209, s37, v32
    v_dot2_f32_bf16 v24, v210, s36, v32
    v_dot2_f32_bf16 v25, v210, s37, v32
    v_dot2_f32_bf16 v26, v211, s36, v32
    v_dot2_f32_bf16 v27, v211, s37, v32
    v_cvt_pk_bf16_f32 v208, v20, v21
    v_cvt_pk_bf16_f32 v209, v22, v23
    v_cvt_pk_bf16_f32 v210, v24, v25
    v_cvt_pk_bf16_f32 v211, v26, v27
    ds_write_b128 v36, v[208:211] offset:128
    v_dot2_f32_bf16 v20, v212, s36, v32
    v_dot2_f32_bf16 v21, v212, s37, v32
    v_dot2_f32_bf16 v22, v213, s36, v32
    v_dot2_f32_bf16 v23, v213, s37, v32
    v_dot2_f32_bf16 v24, v214, s36, v32
    v_dot2_f32_bf16 v25, v214, s37, v32
    v_dot2_f32_bf16 v26, v215, s36, v32
    v_dot2_f32_bf16 v27, v215, s37, v32
    v_cvt_pk_bf16_f32 v212, v20, v21
    v_cvt_pk_bf16_f32 v213, v22, v23
    v_cvt_pk_bf16_f32 v214, v24, v25
    v_cvt_pk_bf16_f32 v215, v26, v27
    ds_write_b128 v36, v[212:215] offset:256
    v_dot2_f32_bf16 v20, v216, s36, v32
    v_dot2_f32_bf16 v21, v216, s37, v32
    v_dot2_f32_bf16 v22, v217, s36, v32
    v_dot2_f32_bf16 v23, v217, s37, v32
    v_dot2_f32_bf16 v24, v218, s36, v32
    v_dot2_f32_bf16 v25, v218, s37, v32
    v_dot2_f32_bf16 v26, v219, s36, v32
    v_dot2_f32_bf16 v27, v219, s37, v32
    v_cvt_pk_bf16_f32 v216, v20, v21
    v_cvt_pk_bf16_f32 v217, v22, v23
    v_cvt_pk_bf16_f32 v218, v24, v25
    v_cvt_pk_bf16_f32 v219, v26, v27
    ds_write_b128 v36, v[216:219] offset:384
    v_dot2_f32_bf16 v20, v220, s36, v32
    v_dot2_f32_bf16 v21, v220, s37, v32
    v_dot2_f32_bf16 v22, v221, s36, v32
    v_dot2_f32_bf16 v23, v221, s37, v32
    v_dot2_f32_bf16 v24, v222, s36, v32
    v_dot2_f32_bf16 v25, v222, s37, v32
    v_dot2_f32_bf16 v26, v223, s36, v32
    v_dot2_f32_bf16 v27, v223, s37, v32
    v_cvt_pk_bf16_f32 v220, v20, v21
    v_cvt_pk_bf16_f32 v221, v22, v23
    v_cvt_pk_bf16_f32 v222, v24, v25
    v_cvt_pk_bf16_f32 v223, v26, v27
    ds_write_b128 v36, v[220:223] offset:512
    v_dot2_f32_bf16 v20, v224, s36, v32
    v_dot2_f32_bf16 v21, v224, s37, v32
    v_dot2_f32_bf16 v22, v225, s36, v32
    v_dot2_f32_bf16 v23, v225, s37, v32
    v_dot2_f32_bf16 v24, v226, s36, v32
    v_dot2_f32_bf16 v25, v226, s37, v32
    v_dot2_f32_bf16 v26, v227, s36, v32
    v_dot2_f32_bf16 v27, v227, s37, v32
    v_cvt_pk_bf16_f32 v224, v20, v21
    v_cvt_pk_bf16_f32 v225, v22, v23
    v_cvt_pk_bf16_f32 v226, v24, v25
    v_cvt_pk_bf16_f32 v227, v26, v27
    ds_write_b128 v36, v[224:227] offset:640
    v_dot2_f32_bf16 v20, v228, s36, v32
    v_dot2_f32_bf16 v21, v228, s37, v32
    v_dot2_f32_bf16 v22, v229, s36, v32
    buffer_load_dwordx4 v[56:59], v240, s[8:11], s69 offen offset:0
    v_dot2_f32_bf16 v23, v229, s37, v32
    v_dot2_f32_bf16 v24, v230, s36, v32
    v_dot2_f32_bf16 v25, v230, s37, v32
    v_dot2_f32_bf16 v26, v231, s36, v32
    v_dot2_f32_bf16 v27, v231, s37, v32
    buffer_load_dwordx4 v[60:63], v240, s[8:11], s69 offen offset:128
    v_cvt_pk_bf16_f32 v228, v20, v21
    v_cvt_pk_bf16_f32 v229, v22, v23
    v_cvt_pk_bf16_f32 v230, v24, v25
    v_cvt_pk_bf16_f32 v231, v26, v27
    buffer_load_dwordx4 v[64:67], v240, s[8:11], s69 offen offset:256
    ds_write_b128 v36, v[228:231] offset:768
    v_dot2_f32_bf16 v20, v232, s36, v32
    v_dot2_f32_bf16 v21, v232, s37, v32
    v_dot2_f32_bf16 v22, v233, s36, v32
    v_dot2_f32_bf16 v23, v233, s37, v32
    buffer_load_dwordx4 v[68:71], v240, s[8:11], s69 offen offset:384
    v_dot2_f32_bf16 v24, v234, s36, v32
    v_dot2_f32_bf16 v25, v234, s37, v32
    v_dot2_f32_bf16 v26, v235, s36, v32
    v_dot2_f32_bf16 v27, v235, s37, v32
    buffer_load_dwordx4 v[72:75], v240, s[8:11], s69 offen offset:512
    v_cvt_pk_bf16_f32 v232, v20, v21
    v_cvt_pk_bf16_f32 v233, v22, v23
    v_cvt_pk_bf16_f32 v234, v24, v25
    v_cvt_pk_bf16_f32 v235, v26, v27
    ds_write_b128 v36, v[232:235] offset:896
    buffer_load_dwordx4 v[76:79], v240, s[8:11], s69 offen offset:640
    v_dot2_f32_bf16 v20, v236, s36, v32
    v_dot2_f32_bf16 v21, v236, s37, v32
    v_dot2_f32_bf16 v22, v237, s36, v32
    v_dot2_f32_bf16 v23, v237, s37, v32
    buffer_load_dwordx4 v[80:83], v240, s[8:11], s69 offen offset:768
    v_dot2_f32_bf16 v24, v238, s36, v32
    v_dot2_f32_bf16 v25, v238, s37, v32
    v_dot2_f32_bf16 v26, v239, s36, v32
    v_dot2_f32_bf16 v27, v239, s37, v32
    v_cvt_pk_bf16_f32 v236, v20, v21
    buffer_load_dwordx4 v[84:87], v240, s[8:11], s69 offen offset:896
    v_cvt_pk_bf16_f32 v237, v22, v23
    v_cvt_pk_bf16_f32 v238, v24, v25
    v_cvt_pk_bf16_f32 v239, v26, v27
    ds_write_b128 v36, v[236:239] offset:1024
    buffer_load_dwordx4 v[88:91], v240, s[8:11], s69 offen offset:1024
    s_lshl_b32 s67, s40, 8
    s_add_u32 s67, s67, s2
    s_and_b32 s68, s67, 31
    s_lshr_b32 s43, s67, 5
    s_mul_i32 s43, s43, 589824
    s_lshl_b32 s68, s68, 7
    s_add_u32 s43, s43, s68
    s_add_u32 s43, s43, 4608
    s_cmp_lt_u32 s67, 288
    s_cselect_b32 s43, s43, 0x7f000000
    v_mul_u32_u24 v2, 9216, v1
    buffer_load_dword v3, v2, s[12:15], s43 offen
    v_mov_b32 v34, 0
    v_mov_b32 v35, 0
    v_dot2_f32_bf16 v34, v204, v204, v34
    v_dot2_f32_bf16 v35, v205, v205, v35
    v_dot2_f32_bf16 v34, v206, v206, v34
    v_dot2_f32_bf16 v35, v207, v207, v35
    v_dot2_f32_bf16 v34, v208, v208, v34
    v_dot2_f32_bf16 v35, v209, v209, v35
    v_dot2_f32_bf16 v34, v210, v210, v34
    v_dot2_f32_bf16 v35, v211, v211, v35
    v_dot2_f32_bf16 v34, v212, v212, v34
    v_dot2_f32_bf16 v35, v213, v213, v35
    v_dot2_f32_bf16 v34, v214, v214, v34
    v_dot2_f32_bf16 v35, v215, v215, v35
    v_dot2_f32_bf16 v34, v216, v216, v34
    v_dot2_f32_bf16 v35, v217, v217, v35
    v_dot2_f32_bf16 v34, v218, v218, v34
    v_dot2_f32_bf16 v35, v219, v219, v35
    v_dot2_f32_bf16 v34, v220, v220, v34
    v_dot2_f32_bf16 v35, v221, v221, v35
    v_dot2_f32_bf16 v34, v222, v222, v34
    v_dot2_f32_bf16 v35, v223, v223, v35
    v_dot2_f32_bf16 v34, v224, v224, v34
    v_dot2_f32_bf16 v35, v225, v225, v35
    v_dot2_f32_bf16 v34, v226, v226, v34
    v_dot2_f32_bf16 v35, v227, v227, v35
    v_dot2_f32_bf16 v34, v228, v228, v34
    v_dot2_f32_bf16 v35, v229, v229, v35
    v_dot2_f32_bf16 v34, v230, v230, v34
    v_dot2_f32_bf16 v35, v231, v231, v35
    v_dot2_f32_bf16 v34, v232, v232, v34
    v_dot2_f32_bf16 v35, v233, v233, v35
    v_dot2_f32_bf16 v34, v234, v234, v34
    v_dot2_f32_bf16 v35, v235, v235, v35
    v_dot2_f32_bf16 v34, v236, v236, v34
    v_dot2_f32_bf16 v35, v237, v237, v35
    v_dot2_f32_bf16 v34, v238, v238, v34
    v_dot2_f32_bf16 v35, v239, v239, v35
    s_nop 2
    v_add_f32 v34, v34, v35
    s_nop 1
    v_add_f32_dpp v34, v34, v34 quad_perm:[1,0,3,2] row_mask:0xf bank_mask:0xf
    s_nop 1
    v_add_f32_dpp v34, v34, v34 quad_perm:[2,3,0,1] row_mask:0xf bank_mask:0xf
    s_nop 1
    v_add_f32_dpp v34, v34, v34 row_half_mirror row_mask:0xf bank_mask:0xf
    v_mul_f32 v34, s45, v34
    v_add_f32 v34, 0x3727c5ac, v34
    v_sqrt_f32 v34, v34
    s_nop 0
    ds_write_b32 v38, v34 offset:0
    s_waitcnt lgkmcnt(0)
    s_barrier
    v_mov_b32 v32, 0
    v_mov_b32 v33, 0
    ds_read_b128 v[96:99], v28 offset:0
    s_waitcnt vmcnt(9)
    ds_read_b128 v[100:103], v29 offset:0
    v_dot2_f32_bf16 v32, v56, s44, v32
    v_dot2_f32_bf16 v33, v57, s44, v33
    ds_read_b128 v[104:107], v30 offset:0
    v_dot2_f32_bf16 v32, v58, s44, v32
    ds_read_b128 v[108:111], v31 offset:0
    v_dot2_f32_bf16 v33, v59, s44, v33
    ds_read_b128 v[112:115], v28 offset:128
    s_waitcnt vmcnt(8)
    v_dot2_f32_bf16 v32, v60, s44, v32
    ds_read_b128 v[116:119], v29 offset:128
    v_dot2_f32_bf16 v33, v61, s44, v33
    ds_read_b128 v[120:123], v30 offset:128
    v_dot2_f32_bf16 v32, v62, s44, v32
    v_dot2_f32_bf16 v33, v63, s44, v33
    ds_read_b128 v[124:127], v31 offset:128
    s_waitcnt vmcnt(7)
    ds_read_b128 v[128:131], v28 offset:256
    v_dot2_f32_bf16 v32, v64, s44, v32
    ds_read_b128 v[132:135], v29 offset:256
    v_dot2_f32_bf16 v33, v65, s44, v33
    v_dot2_f32_bf16 v32, v66, s44, v32
    ds_read_b128 v[136:139], v30 offset:256
    v_dot2_f32_bf16 v33, v67, s44, v33
    ds_read_b128 v[140:143], v31 offset:256
    s_waitcnt vmcnt(6)
    v_dot2_f32_bf16 v32, v68, s44, v32
    ds_read_b128 v[144:147], v28 offset:384
    v_dot2_f32_bf16 v33, v69, s44, v33
    ds_read_b128 v[148:151], v29 offset:384
    v_dot2_f32_bf16 v32, v70, s44, v32
    ds_read_b128 v[152:155], v30 offset:384
    v_dot2_f32_bf16 v33, v71, s44, v33
    s_waitcnt vmcnt(5)
    ds_read_b128 v[156:159], v31 offset:384
    v_dot2_f32_bf16 v32, v72, s44, v32
    ds_read_b128 v[160:163], v28 offset:512
    v_dot2_f32_bf16 v33, v73, s44, v33
    ds_read_b128 v[164:167], v29 offset:512
    v_dot2_f32_bf16 v32, v74, s44, v32
    v_dot2_f32_bf16 v33, v75, s44, v33
    ds_read_b128 v[168:171], v30 offset:512
    s_waitcnt vmcnt(4)
    ds_read_b128 v[172:175], v31 offset:512
    v_dot2_f32_bf16 v32, v76, s44, v32
    v_dot2_f32_bf16 v33, v77, s44, v33
    ds_read_b128 v[176:179], v28 offset:640
    v_dot2_f32_bf16 v32, v78, s44, v32
    ds_read_b128 v[180:183], v29 offset:640
    v_dot2_f32_bf16 v33, v79, s44, v33
    ds_read_b128 v[184:187], v30 offset:640
    s_waitcnt vmcnt(3)
    v_dot2_f32_bf16 v32, v80, s44, v32
    ds_read_b128 v[188:191], v31 offset:640
    v_dot2_f32_bf16 v33, v81, s44, v33
    ds_read_b128 v[192:195], v28 offset:768
    v_dot2_f32_bf16 v32, v82, s44, v32
    v_dot2_f32_bf16 v33, v83, s44, v33
    ds_read_b128 v[196:199], v29 offset:768
    s_waitcnt vmcnt(2)
    ds_read_b128 v[200:203], v30 offset:768
    v_dot2_f32_bf16 v32, v84, s44, v32
    ds_read_b128 v[204:207], v31 offset:768
    v_dot2_f32_bf16 v33, v85, s44, v33
    v_dot2_f32_bf16 v32, v86, s44, v32
    ds_read_b128 v[208:211], v28 offset:896
    v_dot2_f32_bf16 v33, v87, s44, v33
    ds_read_b128 v[212:215], v29 offset:896
    s_waitcnt vmcnt(1)
    v_dot2_f32_bf16 v32, v88, s44, v32
    ds_read_b128 v[216:219], v30 offset:896
    v_dot2_f32_bf16 v33, v89, s44, v33
    ds_read_b128 v[220:223], v31 offset:896
    v_dot2_f32_bf16 v32, v90, s44, v32
    ds_read_b128 v[224:227], v28 offset:1024
    v_dot2_f32_bf16 v33, v91, s44, v33
    s_nop 2
    v_add_f32 v32, v32, v33
    ds_read_b128 v[228:231], v29 offset:1024
    s_nop 0
    v_add_f32_dpp v32, v32, v32 quad_perm:[1,0,3,2] row_mask:0xf bank_mask:0xf
    ds_read_b128 v[232:235], v30 offset:1024
    s_nop 0
    v_add_f32_dpp v32, v32, v32 quad_perm:[2,3,0,1] row_mask:0xf bank_mask:0xf
    ds_read_b128 v[236:239], v31 offset:1024
    s_nop 0
    v_add_f32_dpp v32, v32, v32 row_half_mirror row_mask:0xf bank_mask:0xf
    v_mul_f32 v32, 0xbae38e39, v32
    v_dot2_f32_bf16 v20, v56, s36, v32
    v_dot2_f32_bf16 v21, v56, s37, v32
    v_dot2_f32_bf16 v22, v57, s36, v32
    v_dot2_f32_bf16 v23, v57, s37, v32
    v_dot2_f32_bf16 v24, v58, s36, v32
    v_dot2_f32_bf16 v25, v58, s37, v32
    v_dot2_f32_bf16 v26, v59, s36, v32
    v_dot2_f32_bf16 v27, v59, s37, v32
    v_cvt_pk_bf16_f32 v56, v20, v21
    v_cvt_pk_bf16_f32 v57, v22, v23
    v_cvt_pk_bf16_f32 v58, v24, v25
    v_cvt_pk_bf16_f32 v59, v26, v27
    ds_write_b128 v37, v[56:59] offset:0
    v_dot2_f32_bf16 v20, v60, s36, v32
    v_dot2_f32_bf16 v21, v60, s37, v32
    v_dot2_f32_bf16 v22, v61, s36, v32
    v_dot2_f32_bf16 v23, v61, s37, v32
    v_dot2_f32_bf16 v24, v62, s36, v32
    v_dot2_f32_bf16 v25, v62, s37, v32
    v_dot2_f32_bf16 v26, v63, s36, v32
    v_dot2_f32_bf16 v27, v63, s37, v32
    v_cvt_pk_bf16_f32 v60, v20, v21
    v_cvt_pk_bf16_f32 v61, v22, v23
    v_cvt_pk_bf16_f32 v62, v24, v25
    v_cvt_pk_bf16_f32 v63, v26, v27
    ds_write_b128 v37, v[60:63] offset:128
    s_waitcnt lgkmcnt(2)
    s_barrier
    s_mul_i32 s57, s40, 9216
    s_mul_i32 s56, s40, 663552
    s_add_u32 s56, s56, s49
    s_add_u32 m0, s57, 0
    s_add_u32 s56, s56, 0
    buffer_load_dwordx4 v4, s[12:15], s56 offen offset:0 lds
    buffer_load_dwordx4 v5, s[12:15], s56 offen offset:1024 lds
    buffer_load_dwordx4 v6, s[12:15], s56 offen offset:2048 lds
    s_add_u32 m0, s57, 3072
    s_add_u32 s56, s56, 221184
    buffer_load_dwordx4 v4, s[12:15], s56 offen offset:0 lds
    buffer_load_dwordx4 v5, s[12:15], s56 offen offset:1024 lds
    buffer_load_dwordx4 v6, s[12:15], s56 offen offset:2048 lds
    s_add_u32 m0, s57, 6144
    s_add_u32 s56, s56, 221184
    buffer_load_dwordx4 v4, s[12:15], s56 offen offset:0 lds
    buffer_load_dwordx4 v5, s[12:15], s56 offen offset:1024 lds
    buffer_load_dwordx4 v6, s[12:15], s56 offen offset:2048 lds
    v_dot2_f32_bf16 v20, v64, s36, v32
    v_dot2_f32_bf16 v21, v64, s37, v32
    v_dot2_f32_bf16 v22, v65, s36, v32
    v_dot2_f32_bf16 v23, v65, s37, v32
    v_dot2_f32_bf16 v24, v66, s36, v32
    v_dot2_f32_bf16 v25, v66, s37, v32
    v_dot2_f32_bf16 v26, v67, s36, v32
    v_dot2_f32_bf16 v27, v67, s37, v32
    v_cvt_pk_bf16_f32 v64, v20, v21
    v_cvt_pk_bf16_f32 v65, v22, v23
    v_cvt_pk_bf16_f32 v66, v24, v25
    v_cvt_pk_bf16_f32 v67, v26, v27
    ds_write_b128 v37, v[64:67] offset:256
    v_dot2_f32_bf16 v20, v68, s36, v32
    v_dot2_f32_bf16 v21, v68, s37, v32
    v_dot2_f32_bf16 v22, v69, s36, v32
    v_dot2_f32_bf16 v23, v69, s37, v32
    v_dot2_f32_bf16 v24, v70, s36, v32
    v_dot2_f32_bf16 v25, v70, s37, v32
    v_dot2_f32_bf16 v26, v71, s36, v32
    v_dot2_f32_bf16 v27, v71, s37, v32
    v_cvt_pk_bf16_f32 v68, v20, v21
    v_cvt_pk_bf16_f32 v69, v22, v23
    v_cvt_pk_bf16_f32 v70, v24, v25
    v_cvt_pk_bf16_f32 v71, v26, v27
    ds_write_b128 v37, v[68:71] offset:384
    v_dot2_f32_bf16 v20, v72, s36, v32
    v_dot2_f32_bf16 v21, v72, s37, v32
    v_dot2_f32_bf16 v22, v73, s36, v32
    v_dot2_f32_bf16 v23, v73, s37, v32
    v_dot2_f32_bf16 v24, v74, s36, v32
    v_dot2_f32_bf16 v25, v74, s37, v32
    v_dot2_f32_bf16 v26, v75, s36, v32
    v_dot2_f32_bf16 v27, v75, s37, v32
    v_cvt_pk_bf16_f32 v72, v20, v21
    v_cvt_pk_bf16_f32 v73, v22, v23
    v_cvt_pk_bf16_f32 v74, v24, v25
    v_cvt_pk_bf16_f32 v75, v26, v27
    ds_write_b128 v37, v[72:75] offset:512
    v_dot2_f32_bf16 v20, v76, s36, v32
    v_dot2_f32_bf16 v21, v76, s37, v32
    v_dot2_f32_bf16 v22, v77, s36, v32
    v_dot2_f32_bf16 v23, v77, s37, v32
    v_dot2_f32_bf16 v24, v78, s36, v32
    v_dot2_f32_bf16 v25, v78, s37, v32
    v_dot2_f32_bf16 v26, v79, s36, v32
    v_dot2_f32_bf16 v27, v79, s37, v32
    v_cvt_pk_bf16_f32 v76, v20, v21
    v_cvt_pk_bf16_f32 v77, v22, v23
    v_cvt_pk_bf16_f32 v78, v24, v25
    v_cvt_pk_bf16_f32 v79, v26, v27
    ds_write_b128 v37, v[76:79] offset:640
    v_dot2_f32_bf16 v20, v80, s36, v32
    v_dot2_f32_bf16 v21, v80, s37, v32
    v_dot2_f32_bf16 v22, v81, s36, v32
    v_dot2_f32_bf16 v23, v81, s37, v32
    v_dot2_f32_bf16 v24, v82, s36, v32
    v_dot2_f32_bf16 v25, v82, s37, v32
    v_dot2_f32_bf16 v26, v83, s36, v32
    v_dot2_f32_bf16 v27, v83, s37, v32
    v_cvt_pk_bf16_f32 v80, v20, v21
    v_cvt_pk_bf16_f32 v81, v22, v23
    v_cvt_pk_bf16_f32 v82, v24, v25
    v_cvt_pk_bf16_f32 v83, v26, v27
    ds_write_b128 v37, v[80:83] offset:768
    v_dot2_f32_bf16 v20, v84, s36, v32
    v_dot2_f32_bf16 v21, v84, s37, v32
    v_dot2_f32_bf16 v22, v85, s36, v32
    v_dot2_f32_bf16 v23, v85, s37, v32
    v_dot2_f32_bf16 v24, v86, s36, v32
    v_dot2_f32_bf16 v25, v86, s37, v32
    v_dot2_f32_bf16 v26, v87, s36, v32
    v_dot2_f32_bf16 v27, v87, s37, v32
    v_cvt_pk_bf16_f32 v84, v20, v21
    v_cvt_pk_bf16_f32 v85, v22, v23
    v_cvt_pk_bf16_f32 v86, v24, v25
    v_cvt_pk_bf16_f32 v87, v26, v27
    ds_write_b128 v37, v[84:87] offset:896
    v_dot2_f32_bf16 v20, v88, s36, v32
    v_dot2_f32_bf16 v21, v88, s37, v32
    v_dot2_f32_bf16 v22, v89, s36, v32
    v_dot2_f32_bf16 v23, v89, s37, v32
    v_dot2_f32_bf16 v24, v90, s36, v32
    v_dot2_f32_bf16 v25, v90, s37, v32
    v_dot2_f32_bf16 v26, v91, s36, v32
    v_dot2_f32_bf16 v27, v91, s37, v32
    v_cvt_pk_bf16_f32 v88, v20, v21
    v_cvt_pk_bf16_f32 v89, v22, v23
    v_cvt_pk_bf16_f32 v90, v24, v25
    v_cvt_pk_bf16_f32 v91, v26, v27
    ds_write_b128 v37, v[88:91] offset:1024
    s_mul_i32 s56, s40, 663552
    s_add_u32 s56, s56, s49
    s_add_u32 m0, s57, 36864
    s_add_u32 s56, s56, 2654208
    buffer_load_dwordx4 v4, s[12:15], s56 offen offset:0 lds
    buffer_load_dwordx4 v5, s[12:15], s56 offen offset:1024 lds
    buffer_load_dwordx4 v6, s[12:15], s56 offen offset:2048 lds
    s_add_u32 m0, s57, 39936
    s_add_u32 s56, s56, 221184
    buffer_load_dwordx4 v4, s[12:15], s56 offen offset:0 lds
    buffer_load_dwordx4 v5, s[12:15], s56 offen offset:1024 lds
    buffer_load_dwordx4 v6, s[12:15], s56 offen offset:2048 lds
    s_add_u32 m0, s57, 43008
    s_add_u32 s56, s56, 221184
    buffer_load_dwordx4 v4, s[12:15], s56 offen offset:0 lds
    buffer_load_dwordx4 v5, s[12:15], s56 offen offset:1024 lds
    buffer_load_dwordx4 v6, s[12:15], s56 offen offset:2048 lds
    s_lshl_b32 s43, s2, 2
    s_add_u32 s43, s43, s40
    s_mul_i32 s67, s43, 7282
    s_lshr_b32 s67, s67, 16
    s_mul_i32 s68, s67, 9
    s_sub_u32 s68, s43, s68
    s_add_u32 s43, s67, 32
    s_cmp_lt_u32 s67, 36
    s_cselect_b32 s43, s67, s43
    s_sub_u32 s69, s67, 40
    s_cmp_lt_u32 s67, 40
    s_cselect_b32 s43, s43, s69
    s_cselect_b32 s32, s12, s16
    s_cselect_b32 s33, s13, s17
    s_cselect_b32 s34, s14, s18
    s_mov_b32 s35, 0x20000
    s_mov_b32 s69, 3456
    s_cselect_b32 s69, 9216, s69
    s_lshl_b32 s43, s43, 7
    s_mul_i32 s68, s68, s69
    s_lshl_b32 s68, s68, 6
    s_add_u32 s43, s43, s68
    s_cmp_lt_u32 s67, 67
    s_cselect_b32 s43, s43, 0x7f000000
    v_mul_u32_u24 v2, s69, v1
    buffer_load_dword v3, v2, s[32:35], s43 offen
    v_mov_b32 v34, 0
    v_mov_b32 v35, 0
    v_dot2_f32_bf16 v34, v56, v56, v34
    v_dot2_f32_bf16 v35, v57, v57, v35
    v_dot2_f32_bf16 v34, v58, v58, v34
    v_dot2_f32_bf16 v35, v59, v59, v35
    v_dot2_f32_bf16 v34, v60, v60, v34
    v_dot2_f32_bf16 v35, v61, v61, v35
    v_dot2_f32_bf16 v34, v62, v62, v34
    v_dot2_f32_bf16 v35, v63, v63, v35
    v_dot2_f32_bf16 v34, v64, v64, v34
    v_dot2_f32_bf16 v35, v65, v65, v35
    v_dot2_f32_bf16 v34, v66, v66, v34
    v_dot2_f32_bf16 v35, v67, v67, v35
    v_dot2_f32_bf16 v34, v68, v68, v34
    v_dot2_f32_bf16 v35, v69, v69, v35
    v_dot2_f32_bf16 v34, v70, v70, v34
    v_dot2_f32_bf16 v35, v71, v71, v35
    v_dot2_f32_bf16 v34, v72, v72, v34
    v_dot2_f32_bf16 v35, v73, v73, v35
    v_dot2_f32_bf16 v34, v74, v74, v34
    v_dot2_f32_bf16 v35, v75, v75, v35
    v_dot2_f32_bf16 v34, v76, v76, v34
    v_dot2_f32_bf16 v35, v77, v77, v35
    v_dot2_f32_bf16 v34, v78, v78, v34
    v_dot2_f32_bf16 v35, v79, v79, v35
    v_dot2_f32_bf16 v34, v80, v80, v34
    v_dot2_f32_bf16 v35, v81, v81, v35
    v_dot2_f32_bf16 v34, v82, v82, v34
    v_dot2_f32_bf16 v35, v83, v83, v35
    v_dot2_f32_bf16 v34, v84, v84, v34
    v_dot2_f32_bf16 v35, v85, v85, v35
    v_dot2_f32_bf16 v34, v86, v86, v34
    v_dot2_f32_bf16 v35, v87, v87, v35
    v_dot2_f32_bf16 v34, v88, v88, v34
    v_dot2_f32_bf16 v35, v89, v89, v35
    v_dot2_f32_bf16 v34, v90, v90, v34
    v_dot2_f32_bf16 v35, v91, v91, v35
    s_nop 2
    v_add_f32 v34, v34, v35
    s_nop 1
    v_add_f32_dpp v34, v34, v34 quad_perm:[1,0,3,2] row_mask:0xf bank_mask:0xf
    s_nop 1
    v_add_f32_dpp v34, v34, v34 quad_perm:[2,3,0,1] row_mask:0xf bank_mask:0xf
    s_nop 1
    v_add_f32_dpp v34, v34, v34 row_half_mirror row_mask:0xf bank_mask:0xf
    v_mul_f32 v34, s45, v34
    v_add_f32 v34, 0x3727c5ac, v34
    v_sqrt_f32 v34, v34
    s_nop 0
    ds_write_b32 v38, v34 offset:256
    s_waitcnt vmcnt(10) lgkmcnt(0)
    s_barrier
    ds_read_b32 v2, v39
    s_waitcnt vmcnt(1)
    s_barrier
    s_branch L1_fx1e
L1_fx1b:
    v_dot2_f32_bf16 v20, v204, s36, v32
    v_dot2_f32_bf16 v21, v204, s37, v32
    v_dot2_f32_bf16 v22, v205, s36, v32
    v_dot2_f32_bf16 v23, v205, s37, v32
    v_dot2_f32_bf16 v24, v206, s36, v32
    v_dot2_f32_bf16 v25, v206, s37, v32
    v_dot2_f32_bf16 v26, v207, s36, v32
    v_dot2_f32_bf16 v27, v207, s37, v32
    v_cvt_pk_bf16_f32 v204, v20, v21
    v_cvt_pk_bf16_f32 v205, v22, v23
    v_cvt_pk_bf16_f32 v206, v24, v25
    v_cvt_pk_bf16_f32 v207, v26, v27
    ds_write_b128 v36, v[204:207] offset:0
    v_dot2_f32_bf16 v20, v208, s36, v32
    v_dot2_f32_bf16 v21, v208, s37, v32
    v_dot2_f32_bf16 v22, v209, s36, v32
    v_dot2_f32_bf16 v23, v209, s37, v32
    v_dot2_f32_bf16 v24, v210, s36, v32
    v_dot2_f32_bf16 v25, v210, s37, v32
    v_dot2_f32_bf16 v26, v211, s36, v32
    v_dot2_f32_bf16 v27, v211, s37, v32
    v_cvt_pk_bf16_f32 v208, v20, v21
    v_cvt_pk_bf16_f32 v209, v22, v23
    v_cvt_pk_bf16_f32 v210, v24, v25
    v_cvt_pk_bf16_f32 v211, v26, v27
    ds_write_b128 v36, v[208:211] offset:128
    v_dot2_f32_bf16 v20, v212, s36, v32
    v_dot2_f32_bf16 v21, v212, s37, v32
    v_dot2_f32_bf16 v22, v213, s36, v32
    v_dot2_f32_bf16 v23, v213, s37, v32
    v_dot2_f32_bf16 v24, v214, s36, v32
    v_dot2_f32_bf16 v25, v214, s37, v32
    v_dot2_f32_bf16 v26, v215, s36, v32
    v_dot2_f32_bf16 v27, v215, s37, v32
    v_cvt_pk_bf16_f32 v212, v20, v21
    v_cvt_pk_bf16_f32 v213, v22, v23
    v_cvt_pk_bf16_f32 v214, v24, v25
    v_cvt_pk_bf16_f32 v215, v26, v27
    ds_write_b128 v36, v[212:215] offset:256
    v_dot2_f32_bf16 v20, v216, s36, v32
    v_dot2_f32_bf16 v21, v216, s37, v32
    v_dot2_f32_bf16 v22, v217, s36, v32
    v_dot2_f32_bf16 v23, v217, s37, v32
    v_dot2_f32_bf16 v24, v218, s36, v32
    v_dot2_f32_bf16 v25, v218, s37, v32
    v_dot2_f32_bf16 v26, v219, s36, v32
    v_dot2_f32_bf16 v27, v219, s37, v32
    v_cvt_pk_bf16_f32 v216, v20, v21
    v_cvt_pk_bf16_f32 v217, v22, v23
    v_cvt_pk_bf16_f32 v218, v24, v25
    v_cvt_pk_bf16_f32 v219, v26, v27
    ds_write_b128 v36, v[216:219] offset:384
    v_dot2_f32_bf16 v20, v220, s36, v32
    v_dot2_f32_bf16 v21, v220, s37, v32
    v_dot2_f32_bf16 v22, v221, s36, v32
    v_dot2_f32_bf16 v23, v221, s37, v32
    v_dot2_f32_bf16 v24, v222, s36, v32
    v_dot2_f32_bf16 v25, v222, s37, v32
    v_dot2_f32_bf16 v26, v223, s36, v32
    v_dot2_f32_bf16 v27, v223, s37, v32
    v_cvt_pk_bf16_f32 v220, v20, v21
    v_cvt_pk_bf16_f32 v221, v22, v23
    v_cvt_pk_bf16_f32 v222, v24, v25
    v_cvt_pk_bf16_f32 v223, v26, v27
    ds_write_b128 v36, v[220:223] offset:512
    v_dot2_f32_bf16 v20, v224, s36, v32
    v_dot2_f32_bf16 v21, v224, s37, v32
    v_dot2_f32_bf16 v22, v225, s36, v32
    v_dot2_f32_bf16 v23, v225, s37, v32
    v_dot2_f32_bf16 v24, v226, s36, v32
    v_dot2_f32_bf16 v25, v226, s37, v32
    v_dot2_f32_bf16 v26, v227, s36, v32
    v_dot2_f32_bf16 v27, v227, s37, v32
    v_cvt_pk_bf16_f32 v224, v20, v21
    v_cvt_pk_bf16_f32 v225, v22, v23
    v_cvt_pk_bf16_f32 v226, v24, v25
    v_cvt_pk_bf16_f32 v227, v26, v27
    ds_write_b128 v36, v[224:227] offset:640
    v_dot2_f32_bf16 v20, v228, s36, v32
    v_dot2_f32_bf16 v21, v228, s37, v32
    v_dot2_f32_bf16 v22, v229, s36, v32
    v_dot2_f32_bf16 v23, v229, s37, v32
    v_dot2_f32_bf16 v24, v230, s36, v32
    v_dot2_f32_bf16 v25, v230, s37, v32
    v_dot2_f32_bf16 v26, v231, s36, v32
    v_dot2_f32_bf16 v27, v231, s37, v32
    v_cvt_pk_bf16_f32 v228, v20, v21
    v_cvt_pk_bf16_f32 v229, v22, v23
    v_cvt_pk_bf16_f32 v230, v24, v25
    v_cvt_pk_bf16_f32 v231, v26, v27
    ds_write_b128 v36, v[228:231] offset:768
    v_dot2_f32_bf16 v20, v232, s36, v32
    v_dot2_f32_bf16 v21, v232, s37, v32
    v_dot2_f32_bf16 v22, v233, s36, v32
    v_dot2_f32_bf16 v23, v233, s37, v32
    v_dot2_f32_bf16 v24, v234, s36, v32
    v_dot2_f32_bf16 v25, v234, s37, v32
    v_dot2_f32_bf16 v26, v235, s36, v32
    v_dot2_f32_bf16 v27, v235, s37, v32
    v_cvt_pk_bf16_f32 v232, v20, v21
    v_cvt_pk_bf16_f32 v233, v22, v23
    v_cvt_pk_bf16_f32 v234, v24, v25
    v_cvt_pk_bf16_f32 v235, v26, v27
    ds_write_b128 v36, v[232:235] offset:896
    v_dot2_f32_bf16 v20, v236, s36, v32
    v_dot2_f32_bf16 v21, v236, s37, v32
    v_dot2_f32_bf16 v22, v237, s36, v32
    v_dot2_f32_bf16 v23, v237, s37, v32
    v_dot2_f32_bf16 v24, v238, s36, v32
    v_dot2_f32_bf16 v25, v238, s37, v32
    v_dot2_f32_bf16 v26, v239, s36, v32
    v_dot2_f32_bf16 v27, v239, s37, v32
    v_cvt_pk_bf16_f32 v236, v20, v21
    v_cvt_pk_bf16_f32 v237, v22, v23
    v_cvt_pk_bf16_f32 v238, v24, v25
    v_cvt_pk_bf16_f32 v239, v26, v27
    ds_write_b128 v36, v[236:239] offset:1024
    s_waitcnt lgkmcnt(0)
    s_barrier
    buffer_load_dwordx4 v[56:59], v240, s[8:11], s69 offen offset:0
    buffer_load_dwordx4 v[60:63], v240, s[8:11], s69 offen offset:128
    buffer_load_dwordx4 v[64:67], v240, s[8:11], s69 offen offset:256
    buffer_load_dwordx4 v[68:71], v240, s[8:11], s69 offen offset:384
    buffer_load_dwordx4 v[72:75], v240, s[8:11], s69 offen offset:512
    buffer_load_dwordx4 v[76:79], v240, s[8:11], s69 offen offset:640
    buffer_load_dwordx4 v[80:83], v240, s[8:11], s69 offen offset:768
    buffer_load_dwordx4 v[84:87], v240, s[8:11], s69 offen offset:896
    buffer_load_dwordx4 v[88:91], v240, s[8:11], s69 offen offset:1024
    v_mov_b32 v34, 0
    v_mov_b32 v35, 0
    v_dot2_f32_bf16 v34, v204, v204, v34
    v_dot2_f32_bf16 v35, v205, v205, v35
    v_dot2_f32_bf16 v34, v206, v206, v34
    v_dot2_f32_bf16 v35, v207, v207, v35
    v_dot2_f32_bf16 v34, v208, v208, v34
    v_dot2_f32_bf16 v35, v209, v209, v35
    v_dot2_f32_bf16 v34, v210, v210, v34
    v_dot2_f32_bf16 v35, v211, v211, v35
    v_dot2_f32_bf16 v34, v212, v212, v34
    v_dot2_f32_bf16 v35, v213, v213, v35
    v_dot2_f32_bf16 v34, v214, v214, v34
    v_dot2_f32_bf16 v35, v215, v215, v35
    v_dot2_f32_bf16 v34, v216, v216, v34
    v_dot2_f32_bf16 v35, v217, v217, v35
    v_dot2_f32_bf16 v34, v218, v218, v34
    v_dot2_f32_bf16 v35, v219, v219, v35
    v_dot2_f32_bf16 v34, v220, v220, v34
    v_dot2_f32_bf16 v35, v221, v221, v35
    v_dot2_f32_bf16 v34, v222, v222, v34
    v_dot2_f32_bf16 v35, v223, v223, v35
    v_dot2_f32_bf16 v34, v224, v224, v34
    v_dot2_f32_bf16 v35, v225, v225, v35
    v_dot2_f32_bf16 v34, v226, v226, v34
    v_dot2_f32_bf16 v35, v227, v227, v35
    v_dot2_f32_bf16 v34, v228, v228, v34
    v_dot2_f32_bf16 v35, v229, v229, v35
    v_dot2_f32_bf16 v34, v230, v230, v34
    v_dot2_f32_bf16 v35, v231, v231, v35
    v_dot2_f32_bf16 v34, v232, v232, v34
    v_dot2_f32_bf16 v35, v233, v233, v35
    v_dot2_f32_bf16 v34, v234, v234, v34
    v_dot2_f32_bf16 v35, v235, v235, v35
    v_dot2_f32_bf16 v34, v236, v236, v34
    v_dot2_f32_bf16 v35, v237, v237, v35
    v_dot2_f32_bf16 v34, v238, v238, v34
    v_dot2_f32_bf16 v35, v239, v239, v35
    s_nop 2
    v_add_f32 v34, v34, v35
    s_nop 1
    v_add_f32_dpp v34, v34, v34 quad_perm:[1,0,3,2] row_mask:0xf bank_mask:0xf
    s_nop 1
    v_add_f32_dpp v34, v34, v34 quad_perm:[2,3,0,1] row_mask:0xf bank_mask:0xf
    s_nop 1
    v_add_f32_dpp v34, v34, v34 row_half_mirror row_mask:0xf bank_mask:0xf
    v_mul_f32 v34, s45, v34
    v_add_f32 v34, 0x3727c5ac, v34
    v_sqrt_f32 v34, v34
    s_nop 0
    ds_write_b32 v38, v34 offset:0
    v_mov_b32 v32, 0
    v_mov_b32 v33, 0
    s_waitcnt vmcnt(8)
    v_dot2_f32_bf16 v32, v56, s44, v32
    v_dot2_f32_bf16 v33, v57, s44, v33
    v_dot2_f32_bf16 v32, v58, s44, v32
    v_dot2_f32_bf16 v33, v59, s44, v33
    s_waitcnt vmcnt(7)
    v_dot2_f32_bf16 v32, v60, s44, v32
    v_dot2_f32_bf16 v33, v61, s44, v33
    v_dot2_f32_bf16 v32, v62, s44, v32
    v_dot2_f32_bf16 v33, v63, s44, v33
    s_waitcnt vmcnt(6)
    v_dot2_f32_bf16 v32, v64, s44, v32
    v_dot2_f32_bf16 v33, v65, s44, v33
    v_dot2_f32_bf16 v32, v66, s44, v32
    v_dot2_f32_bf16 v33, v67, s44, v33
    s_waitcnt vmcnt(5)
    v_dot2_f32_bf16 v32, v68, s44, v32
    v_dot2_f32_bf16 v33, v69, s44, v33
    v_dot2_f32_bf16 v32, v70, s44, v32
    v_dot2_f32_bf16 v33, v71, s44, v33
    s_waitcnt vmcnt(4)
    v_dot2_f32_bf16 v32, v72, s44, v32
    v_dot2_f32_bf16 v33, v73, s44, v33
    v_dot2_f32_bf16 v32, v74, s44, v32
    v_dot2_f32_bf16 v33, v75, s44, v33
    s_waitcnt vmcnt(3)
    v_dot2_f32_bf16 v32, v76, s44, v32
    v_dot2_f32_bf16 v33, v77, s44, v33
    v_dot2_f32_bf16 v32, v78, s44, v32
    v_dot2_f32_bf16 v33, v79, s44, v33
    s_waitcnt vmcnt(2)
    v_dot2_f32_bf16 v32, v80, s44, v32
    v_dot2_f32_bf16 v33, v81, s44, v33
    v_dot2_f32_bf16 v32, v82, s44, v32
    v_dot2_f32_bf16 v33, v83, s44, v33
    s_waitcnt vmcnt(1)
    v_dot2_f32_bf16 v32, v84, s44, v32
    v_dot2_f32_bf16 v33, v85, s44, v33
    v_dot2_f32_bf16 v32, v86, s44, v32
    v_dot2_f32_bf16 v33, v87, s44, v33
    s_waitcnt vmcnt(0)
    v_dot2_f32_bf16 v32, v88, s44, v32
    v_dot2_f32_bf16 v33, v89, s44, v33
    v_dot2_f32_bf16 v32, v90, s44, v32
    v_dot2_f32_bf16 v33, v91, s44, v33
    s_nop 2
    v_add_f32 v32, v32, v33
    s_nop 1
    v_add_f32_dpp v32, v32, v32 quad_perm:[1,0,3,2] row_mask:0xf bank_mask:0xf
    s_nop 1
    v_add_f32_dpp v32, v32, v32 quad_perm:[2,3,0,1] row_mask:0xf bank_mask:0xf
    s_nop 1
    v_add_f32_dpp v32, v32, v32 row_half_mirror row_mask:0xf bank_mask:0xf
    v_mul_f32 v32, 0xbae38e39, v32
    v_dot2_f32_bf16 v20, v56, s36, v32
    v_dot2_f32_bf16 v21, v56, s37, v32
    v_dot2_f32_bf16 v22, v57, s36, v32
    v_dot2_f32_bf16 v23, v57, s37, v32
    v_dot2_f32_bf16 v24, v58, s36, v32
    v_dot2_f32_bf16 v25, v58, s37, v32
    v_dot2_f32_bf16 v26, v59, s36, v32
    v_dot2_f32_bf16 v27, v59, s37, v32
    v_cvt_pk_bf16_f32 v56, v20, v21
    v_cvt_pk_bf16_f32 v57, v22, v23
    v_cvt_pk_bf16_f32 v58, v24, v25
    v_cvt_pk_bf16_f32 v59, v26, v27
    ds_write_b128 v37, v[56:59] offset:0
    v_dot2_f32_bf16 v20, v60, s36, v32
    v_dot2_f32_bf16 v21, v60, s37, v32
    v_dot2_f32_bf16 v22, v61, s36, v32
    v_dot2_f32_bf16 v23, v61, s37, v32
    v_dot2_f32_bf16 v24, v62, s36, v32
    v_dot2_f32_bf16 v25, v62, s37, v32
    v_dot2_f32_bf16 v26, v63, s36, v32
    v_dot2_f32_bf16 v27, v63, s37, v32
    v_cvt_pk_bf16_f32 v60, v20, v21
    v_cvt_pk_bf16_f32 v61, v22, v23
    v_cvt_pk_bf16_f32 v62, v24, v25
    v_cvt_pk_bf16_f32 v63, v26, v27
    ds_write_b128 v37, v[60:63] offset:128
    s_barrier
    v_dot2_f32_bf16 v20, v64, s36, v32
    v_dot2_f32_bf16 v21, v64, s37, v32
    v_dot2_f32_bf16 v22, v65, s36, v32
    v_dot2_f32_bf16 v23, v65, s37, v32
    v_dot2_f32_bf16 v24, v66, s36, v32
    v_dot2_f32_bf16 v25, v66, s37, v32
    v_dot2_f32_bf16 v26, v67, s36, v32
    v_dot2_f32_bf16 v27, v67, s37, v32
    v_cvt_pk_bf16_f32 v64, v20, v21
    v_cvt_pk_bf16_f32 v65, v22, v23
    v_cvt_pk_bf16_f32 v66, v24, v25
    v_cvt_pk_bf16_f32 v67, v26, v27
    ds_write_b128 v37, v[64:67] offset:256
    v_dot2_f32_bf16 v20, v68, s36, v32
    v_dot2_f32_bf16 v21, v68, s37, v32
    v_dot2_f32_bf16 v22, v69, s36, v32
    v_dot2_f32_bf16 v23, v69, s37, v32
    v_dot2_f32_bf16 v24, v70, s36, v32
    v_dot2_f32_bf16 v25, v70, s37, v32
    v_dot2_f32_bf16 v26, v71, s36, v32
    v_dot2_f32_bf16 v27, v71, s37, v32
    v_cvt_pk_bf16_f32 v68, v20, v21
    v_cvt_pk_bf16_f32 v69, v22, v23
    v_cvt_pk_bf16_f32 v70, v24, v25
    v_cvt_pk_bf16_f32 v71, v26, v27
    ds_write_b128 v37, v[68:71] offset:384
    v_dot2_f32_bf16 v20, v72, s36, v32
    v_dot2_f32_bf16 v21, v72, s37, v32
    v_dot2_f32_bf16 v22, v73, s36, v32
    v_dot2_f32_bf16 v23, v73, s37, v32
    v_dot2_f32_bf16 v24, v74, s36, v32
    v_dot2_f32_bf16 v25, v74, s37, v32
    v_dot2_f32_bf16 v26, v75, s36, v32
    v_dot2_f32_bf16 v27, v75, s37, v32
    v_cvt_pk_bf16_f32 v72, v20, v21
    v_cvt_pk_bf16_f32 v73, v22, v23
    v_cvt_pk_bf16_f32 v74, v24, v25
    v_cvt_pk_bf16_f32 v75, v26, v27
    ds_write_b128 v37, v[72:75] offset:512
    v_dot2_f32_bf16 v20, v76, s36, v32
    v_dot2_f32_bf16 v21, v76, s37, v32
    v_dot2_f32_bf16 v22, v77, s36, v32
    v_dot2_f32_bf16 v23, v77, s37, v32
    v_dot2_f32_bf16 v24, v78, s36, v32
    v_dot2_f32_bf16 v25, v78, s37, v32
    v_dot2_f32_bf16 v26, v79, s36, v32
    v_dot2_f32_bf16 v27, v79, s37, v32
    v_cvt_pk_bf16_f32 v76, v20, v21
    v_cvt_pk_bf16_f32 v77, v22, v23
    v_cvt_pk_bf16_f32 v78, v24, v25
    v_cvt_pk_bf16_f32 v79, v26, v27
    ds_write_b128 v37, v[76:79] offset:640
    v_dot2_f32_bf16 v20, v80, s36, v32
    v_dot2_f32_bf16 v21, v80, s37, v32
    v_dot2_f32_bf16 v22, v81, s36, v32
    v_dot2_f32_bf16 v23, v81, s37, v32
    v_dot2_f32_bf16 v24, v82, s36, v32
    v_dot2_f32_bf16 v25, v82, s37, v32
    v_dot2_f32_bf16 v26, v83, s36, v32
    v_dot2_f32_bf16 v27, v83, s37, v32
    v_cvt_pk_bf16_f32 v80, v20, v21
    v_cvt_pk_bf16_f32 v81, v22, v23
    v_cvt_pk_bf16_f32 v82, v24, v25
    v_cvt_pk_bf16_f32 v83, v26, v27
    ds_write_b128 v37, v[80:83] offset:768
    v_dot2_f32_bf16 v20, v84, s36, v32
    v_dot2_f32_bf16 v21, v84, s37, v32
    v_dot2_f32_bf16 v22, v85, s36, v32
    v_dot2_f32_bf16 v23, v85, s37, v32
    v_dot2_f32_bf16 v24, v86, s36, v32
    v_dot2_f32_bf16 v25, v86, s37, v32
    v_dot2_f32_bf16 v26, v87, s36, v32
    v_dot2_f32_bf16 v27, v87, s37, v32
    v_cvt_pk_bf16_f32 v84, v20, v21
    v_cvt_pk_bf16_f32 v85, v22, v23
    v_cvt_pk_bf16_f32 v86, v24, v25
    v_cvt_pk_bf16_f32 v87, v26, v27
    ds_write_b128 v37, v[84:87] offset:896
    v_dot2_f32_bf16 v20, v88, s36, v32
    v_dot2_f32_bf16 v21, v88, s37, v32
    v_dot2_f32_bf16 v22, v89, s36, v32
    v_dot2_f32_bf16 v23, v89, s37, v32
    v_dot2_f32_bf16 v24, v90, s36, v32
    v_dot2_f32_bf16 v25, v90, s37, v32
    v_dot2_f32_bf16 v26, v91, s36, v32
    v_dot2_f32_bf16 v27, v91, s37, v32
    v_cvt_pk_bf16_f32 v88, v20, v21
    v_cvt_pk_bf16_f32 v89, v22, v23
    v_cvt_pk_bf16_f32 v90, v24, v25
    v_cvt_pk_bf16_f32 v91, v26, v27
    ds_write_b128 v37, v[88:91] offset:1024
    v_mov_b32 v34, 0
    v_mov_b32 v35, 0
    v_dot2_f32_bf16 v34, v56, v56, v34
    v_dot2_f32_bf16 v35, v57, v57, v35
    v_dot2_f32_bf16 v34, v58, v58, v34
    v_dot2_f32_bf16 v35, v59, v59, v35
    v_dot2_f32_bf16 v34, v60, v60, v34
    v_dot2_f32_bf16 v35, v61, v61, v35
    v_dot2_f32_bf16 v34, v62, v62, v34
    v_dot2_f32_bf16 v35, v63, v63, v35
    v_dot2_f32_bf16 v34, v64, v64, v34
    v_dot2_f32_bf16 v35, v65, v65, v35
    v_dot2_f32_bf16 v34, v66, v66, v34
    v_dot2_f32_bf16 v35, v67, v67, v35
    v_dot2_f32_bf16 v34, v68, v68, v34
    v_dot2_f32_bf16 v35, v69, v69, v35
    v_dot2_f32_bf16 v34, v70, v70, v34
    v_dot2_f32_bf16 v35, v71, v71, v35
    v_dot2_f32_bf16 v34, v72, v72, v34
    v_dot2_f32_bf16 v35, v73, v73, v35
    v_dot2_f32_bf16 v34, v74, v74, v34
    v_dot2_f32_bf16 v35, v75, v75, v35
    v_dot2_f32_bf16 v34, v76, v76, v34
    v_dot2_f32_bf16 v35, v77, v77, v35
    v_dot2_f32_bf16 v34, v78, v78, v34
    v_dot2_f32_bf16 v35, v79, v79, v35
    v_dot2_f32_bf16 v34, v80, v80, v34
    v_dot2_f32_bf16 v35, v81, v81, v35
    v_dot2_f32_bf16 v34, v82, v82, v34
    v_dot2_f32_bf16 v35, v83, v83, v35
    v_dot2_f32_bf16 v34, v84, v84, v34
    v_dot2_f32_bf16 v35, v85, v85, v35
    v_dot2_f32_bf16 v34, v86, v86, v34
    v_dot2_f32_bf16 v35, v87, v87, v35
    v_dot2_f32_bf16 v34, v88, v88, v34
    v_dot2_f32_bf16 v35, v89, v89, v35
    v_dot2_f32_bf16 v34, v90, v90, v34
    v_dot2_f32_bf16 v35, v91, v91, v35
    s_nop 2
    v_add_f32 v34, v34, v35
    s_nop 1
    v_add_f32_dpp v34, v34, v34 quad_perm:[1,0,3,2] row_mask:0xf bank_mask:0xf
    s_nop 1
    v_add_f32_dpp v34, v34, v34 quad_perm:[2,3,0,1] row_mask:0xf bank_mask:0xf
    s_nop 1
    v_add_f32_dpp v34, v34, v34 row_half_mirror row_mask:0xf bank_mask:0xf
    v_mul_f32 v34, s45, v34
    v_add_f32 v34, 0x3727c5ac, v34
    v_sqrt_f32 v34, v34
    s_nop 0
    ds_write_b32 v38, v34 offset:256
    s_waitcnt lgkmcnt(0)
    s_barrier
    ds_read_b32 v2, v39
    v_mov_b32 v252, 0
    s_cmp_lg_u32 s40, 4
    s_cbranch_scc1 L1_tag0
    global_load_dwordx2 v[244:245], v252, s[30:31] sc1
L1_tag0:
    ds_read_b128 v[96:99], v28 offset:0
    ds_read_b128 v[100:103], v29 offset:0
    ds_read_b128 v[104:107], v30 offset:0
    ds_read_b128 v[108:111], v31 offset:0
    ds_read_b128 v[112:115], v28 offset:128
    ds_read_b128 v[116:119], v29 offset:128
    ds_read_b128 v[120:123], v30 offset:128
    ds_read_b128 v[124:127], v31 offset:128
    ds_read_b128 v[128:131], v28 offset:256
    ds_read_b128 v[132:135], v29 offset:256
    ds_read_b128 v[136:139], v30 offset:256
    ds_read_b128 v[140:143], v31 offset:256
    ds_read_b128 v[144:147], v28 offset:384
    ds_read_b128 v[148:151], v29 offset:384
    ds_read_b128 v[152:155], v30 offset:384
    ds_read_b128 v[156:159], v31 offset:384
    ds_read_b128 v[160:163], v28 offset:512
    ds_read_b128 v[164:167], v29 offset:512
    ds_read_b128 v[168:171], v30 offset:512
    ds_read_b128 v[172:175], v31 offset:512
    ds_read_b128 v[176:179], v28 offset:640
    ds_read_b128 v[180:183], v29 offset:640
    ds_read_b128 v[184:187], v30 offset:640
    ds_read_b128 v[188:191], v31 offset:640
    ds_read_b128 v[192:195], v28 offset:768
    ds_read_b128 v[196:199], v29 offset:768
    ds_read_b128 v[200:203], v30 offset:768
    ds_read_b128 v[204:207], v31 offset:768
    ds_read_b128 v[208:211], v28 offset:896
    ds_read_b128 v[212:215], v29 offset:896
    ds_read_b128 v[216:219], v30 offset:896
    ds_read_b128 v[220:223], v31 offset:896
    ds_read_b128 v[224:227], v28 offset:1024
    ds_read_b128 v[228:231], v29 offset:1024
    ds_read_b128 v[232:235], v30 offset:1024
    ds_read_b128 v[236:239], v31 offset:1024
    s_waitcnt lgkmcnt(0)
    s_barrier
L1_fx1e:
    s_nop 1
    s_mov_b32 s71, 0xe0c0
    s_bitcmp1_b32 s71, s42
    s_cselect_b32 s71, 0x7f000000, 0
    s_add_u32 s70, s71, s51
    s_waitcnt lgkmcnt(0)
    v_rcp_f32 v0, v2
    s_nop 0
    v_mul_f32 v17, 0xc0135761, v0
    v_mul_f32 v20, v0, v0
    v_mul_f32 v0, v0, v20
    v_mul_f32 v0, 0xbdd2d3e8, v0
    s_mul_i32 s56, s46, 663552
    s_add_u32 s56, s56, s49
    s_add_u32 m0, s53, 73728
    s_add_u32 s56, s56, 128
    buffer_load_dwordx4 v4, s[12:15], s56 offen offset:0 lds
    buffer_load_dwordx4 v5, s[12:15], s56 offen offset:1024 lds
    buffer_load_dwordx4 v6, s[12:15], s56 offen offset:2048 lds
    s_add_u32 m0, s53, 76800
    s_add_u32 s56, s56, 221184
    buffer_load_dwordx4 v4, s[12:15], s56 offen offset:0 lds
    buffer_load_dwordx4 v5, s[12:15], s56 offen offset:1024 lds
    buffer_load_dwordx4 v6, s[12:15], s56 offen offset:2048 lds
    s_add_u32 m0, s53, 79872
    s_add_u32 s56, s56, 221184
    buffer_load_dwordx4 v4, s[12:15], s56 offen offset:0 lds
    buffer_load_dwordx4 v5, s[12:15], s56 offen offset:1024 lds
    buffer_load_dwordx4 v6, s[12:15], s56 offen offset:2048 lds
    s_waitcnt lgkmcnt(0)
    s_barrier
    s_setprio 1
    v_add_u32 v13, 0, v11
    ds_read_b64_tr_b16 v[40:41], v13 offset:0
    ds_read_b64_tr_b16 v[42:43], v13 offset:512
    ds_read_b64_tr_b16 v[44:45], v13 offset:2048
    ds_read_b64_tr_b16 v[46:47], v13 offset:2560
    ds_read_b64_tr_b16 v[48:49], v13 offset:4096
    ds_read_b64_tr_b16 v[50:51], v13 offset:4608
    s_waitcnt lgkmcnt(4)
    v_mfma_f32_32x32x16_bf16 v[80:95], v[40:43], v[96:99], 0
    ds_read_b64_tr_b16 v[52:53], v13 offset:6144
    ds_read_b64_tr_b16 v[54:55], v13 offset:6656
    s_waitcnt lgkmcnt(4)
    v_mfma_f32_32x32x16_bf16 v[80:95], v[44:47], v[100:103], v[80:95]
    ds_read_b64_tr_b16 v[40:41], v13 offset:8192
    ds_read_b64_tr_b16 v[42:43], v13 offset:8704
    s_waitcnt lgkmcnt(4)
    v_mfma_f32_32x32x16_bf16 v[80:95], v[48:51], v[104:107], v[80:95]
    ds_read_b64_tr_b16 v[44:45], v13 offset:10240
    ds_read_b64_tr_b16 v[46:47], v13 offset:10752
    s_waitcnt lgkmcnt(4)
    v_mfma_f32_32x32x16_bf16 v[80:95], v[52:55], v[108:111], v[80:95]
    ds_read_b64_tr_b16 v[48:49], v13 offset:12288
    ds_read_b64_tr_b16 v[50:51], v13 offset:12800
    s_waitcnt lgkmcnt(4)
    v_mfma_f32_32x32x16_bf16 v[80:95], v[40:43], v[112:115], v[80:95]
    ds_read_b64_tr_b16 v[52:53], v13 offset:14336
    ds_read_b64_tr_b16 v[54:55], v13 offset:14848
    s_waitcnt lgkmcnt(4)
    v_mfma_f32_32x32x16_bf16 v[80:95], v[44:47], v[116:119], v[80:95]
    ds_read_b64_tr_b16 v[40:41], v13 offset:16384
    ds_read_b64_tr_b16 v[42:43], v13 offset:16896
    s_waitcnt lgkmcnt(4)
    v_mfma_f32_32x32x16_bf16 v[80:95], v[48:51], v[120:123], v[80:95]
    ds_read_b64_tr_b16 v[44:45], v13 offset:18432
    ds_read_b64_tr_b16 v[46:47], v13 offset:18944
    s_waitcnt lgkmcnt(4)
    v_mfma_f32_32x32x16_bf16 v[80:95], v[52:55], v[124:127], v[80:95]
    ds_read_b64_tr_b16 v[48:49], v13 offset:20480
    ds_read_b64_tr_b16 v[50:51], v13 offset:20992
    s_waitcnt lgkmcnt(4)
    v_mfma_f32_32x32x16_bf16 v[80:95], v[40:43], v[128:131], v[80:95]
    ds_read_b64_tr_b16 v[52:53], v13 offset:22528
    ds_read_b64_tr_b16 v[54:55], v13 offset:23040
    s_waitcnt lgkmcnt(4)
    v_mfma_f32_32x32x16_bf16 v[80:95], v[44:47], v[132:135], v[80:95]
    ds_read_b64_tr_b16 v[40:41], v13 offset:24576
    ds_read_b64_tr_b16 v[42:43], v13 offset:25088
    s_waitcnt lgkmcnt(4)
    v_mfma_f32_32x32x16_bf16 v[80:95], v[48:51], v[136:139], v[80:95]
    ds_read_b64_tr_b16 v[44:45], v13 offset:26624
    ds_read_b64_tr_b16 v[46:47], v13 offset:27136
    s_waitcnt lgkmcnt(4)
    v_mfma_f32_32x32x16_bf16 v[80:95], v[52:55], v[140:143], v[80:95]
    ds_read_b64_tr_b16 v[48:49], v13 offset:28672
    ds_read_b64_tr_b16 v[50:51], v13 offset:29184
    s_waitcnt lgkmcnt(4)
    v_mfma_f32_32x32x16_bf16 v[80:95], v[40:43], v[144:147], v[80:95]
    ds_read_b64_tr_b16 v[52:53], v13 offset:30720
    ds_read_b64_tr_b16 v[54:55], v13 offset:31232
    s_waitcnt lgkmcnt(4)
    v_mfma_f32_32x32x16_bf16 v[80:95], v[44:47], v[148:151], v[80:95]
    ds_read_b64_tr_b16 v[40:41], v13 offset:32768
    ds_read_b64_tr_b16 v[42:43], v13 offset:33280
    s_waitcnt lgkmcnt(4)
    v_mfma_f32_32x32x16_bf16 v[80:95], v[48:51], v[152:155], v[80:95]
    ds_read_b64_tr_b16 v[44:45], v13 offset:34816
    ds_read_b64_tr_b16 v[46:47], v13 offset:35328
    s_waitcnt lgkmcnt(4)
    v_mfma_f32_32x32x16_bf16 v[80:95], v[52:55], v[156:159], v[80:95]
    v_add_u32 v13, 36864, v11
    ds_read_b64_tr_b16 v[48:49], v13 offset:0
    ds_read_b64_tr_b16 v[50:51], v13 offset:512
    s_waitcnt lgkmcnt(4)
    v_mfma_f32_32x32x16_bf16 v[80:95], v[40:43], v[160:163], v[80:95]
    ds_read_b64_tr_b16 v[52:53], v13 offset:2048
    ds_read_b64_tr_b16 v[54:55], v13 offset:2560
    s_waitcnt lgkmcnt(4)
    v_mfma_f32_32x32x16_bf16 v[80:95], v[44:47], v[164:167], v[80:95]
    ds_read_b64_tr_b16 v[40:41], v13 offset:4096
    ds_read_b64_tr_b16 v[42:43], v13 offset:4608
    s_waitcnt lgkmcnt(4)
    v_mfma_f32_32x32x16_bf16 v[80:95], v[48:51], v[168:171], v[80:95]
    ds_read_b64_tr_b16 v[44:45], v13 offset:6144
    ds_read_b64_tr_b16 v[46:47], v13 offset:6656
    s_waitcnt lgkmcnt(4)
    v_mfma_f32_32x32x16_bf16 v[80:95], v[52:55], v[172:175], v[80:95]
    ds_read_b64_tr_b16 v[48:49], v13 offset:8192
    ds_read_b64_tr_b16 v[50:51], v13 offset:8704
    s_waitcnt lgkmcnt(4)
    v_mfma_f32_32x32x16_bf16 v[80:95], v[40:43], v[176:179], v[80:95]
    ds_read_b64_tr_b16 v[52:53], v13 offset:10240
    ds_read_b64_tr_b16 v[54:55], v13 offset:10752
    s_waitcnt lgkmcnt(4)
    v_mfma_f32_32x32x16_bf16 v[80:95], v[44:47], v[180:183], v[80:95]
    ds_read_b64_tr_b16 v[40:41], v13 offset:12288
    ds_read_b64_tr_b16 v[42:43], v13 offset:12800
    s_waitcnt lgkmcnt(4)
    v_mfma_f32_32x32x16_bf16 v[80:95], v[48:51], v[184:187], v[80:95]
    ds_read_b64_tr_b16 v[44:45], v13 offset:14336
    ds_read_b64_tr_b16 v[46:47], v13 offset:14848
    s_waitcnt lgkmcnt(4)
    v_mfma_f32_32x32x16_bf16 v[80:95], v[52:55], v[188:191], v[80:95]
    ds_read_b64_tr_b16 v[48:49], v13 offset:16384
    ds_read_b64_tr_b16 v[50:51], v13 offset:16896
    s_waitcnt lgkmcnt(4)
    v_mfma_f32_32x32x16_bf16 v[80:95], v[40:43], v[192:195], v[80:95]
    ds_read_b64_tr_b16 v[52:53], v13 offset:18432
    ds_read_b64_tr_b16 v[54:55], v13 offset:18944
    s_waitcnt lgkmcnt(4)
    v_mfma_f32_32x32x16_bf16 v[80:95], v[44:47], v[196:199], v[80:95]
    ds_read_b64_tr_b16 v[40:41], v13 offset:20480
    ds_read_b64_tr_b16 v[42:43], v13 offset:20992
    s_waitcnt lgkmcnt(4)
    v_mfma_f32_32x32x16_bf16 v[80:95], v[48:51], v[200:203], v[80:95]
    ds_read_b64_tr_b16 v[44:45], v13 offset:22528
    ds_read_b64_tr_b16 v[46:47], v13 offset:23040
    s_waitcnt lgkmcnt(4)
    v_mfma_f32_32x32x16_bf16 v[80:95], v[52:55], v[204:207], v[80:95]
    ds_read_b64_tr_b16 v[48:49], v13 offset:24576
    ds_read_b64_tr_b16 v[50:51], v13 offset:25088
    s_waitcnt lgkmcnt(4)
    v_mfma_f32_32x32x16_bf16 v[80:95], v[40:43], v[208:211], v[80:95]
    ds_read_b64_tr_b16 v[52:53], v13 offset:26624
    ds_read_b64_tr_b16 v[54:55], v13 offset:27136
    s_waitcnt lgkmcnt(4)
    v_mfma_f32_32x32x16_bf16 v[80:95], v[44:47], v[212:215], v[80:95]
    ds_read_b64_tr_b16 v[40:41], v13 offset:28672
    ds_read_b64_tr_b16 v[42:43], v13 offset:29184
    s_waitcnt lgkmcnt(4)
    v_mfma_f32_32x32x16_bf16 v[80:95], v[48:51], v[216:219], v[80:95]
    ds_read_b64_tr_b16 v[44:45], v13 offset:30720
    ds_read_b64_tr_b16 v[46:47], v13 offset:31232
    s_waitcnt lgkmcnt(4)
    v_mfma_f32_32x32x16_bf16 v[80:95], v[52:55], v[220:223], v[80:95]
    ds_read_b64_tr_b16 v[48:49], v13 offset:32768
    ds_read_b64_tr_b16 v[50:51], v13 offset:33280
    s_waitcnt lgkmcnt(4)
    v_mfma_f32_32x32x16_bf16 v[80:95], v[40:43], v[224:227], v[80:95]
    ds_read_b64_tr_b16 v[52:53], v13 offset:34816
    ds_read_b64_tr_b16 v[54:55], v13 offset:35328
    s_waitcnt vmcnt(0) lgkmcnt(0)
    s_barrier
    v_mfma_f32_32x32x16_bf16 v[80:95], v[44:47], v[228:231], v[80:95]
    v_mfma_f32_32x32x16_bf16 v[80:95], v[48:51], v[232:235], v[80:95]
    v_mfma_f32_32x32x16_bf16 v[80:95], v[52:55], v[236:239], v[80:95]
    s_setprio 0
    s_cmp_lg_u32 s40, 4
    s_cbranch_scc1 L1_tag
    v_mov_b32 v252, 0
    s_waitcnt vmcnt(0)
    v_cmp_ne_u32 vcc, 1, v245
    s_nop 4
    s_cbranch_vccz L1_tgd
    s_mov_b32 s45, 0
L1_tgl:
    global_load_dwordx2 v[244:245], v252, s[30:31] sc1
    s_waitcnt vmcnt(0)
    v_cmp_ne_u32 vcc, 1, v245
    s_nop 4
    s_cbranch_vccz L1_tgd
    s_sleep 8
    s_add_u32 s45, s45, 1
    s_cmp_lt_u32 s45, 0x4000
    s_cbranch_scc1 L1_tgl
L1_tgd:
    v_mov_b32 v252, 150016
    ds_write_b32 v252, v244
L1_tag:
    v_mul_f32 v20, v80, v80
    v_mul_f32 v21, v81, v81
    v_mul_f32 v22, v82, v82
    v_mul_f32 v23, v83, v83
    v_fma_f32 v20, v20, v0, v17
    v_fma_f32 v21, v21, v0, v17
    v_fma_f32 v22, v22, v0, v17
    v_fma_f32 v23, v23, v0, v17
    v_mul_f32 v20, v20, v80
    v_mul_f32 v21, v21, v81
    v_mul_f32 v22, v22, v82
    v_mul_f32 v23, v23, v83
    v_exp_f32 v20, v20
    v_exp_f32 v21, v21
    v_exp_f32 v22, v22
    v_exp_f32 v23, v23
    v_fma_f32 v20, v20, v2, v2
    v_fma_f32 v21, v21, v2, v2
    v_fma_f32 v22, v22, v2, v2
    s_mul_i32 s56, s46, 1327104
    s_add_u32 s56, s56, s48
    s_add_u32 m0, s53, 0
    s_add_u32 s56, s56, 0
    buffer_load_dwordx4 v248, s[12:15], s56 offen offset:0 lds
    v_fma_f32 v23, v23, v2, v2
    v_rcp_f32 v20, v20
    v_rcp_f32 v21, v21
    v_rcp_f32 v22, v22
    v_rcp_f32 v23, v23
    v_mul_f32 v80, v80, v20
    v_mul_f32 v81, v81, v21
    v_mul_f32 v82, v82, v22
    v_mul_f32 v83, v83, v23
    v_add_f32 v18, v18, v80
    v_fmac_f32 v19, v80, v80
    v_add_f32 v18, v18, v81
    v_fmac_f32 v19, v81, v81
    v_add_f32 v18, v18, v82
    v_fmac_f32 v19, v82, v82
    buffer_load_dwordx4 v249, s[12:15], s56 offen offset:1024 lds
    v_add_f32 v18, v18, v83
    v_fmac_f32 v19, v83, v83
    v_cvt_pk_bf16_f32 v56, v80, v81
    v_cvt_pk_bf16_f32 v57, v82, v83
    s_barrier
    v_mul_f32 v24, v84, v84
    v_mul_f32 v25, v85, v85
    v_mul_f32 v26, v86, v86
    v_mul_f32 v27, v87, v87
    v_fma_f32 v24, v24, v0, v17
    v_fma_f32 v25, v25, v0, v17
    v_fma_f32 v26, v26, v0, v17
    v_fma_f32 v27, v27, v0, v17
    v_mul_f32 v24, v24, v84
    v_mul_f32 v25, v25, v85
    buffer_load_dwordx4 v250, s[12:15], s56 offen offset:2048 lds
    v_mul_f32 v26, v26, v86
    v_mul_f32 v27, v27, v87
    v_exp_f32 v24, v24
    v_exp_f32 v25, v25
    v_exp_f32 v26, v26
    v_exp_f32 v27, v27
    v_fma_f32 v24, v24, v2, v2
    v_fma_f32 v25, v25, v2, v2
    v_fma_f32 v26, v26, v2, v2
    v_fma_f32 v27, v27, v2, v2
    v_rcp_f32 v24, v24
    v_rcp_f32 v25, v25
    v_rcp_f32 v26, v26
    v_rcp_f32 v27, v27
    v_mul_f32 v84, v84, v24
    s_add_u32 m0, s53, 3072
    s_add_u32 s56, s56, 442368
    buffer_load_dwordx4 v248, s[12:15], s56 offen offset:0 lds
    v_mul_f32 v85, v85, v25
    v_mul_f32 v86, v86, v26
    v_mul_f32 v87, v87, v27
    v_add_f32 v18, v18, v84
    v_fmac_f32 v19, v84, v84
    v_add_f32 v18, v18, v85
    v_fmac_f32 v19, v85, v85
    v_add_f32 v18, v18, v86
    v_fmac_f32 v19, v86, v86
    v_add_f32 v18, v18, v87
    v_fmac_f32 v19, v87, v87
    v_cvt_pk_bf16_f32 v58, v84, v85
    v_cvt_pk_bf16_f32 v59, v86, v87
    v_mul_f32 v20, v88, v88
    v_mul_f32 v21, v89, v89
    buffer_load_dwordx4 v249, s[12:15], s56 offen offset:1024 lds
    v_mul_f32 v22, v90, v90
    v_mul_f32 v23, v91, v91
    v_fma_f32 v20, v20, v0, v17
    v_fma_f32 v21, v21, v0, v17
    v_fma_f32 v22, v22, v0, v17
    v_fma_f32 v23, v23, v0, v17
    v_mul_f32 v20, v20, v88
    v_mul_f32 v21, v21, v89
    v_mul_f32 v22, v22, v90
    v_mul_f32 v23, v23, v91
    v_exp_f32 v20, v20
    v_exp_f32 v21, v21
    v_exp_f32 v22, v22
    v_exp_f32 v23, v23
    buffer_load_dwordx4 v250, s[12:15], s56 offen offset:2048 lds
    v_fma_f32 v20, v20, v2, v2
    v_fma_f32 v21, v21, v2, v2
    v_fma_f32 v22, v22, v2, v2
    v_fma_f32 v23, v23, v2, v2
    v_rcp_f32 v20, v20
    v_rcp_f32 v21, v21
    v_rcp_f32 v22, v22
    v_rcp_f32 v23, v23
    v_mul_f32 v88, v88, v20
    v_mul_f32 v89, v89, v21
    v_mul_f32 v90, v90, v22
    v_mul_f32 v91, v91, v23
    v_add_f32 v18, v18, v88
    v_fmac_f32 v19, v88, v88
    v_add_f32 v18, v18, v89
    s_add_u32 m0, s53, 6144
    s_add_u32 s56, s56, 442368
    buffer_load_dwordx4 v248, s[12:15], s56 offen offset:0 lds
    v_fmac_f32 v19, v89, v89
    v_add_f32 v18, v18, v90
    v_fmac_f32 v19, v90, v90
    v_add_f32 v18, v18, v91
    v_fmac_f32 v19, v91, v91
    v_cvt_pk_bf16_f32 v60, v88, v89
    v_cvt_pk_bf16_f32 v61, v90, v91
    v_mul_f32 v24, v92, v92
    v_mul_f32 v25, v93, v93
    v_mul_f32 v26, v94, v94
    v_mul_f32 v27, v95, v95
    v_fma_f32 v24, v24, v0, v17
    v_fma_f32 v25, v25, v0, v17
    v_fma_f32 v26, v26, v0, v17
    v_fma_f32 v27, v27, v0, v17
    buffer_load_dwordx4 v249, s[12:15], s56 offen offset:1024 lds
    v_mul_f32 v24, v24, v92
    v_mul_f32 v25, v25, v93
    v_mul_f32 v26, v26, v94
    v_mul_f32 v27, v27, v95
    v_exp_f32 v24, v24
    v_exp_f32 v25, v25
    v_exp_f32 v26, v26
    v_exp_f32 v27, v27
    v_fma_f32 v24, v24, v2, v2
    v_fma_f32 v25, v25, v2, v2
    v_fma_f32 v26, v26, v2, v2
    v_fma_f32 v27, v27, v2, v2
    v_rcp_f32 v24, v24
    v_rcp_f32 v25, v25
    buffer_load_dwordx4 v250, s[12:15], s56 offen offset:2048 lds
    v_rcp_f32 v26, v26
    v_rcp_f32 v27, v27
    v_mul_f32 v92, v92, v24
    v_mul_f32 v93, v93, v25
    v_mul_f32 v94, v94, v26
    v_mul_f32 v95, v95, v27
    v_add_f32 v18, v18, v92
    v_fmac_f32 v19, v92, v92
    v_add_f32 v18, v18, v93
    v_fmac_f32 v19, v93, v93
    v_add_f32 v18, v18, v94
    v_fmac_f32 v19, v94, v94
    v_add_f32 v18, v18, v95
    v_fmac_f32 v19, v95, v95
    v_cvt_pk_bf16_f32 v62, v92, v93
    v_cvt_pk_bf16_f32 v63, v94, v95
    s_waitcnt lgkmcnt(0)
    s_barrier
    s_setprio 1
    v_add_u32 v13, 73728, v11
    ds_read_b64_tr_b16 v[40:41], v13 offset:0
    ds_read_b64_tr_b16 v[42:43], v13 offset:512
    ds_read_b64_tr_b16 v[44:45], v13 offset:2048
    ds_read_b64_tr_b16 v[46:47], v13 offset:2560
    ds_read_b64_tr_b16 v[48:49], v13 offset:4096
    ds_read_b64_tr_b16 v[50:51], v13 offset:4608
    s_waitcnt lgkmcnt(4)
    v_mfma_f32_32x32x16_bf16 v[80:95], v[40:43], v[96:99], 0
    ds_read_b64_tr_b16 v[52:53], v13 offset:6144
    ds_read_b64_tr_b16 v[54:55], v13 offset:6656
    s_waitcnt lgkmcnt(4)
    v_mfma_f32_32x32x16_bf16 v[80:95], v[44:47], v[100:103], v[80:95]
    ds_read_b64_tr_b16 v[40:41], v13 offset:8192
    ds_read_b64_tr_b16 v[42:43], v13 offset:8704
    s_waitcnt lgkmcnt(4)
    v_mfma_f32_32x32x16_bf16 v[80:95], v[48:51], v[104:107], v[80:95]
    ds_read_b64_tr_b16 v[44:45], v13 offset:10240
    ds_read_b64_tr_b16 v[46:47], v13 offset:10752
    s_waitcnt lgkmcnt(4)
    v_mfma_f32_32x32x16_bf16 v[80:95], v[52:55], v[108:111], v[80:95]
    ds_read_b64_tr_b16 v[48:49], v13 offset:12288
    ds_read_b64_tr_b16 v[50:51], v13 offset:12800
    s_waitcnt lgkmcnt(4)
    v_mfma_f32_32x32x16_bf16 v[80:95], v[40:43], v[112:115], v[80:95]
    ds_read_b64_tr_b16 v[52:53], v13 offset:14336
    ds_read_b64_tr_b16 v[54:55], v13 offset:14848
    s_waitcnt lgkmcnt(4)
    v_mfma_f32_32x32x16_bf16 v[80:95], v[44:47], v[116:119], v[80:95]
    ds_read_b64_tr_b16 v[40:41], v13 offset:16384
    ds_read_b64_tr_b16 v[42:43], v13 offset:16896
    s_waitcnt lgkmcnt(4)
    v_mfma_f32_32x32x16_bf16 v[80:95], v[48:51], v[120:123], v[80:95]
    ds_read_b64_tr_b16 v[44:45], v13 offset:18432
    ds_read_b64_tr_b16 v[46:47], v13 offset:18944
    s_waitcnt lgkmcnt(4)
    v_mfma_f32_32x32x16_bf16 v[80:95], v[52:55], v[124:127], v[80:95]
    ds_read_b64_tr_b16 v[48:49], v13 offset:20480
    ds_read_b64_tr_b16 v[50:51], v13 offset:20992
    s_waitcnt lgkmcnt(4)
    v_mfma_f32_32x32x16_bf16 v[80:95], v[40:43], v[128:131], v[80:95]
    ds_read_b64_tr_b16 v[52:53], v13 offset:22528
    ds_read_b64_tr_b16 v[54:55], v13 offset:23040
    s_waitcnt lgkmcnt(4)
    v_mfma_f32_32x32x16_bf16 v[80:95], v[44:47], v[132:135], v[80:95]
    ds_read_b64_tr_b16 v[40:41], v13 offset:24576
    ds_read_b64_tr_b16 v[42:43], v13 offset:25088
    s_waitcnt lgkmcnt(4)
    v_mfma_f32_32x32x16_bf16 v[80:95], v[48:51], v[136:139], v[80:95]
    ds_read_b64_tr_b16 v[44:45], v13 offset:26624
    ds_read_b64_tr_b16 v[46:47], v13 offset:27136
    s_waitcnt lgkmcnt(4)
    v_mfma_f32_32x32x16_bf16 v[80:95], v[52:55], v[140:143], v[80:95]
    ds_read_b64_tr_b16 v[48:49], v13 offset:28672
    ds_read_b64_tr_b16 v[50:51], v13 offset:29184
    s_waitcnt lgkmcnt(4)
    v_mfma_f32_32x32x16_bf16 v[80:95], v[40:43], v[144:147], v[80:95]
    ds_read_b64_tr_b16 v[52:53], v13 offset:30720
    ds_read_b64_tr_b16 v[54:55], v13 offset:31232
    s_waitcnt lgkmcnt(4)
    v_mfma_f32_32x32x16_bf16 v[80:95], v[44:47], v[148:151], v[80:95]
    ds_read_b64_tr_b16 v[40:41], v13 offset:32768
    ds_read_b64_tr_b16 v[42:43], v13 offset:33280
    s_waitcnt lgkmcnt(4)
    v_mfma_f32_32x32x16_bf16 v[80:95], v[48:51], v[152:155], v[80:95]
    ds_read_b64_tr_b16 v[44:45], v13 offset:34816
    ds_read_b64_tr_b16 v[46:47], v13 offset:35328
    s_waitcnt lgkmcnt(4)
    v_mfma_f32_32x32x16_bf16 v[80:95], v[52:55], v[156:159], v[80:95]
    v_add_u32 v13, 110592, v11
    ds_read_b64_tr_b16 v[48:49], v13 offset:0
    ds_read_b64_tr_b16 v[50:51], v13 offset:512
    s_waitcnt lgkmcnt(4)
    v_mfma_f32_32x32x16_bf16 v[80:95], v[40:43], v[160:163], v[80:95]
    ds_read_b64_tr_b16 v[52:53], v13 offset:2048
    ds_read_b64_tr_b16 v[54:55], v13 offset:2560
    s_waitcnt lgkmcnt(4)
    v_mfma_f32_32x32x16_bf16 v[80:95], v[44:47], v[164:167], v[80:95]
    ds_read_b64_tr_b16 v[40:41], v13 offset:4096
    ds_read_b64_tr_b16 v[42:43], v13 offset:4608
    s_waitcnt lgkmcnt(4)
    v_mfma_f32_32x32x16_bf16 v[80:95], v[48:51], v[168:171], v[80:95]
    ds_read_b64_tr_b16 v[44:45], v13 offset:6144
    ds_read_b64_tr_b16 v[46:47], v13 offset:6656
    s_waitcnt lgkmcnt(4)
    v_mfma_f32_32x32x16_bf16 v[80:95], v[52:55], v[172:175], v[80:95]
    ds_read_b64_tr_b16 v[48:49], v13 offset:8192
    ds_read_b64_tr_b16 v[50:51], v13 offset:8704
    s_waitcnt lgkmcnt(4)
    v_mfma_f32_32x32x16_bf16 v[80:95], v[40:43], v[176:179], v[80:95]
    ds_read_b64_tr_b16 v[52:53], v13 offset:10240
    ds_read_b64_tr_b16 v[54:55], v13 offset:10752
    s_waitcnt lgkmcnt(4)
    v_mfma_f32_32x32x16_bf16 v[80:95], v[44:47], v[180:183], v[80:95]
    ds_read_b64_tr_b16 v[40:41], v13 offset:12288
    ds_read_b64_tr_b16 v[42:43], v13 offset:12800
    s_waitcnt lgkmcnt(4)
    v_mfma_f32_32x32x16_bf16 v[80:95], v[48:51], v[184:187], v[80:95]
    ds_read_b64_tr_b16 v[44:45], v13 offset:14336
    ds_read_b64_tr_b16 v[46:47], v13 offset:14848
    s_waitcnt lgkmcnt(4)
    v_mfma_f32_32x32x16_bf16 v[80:95], v[52:55], v[188:191], v[80:95]
    ds_read_b64_tr_b16 v[48:49], v13 offset:16384
    ds_read_b64_tr_b16 v[50:51], v13 offset:16896
    s_waitcnt lgkmcnt(4)
    v_mfma_f32_32x32x16_bf16 v[80:95], v[40:43], v[192:195], v[80:95]
    ds_read_b64_tr_b16 v[52:53], v13 offset:18432
    ds_read_b64_tr_b16 v[54:55], v13 offset:18944
    s_waitcnt lgkmcnt(4)
    v_mfma_f32_32x32x16_bf16 v[80:95], v[44:47], v[196:199], v[80:95]
    ds_read_b64_tr_b16 v[40:41], v13 offset:20480
    ds_read_b64_tr_b16 v[42:43], v13 offset:20992
    s_waitcnt lgkmcnt(4)
    v_mfma_f32_32x32x16_bf16 v[80:95], v[48:51], v[200:203], v[80:95]
    ds_read_b64_tr_b16 v[44:45], v13 offset:22528
    ds_read_b64_tr_b16 v[46:47], v13 offset:23040
    s_waitcnt lgkmcnt(4)
    v_mfma_f32_32x32x16_bf16 v[80:95], v[52:55], v[204:207], v[80:95]
    ds_read_b64_tr_b16 v[48:49], v13 offset:24576
    ds_read_b64_tr_b16 v[50:51], v13 offset:25088
    s_waitcnt lgkmcnt(4)
    v_mfma_f32_32x32x16_bf16 v[80:95], v[40:43], v[208:211], v[80:95]
    ds_read_b64_tr_b16 v[52:53], v13 offset:26624
    ds_read_b64_tr_b16 v[54:55], v13 offset:27136
    s_waitcnt lgkmcnt(4)
    v_mfma_f32_32x32x16_bf16 v[80:95], v[44:47], v[212:215], v[80:95]
    ds_read_b64_tr_b16 v[40:41], v13 offset:28672
    ds_read_b64_tr_b16 v[42:43], v13 offset:29184
    s_waitcnt lgkmcnt(4)
    v_mfma_f32_32x32x16_bf16 v[80:95], v[48:51], v[216:219], v[80:95]
    ds_read_b64_tr_b16 v[44:45], v13 offset:30720
    ds_read_b64_tr_b16 v[46:47], v13 offset:31232
    s_waitcnt lgkmcnt(4)
    v_mfma_f32_32x32x16_bf16 v[80:95], v[52:55], v[220:223], v[80:95]
    ds_read_b64_tr_b16 v[48:49], v13 offset:32768
    ds_read_b64_tr_b16 v[50:51], v13 offset:33280
    s_waitcnt lgkmcnt(4)
    v_mfma_f32_32x32x16_bf16 v[80:95], v[40:43], v[224:227], v[80:95]
    ds_read_b64_tr_b16 v[52:53], v13 offset:34816
    ds_read_b64_tr_b16 v[54:55], v13 offset:35328
    s_waitcnt vmcnt(0) lgkmcnt(0)
    s_barrier
    v_mfma_f32_32x32x16_bf16 v[80:95], v[44:47], v[228:231], v[80:95]
    v_mfma_f32_32x32x16_bf16 v[80:95], v[48:51], v[232:235], v[80:95]
    v_mfma_f32_32x32x16_bf16 v[80:95], v[52:55], v[236:239], v[80:95]
    s_setprio 0
    v_mov_b32 v252, 150016
    ds_read_b32 v252, v252
    s_waitcnt lgkmcnt(0)
    v_readfirstlane_b32 s26, v252
    s_nop 6
    v_mul_f32 v20, v80, v80
    v_mul_f32 v21, v81, v81
    v_mul_f32 v22, v82, v82
    v_mul_f32 v23, v83, v83
    v_fma_f32 v20, v20, v0, v17
    v_fma_f32 v21, v21, v0, v17
    v_fma_f32 v22, v22, v0, v17
    v_fma_f32 v23, v23, v0, v17
    v_mul_f32 v20, v20, v80
    v_mul_f32 v21, v21, v81
    v_mul_f32 v22, v22, v82
    v_mul_f32 v23, v23, v83
    v_exp_f32 v20, v20
    v_exp_f32 v21, v21
    v_exp_f32 v22, v22
    v_exp_f32 v23, v23
    v_fma_f32 v20, v20, v2, v2
    v_fma_f32 v21, v21, v2, v2
    s_mul_i32 s56, s46, 248832
    s_add_u32 s56, s56, s51
    s_add_u32 m0, s53, 73728
    s_add_u32 s56, s56, 995328
    buffer_load_dwordx4 v7, s[16:19], s56 offen offset:0 lds
    v_fma_f32 v22, v22, v2, v2
    v_fma_f32 v23, v23, v2, v2
    v_rcp_f32 v20, v20
    v_rcp_f32 v21, v21
    v_rcp_f32 v22, v22
    v_rcp_f32 v23, v23
    v_mul_f32 v80, v80, v20
    v_mul_f32 v81, v81, v21
    v_mul_f32 v82, v82, v22
    v_mul_f32 v83, v83, v23
    v_add_f32 v18, v18, v80
    v_fmac_f32 v19, v80, v80
    v_add_f32 v18, v18, v81
    buffer_load_dwordx4 v8, s[16:19], s56 offen offset:1024 lds
    v_fmac_f32 v19, v81, v81
    v_add_f32 v18, v18, v82
    v_fmac_f32 v19, v82, v82
    v_add_f32 v18, v18, v83
    v_fmac_f32 v19, v83, v83
    v_cvt_pk_bf16_f32 v64, v80, v81
    v_cvt_pk_bf16_f32 v65, v82, v83
    v_mul_f32 v24, v84, v84
    v_mul_f32 v25, v85, v85
    v_mul_f32 v26, v86, v86
    v_mul_f32 v27, v87, v87
    v_fma_f32 v24, v24, v0, v17
    v_fma_f32 v25, v25, v0, v17
    buffer_load_dwordx4 v9, s[16:19], s56 offen offset:2048 lds
    v_fma_f32 v26, v26, v0, v17
    v_fma_f32 v27, v27, v0, v17
    v_mul_f32 v24, v24, v84
    v_mul_f32 v25, v25, v85
    v_mul_f32 v26, v26, v86
    v_mul_f32 v27, v27, v87
    v_exp_f32 v24, v24
    v_exp_f32 v25, v25
    v_exp_f32 v26, v26
    v_exp_f32 v27, v27
    v_fma_f32 v24, v24, v2, v2
    v_fma_f32 v25, v25, v2, v2
    v_fma_f32 v26, v26, v2, v2
    v_fma_f32 v27, v27, v2, v2
    s_add_u32 m0, s53, 76800
    s_add_u32 s56, s56, 82944
    buffer_load_dwordx4 v7, s[16:19], s56 offen offset:0 lds
    v_rcp_f32 v24, v24
    v_rcp_f32 v25, v25
    v_rcp_f32 v26, v26
    v_rcp_f32 v27, v27
    v_mul_f32 v84, v84, v24
    v_mul_f32 v85, v85, v25
    v_mul_f32 v86, v86, v26
    v_mul_f32 v87, v87, v27
    v_add_f32 v18, v18, v84
    v_fmac_f32 v19, v84, v84
    v_add_f32 v18, v18, v85
    v_fmac_f32 v19, v85, v85
    v_add_f32 v18, v18, v86
    buffer_load_dwordx4 v8, s[16:19], s56 offen offset:1024 lds
    v_fmac_f32 v19, v86, v86
    v_add_f32 v18, v18, v87
    v_fmac_f32 v19, v87, v87
    v_cvt_pk_bf16_f32 v66, v84, v85
    v_cvt_pk_bf16_f32 v67, v86, v87
    v_mul_f32 v20, v88, v88
    v_mul_f32 v21, v89, v89
    v_mul_f32 v22, v90, v90
    v_mul_f32 v23, v91, v91
    v_fma_f32 v20, v20, v0, v17
    v_fma_f32 v21, v21, v0, v17
    v_fma_f32 v22, v22, v0, v17
    v_fma_f32 v23, v23, v0, v17
    buffer_load_dwordx4 v9, s[16:19], s56 offen offset:2048 lds
    v_mul_f32 v20, v20, v88
    v_mul_f32 v21, v21, v89
    v_mul_f32 v22, v22, v90
    v_mul_f32 v23, v23, v91
    v_exp_f32 v20, v20
    v_exp_f32 v21, v21
    v_exp_f32 v22, v22
    v_exp_f32 v23, v23
    v_fma_f32 v20, v20, v2, v2
    v_fma_f32 v21, v21, v2, v2
    v_fma_f32 v22, v22, v2, v2
    v_fma_f32 v23, v23, v2, v2
    v_rcp_f32 v20, v20
    v_rcp_f32 v21, v21
    s_add_u32 m0, s53, 79872
    s_add_u32 s56, s56, 82944
    buffer_load_dwordx4 v7, s[16:19], s56 offen offset:0 lds
    v_rcp_f32 v22, v22
    v_rcp_f32 v23, v23
    v_mul_f32 v88, v88, v20
    v_mul_f32 v89, v89, v21
    v_mul_f32 v90, v90, v22
    v_mul_f32 v91, v91, v23
    v_add_f32 v18, v18, v88
    v_fmac_f32 v19, v88, v88
    v_add_f32 v18, v18, v89
    v_fmac_f32 v19, v89, v89
    v_add_f32 v18, v18, v90
    v_fmac_f32 v19, v90, v90
    v_add_f32 v18, v18, v91
    buffer_load_dwordx4 v8, s[16:19], s56 offen offset:1024 lds
    v_fmac_f32 v19, v91, v91
    v_cvt_pk_bf16_f32 v68, v88, v89
    v_cvt_pk_bf16_f32 v69, v90, v91
    v_mul_f32 v24, v92, v92
    v_mul_f32 v25, v93, v93
    v_mul_f32 v26, v94, v94
    v_mul_f32 v27, v95, v95
    v_fma_f32 v24, v24, v0, v17
    v_fma_f32 v25, v25, v0, v17
    v_fma_f32 v26, v26, v0, v17
    v_fma_f32 v27, v27, v0, v17
    v_mul_f32 v24, v24, v92
    v_mul_f32 v25, v25, v93
    buffer_load_dwordx4 v9, s[16:19], s56 offen offset:2048 lds
    v_mul_f32 v26, v26, v94
    v_mul_f32 v27, v27, v95
    v_exp_f32 v24, v24
    v_exp_f32 v25, v25
    v_exp_f32 v26, v26
    v_exp_f32 v27, v27
    v_fma_f32 v24, v24, v2, v2
    v_fma_f32 v25, v25, v2, v2
    v_fma_f32 v26, v26, v2, v2
    v_fma_f32 v27, v27, v2, v2
    v_rcp_f32 v24, v24
    v_rcp_f32 v25, v25
    v_rcp_f32 v26, v26
    s_mul_i32 s43, s51, 32
    s_lshr_b32 s43, s43, 6
    s_add_u32 s43, s43, 0
    s_min_u32 s43, s43, 1696
    v_lshrrev_b32 v36, 5, v1
    v_lshlrev_b32 v36, 4, v36
    v_add_u32 v36, s43, v36
    global_load_dwordx4 v[36:39], v36, s[54:55]
    v_rcp_f32 v27, v27
    v_mul_f32 v92, v92, v24
    v_mul_f32 v93, v93, v25
    v_mul_f32 v94, v94, v26
    v_mul_f32 v95, v95, v27
    v_add_f32 v18, v18, v92
    v_fmac_f32 v19, v92, v92
    v_add_f32 v18, v18, v93
    v_fmac_f32 v19, v93, v93
    v_add_f32 v18, v18, v94
    v_fmac_f32 v19, v94, v94
    v_add_f32 v18, v18, v95
    v_fmac_f32 v19, v95, v95
    v_cvt_pk_bf16_f32 v70, v92, v93
    v_cvt_pk_bf16_f32 v71, v94, v95
    v_mov_b32 v20, v18
    v_mov_b32 v21, v19
    v_and_b32 v22, 31, v1
    v_lshlrev_b32 v22, 3, v22
    v_permlane32_swap_b32 v20, v18
    v_permlane32_swap_b32 v21, v19
    s_lshl_b32 s43, s46, 8
    s_add_u32 s43, s43, 148480
    v_add_u32 v22, s43, v22
    v_add_f32 v20, v20, v18
    v_add_f32 v21, v21, v19
    ds_write_b64 v22, v[20:21]
    s_waitcnt lgkmcnt(0)
    s_barrier
    s_setprio 1
    v_add_u32 v13, 36864, v10
    ds_read_b64_tr_b16 v[40:41], v13 offset:0
    ds_read_b64_tr_b16 v[42:43], v13 offset:512
    ds_read_b64_tr_b16 v[44:45], v13 offset:2048
    ds_read_b64_tr_b16 v[46:47], v13 offset:2560
    ds_read_b64_tr_b16 v[48:49], v13 offset:4096
    ds_read_b64_tr_b16 v[50:51], v13 offset:4608
    s_waitcnt lgkmcnt(4)
    v_mfma_f32_32x32x16_bf16 v[80:95], v[40:43], v[96:99], 0
    ds_read_b64_tr_b16 v[52:53], v13 offset:6144
    ds_read_b64_tr_b16 v[54:55], v13 offset:6656
    s_waitcnt lgkmcnt(4)
    v_mfma_f32_32x32x16_bf16 v[80:95], v[44:47], v[100:103], v[80:95]
    ds_read_b64_tr_b16 v[40:41], v13 offset:8192
    ds_read_b64_tr_b16 v[42:43], v13 offset:8704
    s_waitcnt lgkmcnt(4)
    v_mfma_f32_32x32x16_bf16 v[80:95], v[48:51], v[104:107], v[80:95]
    ds_read_b64_tr_b16 v[44:45], v13 offset:10240
    ds_read_b64_tr_b16 v[46:47], v13 offset:10752
    s_waitcnt lgkmcnt(4)
    v_mfma_f32_32x32x16_bf16 v[80:95], v[52:55], v[108:111], v[80:95]
    ds_read_b64_tr_b16 v[48:49], v13 offset:12288
    ds_read_b64_tr_b16 v[50:51], v13 offset:12800
    s_waitcnt lgkmcnt(4)
    v_mfma_f32_32x32x16_bf16 v[80:95], v[40:43], v[112:115], v[80:95]
    ds_read_b64_tr_b16 v[52:53], v13 offset:14336
    ds_read_b64_tr_b16 v[54:55], v13 offset:14848
    s_waitcnt lgkmcnt(4)
    v_mfma_f32_32x32x16_bf16 v[80:95], v[44:47], v[116:119], v[80:95]
    ds_read_b64_tr_b16 v[40:41], v13 offset:16384
    ds_read_b64_tr_b16 v[42:43], v13 offset:16896
    s_waitcnt lgkmcnt(4)
    v_mfma_f32_32x32x16_bf16 v[80:95], v[48:51], v[120:123], v[80:95]
    ds_read_b64_tr_b16 v[44:45], v13 offset:18432
    ds_read_b64_tr_b16 v[46:47], v13 offset:18944
    s_waitcnt lgkmcnt(4)
    v_mfma_f32_32x32x16_bf16 v[80:95], v[52:55], v[124:127], v[80:95]
    ds_read_b64_tr_b16 v[48:49], v13 offset:20480
    ds_read_b64_tr_b16 v[50:51], v13 offset:20992
    s_waitcnt lgkmcnt(4)
    v_mfma_f32_32x32x16_bf16 v[80:95], v[40:43], v[128:131], v[80:95]
    ds_read_b64_tr_b16 v[52:53], v13 offset:22528
    ds_read_b64_tr_b16 v[54:55], v13 offset:23040
    s_waitcnt lgkmcnt(4)
    v_mfma_f32_32x32x16_bf16 v[80:95], v[44:47], v[132:135], v[80:95]
    ds_read_b64_tr_b16 v[40:41], v13 offset:24576
    ds_read_b64_tr_b16 v[42:43], v13 offset:25088
    s_waitcnt lgkmcnt(4)
    v_mfma_f32_32x32x16_bf16 v[80:95], v[48:51], v[136:139], v[80:95]
    ds_read_b64_tr_b16 v[44:45], v13 offset:26624
    ds_read_b64_tr_b16 v[46:47], v13 offset:27136
    s_waitcnt lgkmcnt(4)
    v_mfma_f32_32x32x16_bf16 v[80:95], v[52:55], v[140:143], v[80:95]
    ds_read_b64_tr_b16 v[48:49], v13 offset:28672
    ds_read_b64_tr_b16 v[50:51], v13 offset:29184
    s_waitcnt lgkmcnt(4)
    v_mfma_f32_32x32x16_bf16 v[80:95], v[40:43], v[144:147], v[80:95]
    ds_read_b64_tr_b16 v[52:53], v13 offset:30720
    ds_read_b64_tr_b16 v[54:55], v13 offset:31232
    s_waitcnt lgkmcnt(4)
    v_mfma_f32_32x32x16_bf16 v[80:95], v[44:47], v[148:151], v[80:95]
    ds_read_b64_tr_b16 v[40:41], v13 offset:32768
    ds_read_b64_tr_b16 v[42:43], v13 offset:33280
    s_waitcnt lgkmcnt(4)
    v_mfma_f32_32x32x16_bf16 v[80:95], v[48:51], v[152:155], v[80:95]
    ds_read_b64_tr_b16 v[44:45], v13 offset:34816
    ds_read_b64_tr_b16 v[46:47], v13 offset:35328
    s_waitcnt lgkmcnt(4)
    v_mfma_f32_32x32x16_bf16 v[80:95], v[52:55], v[156:159], v[80:95]
    s_waitcnt vmcnt(1)
    s_barrier
    v_add_u32 v13, 73728, v10
    ds_read_b64_tr_b16 v[48:49], v13 offset:0
    ds_read_b64_tr_b16 v[50:51], v13 offset:512
    s_waitcnt lgkmcnt(4)
    v_mfma_f32_32x32x16_bf16 v[80:95], v[40:43], v[160:163], v[80:95]
    ds_read_b64_tr_b16 v[52:53], v13 offset:2048
    ds_read_b64_tr_b16 v[54:55], v13 offset:2560
    s_waitcnt lgkmcnt(4)
    v_mfma_f32_32x32x16_bf16 v[80:95], v[44:47], v[164:167], v[80:95]
    ds_read_b64_tr_b16 v[40:41], v13 offset:4096
    ds_read_b64_tr_b16 v[42:43], v13 offset:4608
    s_waitcnt lgkmcnt(4)
    v_mfma_f32_32x32x16_bf16 v[80:95], v[48:51], v[168:171], v[80:95]
    ds_read_b64_tr_b16 v[44:45], v13 offset:6144
    ds_read_b64_tr_b16 v[46:47], v13 offset:6656
    s_waitcnt lgkmcnt(4)
    v_mfma_f32_32x32x16_bf16 v[80:95], v[52:55], v[172:175], v[80:95]
    ds_read_b64_tr_b16 v[48:49], v13 offset:8192
    ds_read_b64_tr_b16 v[50:51], v13 offset:8704
    s_waitcnt lgkmcnt(4)
    v_mfma_f32_32x32x16_bf16 v[80:95], v[40:43], v[176:179], v[80:95]
    ds_read_b64_tr_b16 v[52:53], v13 offset:10240
    ds_read_b64_tr_b16 v[54:55], v13 offset:10752
    s_waitcnt lgkmcnt(4)
    v_mfma_f32_32x32x16_bf16 v[80:95], v[44:47], v[180:183], v[80:95]
    ds_read_b64_tr_b16 v[40:41], v13 offset:12288
    ds_read_b64_tr_b16 v[42:43], v13 offset:12800
    s_waitcnt lgkmcnt(4)
    v_mfma_f32_32x32x16_bf16 v[80:95], v[48:51], v[184:187], v[80:95]
    ds_read_b64_tr_b16 v[44:45], v13 offset:14336
    ds_read_b64_tr_b16 v[46:47], v13 offset:14848
    s_waitcnt lgkmcnt(4)
    v_mfma_f32_32x32x16_bf16 v[80:95], v[52:55], v[188:191], v[80:95]
    ds_read_b64_tr_b16 v[48:49], v13 offset:16384
    ds_read_b64_tr_b16 v[50:51], v13 offset:16896
    s_waitcnt lgkmcnt(4)
    v_mfma_f32_32x32x16_bf16 v[80:95], v[40:43], v[192:195], v[80:95]
    ds_read_b64_tr_b16 v[52:53], v13 offset:18432
    ds_read_b64_tr_b16 v[54:55], v13 offset:18944
    s_waitcnt lgkmcnt(4)
    v_mfma_f32_32x32x16_bf16 v[80:95], v[44:47], v[196:199], v[80:95]
    ds_read_b64_tr_b16 v[40:41], v13 offset:20480
    ds_read_b64_tr_b16 v[42:43], v13 offset:20992
    s_waitcnt lgkmcnt(4)
    v_mfma_f32_32x32x16_bf16 v[80:95], v[48:51], v[200:203], v[80:95]
    ds_read_b64_tr_b16 v[44:45], v13 offset:22528
    ds_read_b64_tr_b16 v[46:47], v13 offset:23040
    s_waitcnt lgkmcnt(4)
    v_mfma_f32_32x32x16_bf16 v[80:95], v[52:55], v[204:207], v[80:95]
    ds_read_b64_tr_b16 v[48:49], v13 offset:24576
    ds_read_b64_tr_b16 v[50:51], v13 offset:25088
    s_waitcnt lgkmcnt(4)
    v_mfma_f32_32x32x16_bf16 v[80:95], v[40:43], v[208:211], v[80:95]
    ds_read_b64_tr_b16 v[52:53], v13 offset:26624
    ds_read_b64_tr_b16 v[54:55], v13 offset:27136
    s_waitcnt lgkmcnt(4)
    v_mfma_f32_32x32x16_bf16 v[80:95], v[44:47], v[212:215], v[80:95]
    ds_read_b64_tr_b16 v[40:41], v13 offset:28672
    ds_read_b64_tr_b16 v[42:43], v13 offset:29184
    s_waitcnt lgkmcnt(4)
    v_mfma_f32_32x32x16_bf16 v[80:95], v[48:51], v[216:219], v[80:95]
    ds_read_b64_tr_b16 v[44:45], v13 offset:30720
    ds_read_b64_tr_b16 v[46:47], v13 offset:31232
    s_waitcnt lgkmcnt(4)
    v_mfma_f32_32x32x16_bf16 v[80:95], v[52:55], v[220:223], v[80:95]
    ds_read_b64_tr_b16 v[48:49], v13 offset:32768
    ds_read_b64_tr_b16 v[50:51], v13 offset:33280
    s_waitcnt lgkmcnt(4)
    v_mfma_f32_32x32x16_bf16 v[80:95], v[40:43], v[224:227], v[80:95]
    ds_read_b64_tr_b16 v[52:53], v13 offset:34816
    ds_read_b64_tr_b16 v[54:55], v13 offset:35328
    s_waitcnt lgkmcnt(0)
    s_barrier
    v_mfma_f32_32x32x16_bf16 v[80:95], v[44:47], v[228:231], v[80:95]
    v_mfma_f32_32x32x16_bf16 v[80:95], v[48:51], v[232:235], v[80:95]
    v_mfma_f32_32x32x16_bf16 v[80:95], v[52:55], v[236:239], v[80:95]
    s_setprio 0
    s_cmp_lg_u32 s40, 4
    s_cbranch_scc1 L1_pub0
    v_lshlrev_b32 v248, 4, v1
    v_add_u32 v249, 147456, v248
    ds_read_b128 v[240:243], v249
    ds_read_b128 v[244:247], v249 offset:1024
    s_lshl_b32 s43, s41, 4
    s_add_u32 s43, s43, s42
    s_lshl_b32 s43, s43, 10
    s_add_u32 s43, s43, 46137344
    s_waitcnt lgkmcnt(0)
    v_add_f32 v240, v240, v244
    v_add_f32 v241, v241, v245
    v_add_f32 v242, v242, v246
    v_add_f32 v243, v243, v247
    buffer_store_dwordx4 v[240:243], v248, s[20:23], s43 offen sc1
L1_pub0:
    s_mul_i32 s56, s46, 248832
    s_add_u32 s56, s56, s70
    s_add_u32 m0, s53, 0
    s_add_u32 s56, s56, 995456
    buffer_load_dwordx4 v7, s[16:19], s56 offen offset:0 lds
    buffer_load_dwordx4 v8, s[16:19], s56 offen offset:1024 lds
    buffer_load_dwordx4 v9, s[16:19], s56 offen offset:2048 lds
    s_add_u32 m0, s53, 3072
    s_add_u32 s56, s56, 82944
    buffer_load_dwordx4 v7, s[16:19], s56 offen offset:0 lds
    buffer_load_dwordx4 v8, s[16:19], s56 offen offset:1024 lds
    buffer_load_dwordx4 v9, s[16:19], s56 offen offset:2048 lds
    s_add_u32 m0, s53, 6144
    s_add_u32 s56, s56, 82944
    buffer_load_dwordx4 v7, s[16:19], s56 offen offset:0 lds
    buffer_load_dwordx4 v8, s[16:19], s56 offen offset:1024 lds
    buffer_load_dwordx4 v9, s[16:19], s56 offen offset:2048 lds
    s_add_u32 s43, s51, 0
    s_cmp_lt_u32 s43, 1152
    s_cselect_b32 s43, 0xbe173fd8, s52
    s_waitcnt vmcnt(9)
    v_mul_f32 v32, s43, v17
    v_add_u32 v28, v16, v36
    v_add_u32 v29, v16, v37
    v_add_u32 v30, v16, v38
    v_add_u32 v31, v16, v39
    s_mul_i32 s43, s51, 32
    s_lshr_b32 s43, s43, 6
    s_add_u32 s43, s43, 64
    s_min_u32 s43, s43, 1696
    v_lshrrev_b32 v36, 5, v1
    v_lshlrev_b32 v36, 4, v36
    v_add_u32 v36, s43, v36
    global_load_dwordx4 v[36:39], v36, s[54:55]
    s_cmp_lg_u32 s40, 4
    s_cbranch_scc1 L1_f1
    s_lshl_b32 s43, s41, 7
    s_lshl_b32 s44, s42, 2
    s_add_u32 s43, s43, s44
    s_add_u32 s43, s43, 46731264
    v_mov_b32 v252, s43
    v_mov_b32 v253, s26
    s_waitcnt vmcnt(10)
    s_mov_b64 exec, 1
    buffer_store_dword v253, v252, s[20:23], 0 offen sc1
    s_mov_b64 exec, -1
L1_f1:
    v_mul_f32 v80, v32, v80
    v_mul_f32 v81, v32, v81
    v_mul_f32 v82, v32, v82
    v_mul_f32 v83, v32, v83
    v_cvt_pk_bf16_f32 v20, v80, v81
    v_cvt_pk_bf16_f32 v21, v82, v83
    buffer_store_dwordx2 v[20:21], v28, s[20:23], 0 offen sc1
    v_mul_f32 v84, v32, v84
    v_mul_f32 v85, v32, v85
    v_mul_f32 v86, v32, v86
    v_mul_f32 v87, v32, v87
    v_cvt_pk_bf16_f32 v22, v84, v85
    v_cvt_pk_bf16_f32 v23, v86, v87
    buffer_store_dwordx2 v[22:23], v29, s[20:23], 0 offen sc1
    v_mul_f32 v88, v32, v88
    v_mul_f32 v89, v32, v89
    v_mul_f32 v90, v32, v90
    v_mul_f32 v91, v32, v91
    v_cvt_pk_bf16_f32 v24, v88, v89
    v_cvt_pk_bf16_f32 v25, v90, v91
    buffer_store_dwordx2 v[24:25], v30, s[20:23], 0 offen sc1
    v_mul_f32 v92, v32, v92
    v_mul_f32 v93, v32, v93
    v_mul_f32 v94, v32, v94
    v_mul_f32 v95, v32, v95
    v_cvt_pk_bf16_f32 v26, v92, v93
    v_cvt_pk_bf16_f32 v27, v94, v95
    buffer_store_dwordx2 v[26:27], v31, s[20:23], 0 offen sc1
    s_waitcnt lgkmcnt(0)
    s_barrier
    s_setprio 1
    v_add_u32 v13, 110592, v10
    ds_read_b64_tr_b16 v[40:41], v13 offset:0
    ds_read_b64_tr_b16 v[42:43], v13 offset:512
    ds_read_b64_tr_b16 v[44:45], v13 offset:2048
    ds_read_b64_tr_b16 v[46:47], v13 offset:2560
    ds_read_b64_tr_b16 v[48:49], v13 offset:4096
    ds_read_b64_tr_b16 v[50:51], v13 offset:4608
    s_waitcnt lgkmcnt(4)
    v_mfma_f32_32x32x16_bf16 v[80:95], v[40:43], v[96:99], 0
    ds_read_b64_tr_b16 v[52:53], v13 offset:6144
    ds_read_b64_tr_b16 v[54:55], v13 offset:6656
    s_waitcnt lgkmcnt(4)
    v_mfma_f32_32x32x16_bf16 v[80:95], v[44:47], v[100:103], v[80:95]
    ds_read_b64_tr_b16 v[40:41], v13 offset:8192
    ds_read_b64_tr_b16 v[42:43], v13 offset:8704
    s_waitcnt lgkmcnt(4)
    v_mfma_f32_32x32x16_bf16 v[80:95], v[48:51], v[104:107], v[80:95]
    ds_read_b64_tr_b16 v[44:45], v13 offset:10240
    ds_read_b64_tr_b16 v[46:47], v13 offset:10752
    s_waitcnt lgkmcnt(4)
    v_mfma_f32_32x32x16_bf16 v[80:95], v[52:55], v[108:111], v[80:95]
    ds_read_b64_tr_b16 v[48:49], v13 offset:12288
    ds_read_b64_tr_b16 v[50:51], v13 offset:12800
    s_waitcnt lgkmcnt(4)
    v_mfma_f32_32x32x16_bf16 v[80:95], v[40:43], v[112:115], v[80:95]
    ds_read_b64_tr_b16 v[52:53], v13 offset:14336
    ds_read_b64_tr_b16 v[54:55], v13 offset:14848
    s_waitcnt lgkmcnt(4)
    v_mfma_f32_32x32x16_bf16 v[80:95], v[44:47], v[116:119], v[80:95]
    ds_read_b64_tr_b16 v[40:41], v13 offset:16384
    ds_read_b64_tr_b16 v[42:43], v13 offset:16896
    s_waitcnt lgkmcnt(4)
    v_mfma_f32_32x32x16_bf16 v[80:95], v[48:51], v[120:123], v[80:95]
    ds_read_b64_tr_b16 v[44:45], v13 offset:18432
    ds_read_b64_tr_b16 v[46:47], v13 offset:18944
    s_waitcnt lgkmcnt(4)
    v_mfma_f32_32x32x16_bf16 v[80:95], v[52:55], v[124:127], v[80:95]
    ds_read_b64_tr_b16 v[48:49], v13 offset:20480
    ds_read_b64_tr_b16 v[50:51], v13 offset:20992
    s_waitcnt lgkmcnt(4)
    v_mfma_f32_32x32x16_bf16 v[80:95], v[40:43], v[128:131], v[80:95]
    ds_read_b64_tr_b16 v[52:53], v13 offset:22528
    ds_read_b64_tr_b16 v[54:55], v13 offset:23040
    s_waitcnt lgkmcnt(4)
    v_mfma_f32_32x32x16_bf16 v[80:95], v[44:47], v[132:135], v[80:95]
    ds_read_b64_tr_b16 v[40:41], v13 offset:24576
    ds_read_b64_tr_b16 v[42:43], v13 offset:25088
    s_waitcnt lgkmcnt(4)
    v_mfma_f32_32x32x16_bf16 v[80:95], v[48:51], v[136:139], v[80:95]
    ds_read_b64_tr_b16 v[44:45], v13 offset:26624
    ds_read_b64_tr_b16 v[46:47], v13 offset:27136
    s_waitcnt lgkmcnt(4)
    v_mfma_f32_32x32x16_bf16 v[80:95], v[52:55], v[140:143], v[80:95]
    ds_read_b64_tr_b16 v[48:49], v13 offset:28672
    ds_read_b64_tr_b16 v[50:51], v13 offset:29184
    s_waitcnt lgkmcnt(4)
    v_mfma_f32_32x32x16_bf16 v[80:95], v[40:43], v[144:147], v[80:95]
    ds_read_b64_tr_b16 v[52:53], v13 offset:30720
    ds_read_b64_tr_b16 v[54:55], v13 offset:31232
    s_waitcnt lgkmcnt(4)
    v_mfma_f32_32x32x16_bf16 v[80:95], v[44:47], v[148:151], v[80:95]
    ds_read_b64_tr_b16 v[40:41], v13 offset:32768
    ds_read_b64_tr_b16 v[42:43], v13 offset:33280
    s_waitcnt lgkmcnt(4)
    v_mfma_f32_32x32x16_bf16 v[80:95], v[48:51], v[152:155], v[80:95]
    ds_read_b64_tr_b16 v[44:45], v13 offset:34816
    ds_read_b64_tr_b16 v[46:47], v13 offset:35328
    s_waitcnt lgkmcnt(4)
    v_mfma_f32_32x32x16_bf16 v[80:95], v[52:55], v[156:159], v[80:95]
    s_waitcnt vmcnt(5)
    s_barrier
    v_add_u32 v13, 0, v10
    ds_read_b64_tr_b16 v[48:49], v13 offset:0
    ds_read_b64_tr_b16 v[50:51], v13 offset:512
    s_waitcnt lgkmcnt(4)
    v_mfma_f32_32x32x16_bf16 v[80:95], v[40:43], v[160:163], v[80:95]
    ds_read_b64_tr_b16 v[52:53], v13 offset:2048
    ds_read_b64_tr_b16 v[54:55], v13 offset:2560
    s_waitcnt lgkmcnt(4)
    v_mfma_f32_32x32x16_bf16 v[80:95], v[44:47], v[164:167], v[80:95]
    ds_read_b64_tr_b16 v[40:41], v13 offset:4096
    ds_read_b64_tr_b16 v[42:43], v13 offset:4608
    s_waitcnt lgkmcnt(4)
    v_mfma_f32_32x32x16_bf16 v[80:95], v[48:51], v[168:171], v[80:95]
    ds_read_b64_tr_b16 v[44:45], v13 offset:6144
    ds_read_b64_tr_b16 v[46:47], v13 offset:6656
    s_waitcnt lgkmcnt(4)
    v_mfma_f32_32x32x16_bf16 v[80:95], v[52:55], v[172:175], v[80:95]
    ds_read_b64_tr_b16 v[48:49], v13 offset:8192
    ds_read_b64_tr_b16 v[50:51], v13 offset:8704
    s_waitcnt lgkmcnt(4)
    v_mfma_f32_32x32x16_bf16 v[80:95], v[40:43], v[176:179], v[80:95]
    ds_read_b64_tr_b16 v[52:53], v13 offset:10240
    ds_read_b64_tr_b16 v[54:55], v13 offset:10752
    s_waitcnt lgkmcnt(4)
    v_mfma_f32_32x32x16_bf16 v[80:95], v[44:47], v[180:183], v[80:95]
    ds_read_b64_tr_b16 v[40:41], v13 offset:12288
    ds_read_b64_tr_b16 v[42:43], v13 offset:12800
    s_waitcnt lgkmcnt(4)
    v_mfma_f32_32x32x16_bf16 v[80:95], v[48:51], v[184:187], v[80:95]
    ds_read_b64_tr_b16 v[44:45], v13 offset:14336
    ds_read_b64_tr_b16 v[46:47], v13 offset:14848
    s_waitcnt lgkmcnt(4)
    v_mfma_f32_32x32x16_bf16 v[80:95], v[52:55], v[188:191], v[80:95]
    ds_read_b64_tr_b16 v[48:49], v13 offset:16384
    ds_read_b64_tr_b16 v[50:51], v13 offset:16896
    s_waitcnt lgkmcnt(4)
    v_mfma_f32_32x32x16_bf16 v[80:95], v[40:43], v[192:195], v[80:95]
    ds_read_b64_tr_b16 v[52:53], v13 offset:18432
    ds_read_b64_tr_b16 v[54:55], v13 offset:18944
    s_waitcnt lgkmcnt(4)
    v_mfma_f32_32x32x16_bf16 v[80:95], v[44:47], v[196:199], v[80:95]
    ds_read_b64_tr_b16 v[40:41], v13 offset:20480
    ds_read_b64_tr_b16 v[42:43], v13 offset:20992
    s_waitcnt lgkmcnt(4)
    v_mfma_f32_32x32x16_bf16 v[80:95], v[48:51], v[200:203], v[80:95]
    ds_read_b64_tr_b16 v[44:45], v13 offset:22528
    ds_read_b64_tr_b16 v[46:47], v13 offset:23040
    s_waitcnt lgkmcnt(4)
    v_mfma_f32_32x32x16_bf16 v[80:95], v[52:55], v[204:207], v[80:95]
    ds_read_b64_tr_b16 v[48:49], v13 offset:24576
    ds_read_b64_tr_b16 v[50:51], v13 offset:25088
    s_lshl_b32 s27, s41, 7
    s_add_u32 s27, s27, 46731264
    v_and_b32 v252, 15, v1
    v_lshlrev_b32 v252, 2, v252
    buffer_load_dword v253, v252, s[20:23], s27 offen sc1
    s_waitcnt lgkmcnt(4)
    v_mfma_f32_32x32x16_bf16 v[80:95], v[40:43], v[208:211], v[80:95]
    ds_read_b64_tr_b16 v[52:53], v13 offset:26624
    ds_read_b64_tr_b16 v[54:55], v13 offset:27136
    s_waitcnt lgkmcnt(4)
    v_mfma_f32_32x32x16_bf16 v[80:95], v[44:47], v[212:215], v[80:95]
    ds_read_b64_tr_b16 v[40:41], v13 offset:28672
    ds_read_b64_tr_b16 v[42:43], v13 offset:29184
    s_waitcnt lgkmcnt(4)
    v_mfma_f32_32x32x16_bf16 v[80:95], v[48:51], v[216:219], v[80:95]
    ds_read_b64_tr_b16 v[44:45], v13 offset:30720
    ds_read_b64_tr_b16 v[46:47], v13 offset:31232
    s_waitcnt lgkmcnt(4)
    v_mfma_f32_32x32x16_bf16 v[80:95], v[52:55], v[220:223], v[80:95]
    ds_read_b64_tr_b16 v[48:49], v13 offset:32768
    ds_read_b64_tr_b16 v[50:51], v13 offset:33280
    s_waitcnt lgkmcnt(4)
    v_mfma_f32_32x32x16_bf16 v[80:95], v[40:43], v[224:227], v[80:95]
    ds_read_b64_tr_b16 v[52:53], v13 offset:34816
    ds_read_b64_tr_b16 v[54:55], v13 offset:35328
    s_waitcnt lgkmcnt(0)
    s_barrier
    v_mfma_f32_32x32x16_bf16 v[80:95], v[44:47], v[228:231], v[80:95]
    v_mfma_f32_32x32x16_bf16 v[80:95], v[48:51], v[232:235], v[80:95]
    v_mfma_f32_32x32x16_bf16 v[80:95], v[52:55], v[236:239], v[80:95]
    s_setprio 0
    s_waitcnt vmcnt(0)
    v_cmp_ne_u32 vcc, s26, v253
    s_nop 4
    s_cbranch_vccz L1_q1d
    s_mov_b32 s45, 0
L1_q1l:
    buffer_load_dword v253, v252, s[20:23], s27 offen sc1
    s_waitcnt vmcnt(0)
    v_cmp_ne_u32 vcc, s26, v253
    s_nop 4
    s_cbranch_vccz L1_q1d
    s_sleep 10
    s_add_u32 s45, s45, 1
    s_cmp_lt_u32 s45, 0x4000
    s_cbranch_scc1 L1_q1l
L1_q1d:
    v_and_b32 v20, 31, v1
    v_lshlrev_b32 v20, 3, v20
    v_lshrrev_b32 v21, 5, v1
    v_lshlrev_b32 v21, 10, v21
    s_lshl_b32 s43, s41, 14
    s_lshl_b32 s44, s46, 8
    s_add_u32 s43, s43, s44
    s_add_u32 s43, s43, 46137344
    v_add3_u32 v18, v20, v21, s43
    buffer_load_dwordx2 v[240:241], v18, s[20:23], 0 offen offset:0 sc1
    buffer_load_dwordx2 v[242:243], v18, s[20:23], 0 offen offset:2048 sc1
    v_add_u32 v18, 4096, v18
    buffer_load_dwordx2 v[244:245], v18, s[20:23], 0 offen offset:0 sc1
    buffer_load_dwordx2 v[246:247], v18, s[20:23], 0 offen offset:2048 sc1
    v_add_u32 v18, 4096, v18
    buffer_load_dwordx2 v[248:249], v18, s[20:23], 0 offen offset:0 sc1
    buffer_load_dwordx2 v[250:251], v18, s[20:23], 0 offen offset:2048 sc1
    v_add_u32 v18, 4096, v18
    buffer_load_dwordx2 v[252:253], v18, s[20:23], 0 offen offset:0 sc1
    buffer_load_dwordx2 v[254:255], v18, s[20:23], 0 offen offset:2048 sc1
    s_add_u32 s43, s51, 128
    s_cmp_lt_u32 s43, 1152
    s_cselect_b32 s43, 0xbe173fd8, s52
    s_waitcnt vmcnt(13)
    v_mul_f32 v32, s43, v17
    v_add_u32 v28, v16, v36
    v_add_u32 v29, v16, v37
    v_add_u32 v30, v16, v38
    v_add_u32 v31, v16, v39
    v_mul_f32 v80, v32, v80
    v_mul_f32 v81, v32, v81
    v_mul_f32 v82, v32, v82
    v_mul_f32 v83, v32, v83
    v_cvt_pk_bf16_f32 v20, v80, v81
    v_cvt_pk_bf16_f32 v21, v82, v83
    buffer_store_dwordx2 v[20:21], v28, s[20:23], s71 offen sc1
    v_mul_f32 v84, v32, v84
    v_mul_f32 v85, v32, v85
    v_mul_f32 v86, v32, v86
    v_mul_f32 v87, v32, v87
    v_cvt_pk_bf16_f32 v22, v84, v85
    v_cvt_pk_bf16_f32 v23, v86, v87
    buffer_store_dwordx2 v[22:23], v29, s[20:23], s71 offen sc1
    v_mul_f32 v88, v32, v88
    v_mul_f32 v89, v32, v89
    v_mul_f32 v90, v32, v90
    v_mul_f32 v91, v32, v91
    v_cvt_pk_bf16_f32 v24, v88, v89
    v_cvt_pk_bf16_f32 v25, v90, v91
    buffer_store_dwordx2 v[24:25], v30, s[20:23], s71 offen sc1
    v_mul_f32 v92, v32, v92
    v_mul_f32 v93, v32, v93
    v_mul_f32 v94, v32, v94
    v_mul_f32 v95, v32, v95
    v_cvt_pk_bf16_f32 v26, v92, v93
    v_cvt_pk_bf16_f32 v27, v94, v95
    buffer_store_dwordx2 v[26:27], v31, s[20:23], s71 offen sc1
    v_and_b32 v33, 31, v1
    v_lshlrev_b32 v33, 3, v33
    s_lshl_b32 s43, s46, 8
    s_add_u32 s43, s43, 147456
    v_add_u32 v33, s43, v33
    s_waitcnt vmcnt(4)
    v_add_f32 v240, v240, v242
    v_add_f32 v241, v241, v243
    v_add_f32 v240, v240, v244
    v_add_f32 v241, v241, v245
    v_add_f32 v240, v240, v246
    v_add_f32 v241, v241, v247
    v_add_f32 v240, v240, v248
    v_add_f32 v241, v241, v249
    v_add_f32 v240, v240, v250
    v_add_f32 v241, v241, v251
    v_add_f32 v240, v240, v252
    v_add_f32 v241, v241, v253
    v_add_f32 v240, v240, v254
    v_add_f32 v241, v241, v255
    v_mov_b32 v22, v240
    v_mov_b32 v23, v241
    s_nop 1
    v_permlane32_swap_b32 v240, v22
    v_permlane32_swap_b32 v241, v23
    v_add_f32 v20, v240, v22
    v_add_f32 v21, v241, v23
    s_mov_b32 s43, 0x39e38e39
    v_mul_f32 v20, s43, v20
    v_mul_f32 v22, v20, v20
    v_fma_f32 v21, v21, s43, -v22
    v_max_f32 v21, 0, v21
    v_add_f32 v21, 0x3727c5ac, v21
    v_rsq_f32 v18, v21
    s_nop 0
    v_mul_f32 v19, v20, v18
    ds_write_b64 v33, v[18:19]
    v_lshlrev_b32 v20, 16, v56
    v_and_b32 v21, 0xffff0000, v56
    v_fma_f32 v20, v20, v18, -v19
    v_fma_f32 v21, v21, v18, -v19
    v_cvt_pk_bf16_f32 v56, v20, v21
    v_lshlrev_b32 v22, 16, v57
    v_and_b32 v23, 0xffff0000, v57
    v_fma_f32 v22, v22, v18, -v19
    v_fma_f32 v23, v23, v18, -v19
    v_cvt_pk_bf16_f32 v57, v22, v23
    v_lshlrev_b32 v24, 16, v58
    v_and_b32 v25, 0xffff0000, v58
    v_fma_f32 v24, v24, v18, -v19
    v_fma_f32 v25, v25, v18, -v19
    v_cvt_pk_bf16_f32 v58, v24, v25
    v_lshlrev_b32 v26, 16, v59
    v_and_b32 v27, 0xffff0000, v59
    v_fma_f32 v26, v26, v18, -v19
    v_fma_f32 v27, v27, v18, -v19
    v_cvt_pk_bf16_f32 v59, v26, v27
    buffer_store_dwordx4 v[56:59], v14, s[20:23], s58 offen sc1
    v_lshlrev_b32 v20, 16, v60
    v_and_b32 v21, 0xffff0000, v60
    v_fma_f32 v20, v20, v18, -v19
    v_fma_f32 v21, v21, v18, -v19
    v_cvt_pk_bf16_f32 v60, v20, v21
    v_lshlrev_b32 v22, 16, v61
    v_and_b32 v23, 0xffff0000, v61
    v_fma_f32 v22, v22, v18, -v19
    v_fma_f32 v23, v23, v18, -v19
    v_cvt_pk_bf16_f32 v61, v22, v23
    v_lshlrev_b32 v24, 16, v62
    v_and_b32 v25, 0xffff0000, v62
    v_fma_f32 v24, v24, v18, -v19
    v_fma_f32 v25, v25, v18, -v19
    v_cvt_pk_bf16_f32 v62, v24, v25
    v_lshlrev_b32 v26, 16, v63
    v_and_b32 v27, 0xffff0000, v63
    v_fma_f32 v26, v26, v18, -v19
    v_fma_f32 v27, v27, v18, -v19
    v_cvt_pk_bf16_f32 v63, v26, v27
    buffer_store_dwordx4 v[60:63], v14, s[20:23], s59 offen sc1
    v_lshlrev_b32 v20, 16, v64
    v_and_b32 v21, 0xffff0000, v64
    v_fma_f32 v20, v20, v18, -v19
    v_fma_f32 v21, v21, v18, -v19
    v_cvt_pk_bf16_f32 v64, v20, v21
    v_lshlrev_b32 v22, 16, v65
    v_and_b32 v23, 0xffff0000, v65
    v_fma_f32 v22, v22, v18, -v19
    v_fma_f32 v23, v23, v18, -v19
    v_cvt_pk_bf16_f32 v65, v22, v23
    v_lshlrev_b32 v24, 16, v66
    v_and_b32 v25, 0xffff0000, v66
    v_fma_f32 v24, v24, v18, -v19
    v_fma_f32 v25, v25, v18, -v19
    v_cvt_pk_bf16_f32 v66, v24, v25
    v_lshlrev_b32 v26, 16, v67
    v_and_b32 v27, 0xffff0000, v67
    v_fma_f32 v26, v26, v18, -v19
    v_fma_f32 v27, v27, v18, -v19
    v_cvt_pk_bf16_f32 v67, v26, v27
    buffer_store_dwordx4 v[64:67], v14, s[20:23], s60 offen sc1
    v_lshlrev_b32 v20, 16, v68
    v_and_b32 v21, 0xffff0000, v68
    v_fma_f32 v20, v20, v18, -v19
    v_fma_f32 v21, v21, v18, -v19
    v_cvt_pk_bf16_f32 v68, v20, v21
    v_lshlrev_b32 v22, 16, v69
    v_and_b32 v23, 0xffff0000, v69
    v_fma_f32 v22, v22, v18, -v19
    v_fma_f32 v23, v23, v18, -v19
    v_cvt_pk_bf16_f32 v69, v22, v23
    v_lshlrev_b32 v24, 16, v70
    v_and_b32 v25, 0xffff0000, v70
    v_fma_f32 v24, v24, v18, -v19
    v_fma_f32 v25, v25, v18, -v19
    v_cvt_pk_bf16_f32 v70, v24, v25
    v_lshlrev_b32 v26, 16, v71
    v_and_b32 v27, 0xffff0000, v71
    v_fma_f32 v26, v26, v18, -v19
    v_fma_f32 v27, v27, v18, -v19
    v_cvt_pk_bf16_f32 v71, v26, v27
    buffer_store_dwordx4 v[68:71], v14, s[20:23], s61 offen sc1
    s_waitcnt lgkmcnt(0)
    s_barrier
    s_setprio 1
    v_add_u32 v13, 36864, v10
    ds_read_b64_tr_b16 v[40:41], v13 offset:0
    ds_read_b64_tr_b16 v[42:43], v13 offset:512
    ds_read_b64_tr_b16 v[44:45], v13 offset:2048
    ds_read_b64_tr_b16 v[46:47], v13 offset:2560
    ds_read_b64_tr_b16 v[48:49], v13 offset:4096
    ds_read_b64_tr_b16 v[50:51], v13 offset:4608
    s_waitcnt lgkmcnt(4)
    v_mfma_f32_32x32x16_bf16 v[80:95], v[40:43], v[96:99], 0
    ds_read_b64_tr_b16 v[52:53], v13 offset:6144
    ds_read_b64_tr_b16 v[54:55], v13 offset:6656
    s_waitcnt lgkmcnt(4)
    v_mfma_f32_32x32x16_bf16 v[80:95], v[44:47], v[100:103], v[80:95]
    ds_read_b64_tr_b16 v[40:41], v13 offset:8192
    ds_read_b64_tr_b16 v[42:43], v13 offset:8704
    s_waitcnt lgkmcnt(4)
    v_mfma_f32_32x32x16_bf16 v[80:95], v[48:51], v[104:107], v[80:95]
    ds_read_b64_tr_b16 v[44:45], v13 offset:10240
    ds_read_b64_tr_b16 v[46:47], v13 offset:10752
    s_waitcnt lgkmcnt(4)
    v_mfma_f32_32x32x16_bf16 v[80:95], v[52:55], v[108:111], v[80:95]
    ds_read_b64_tr_b16 v[48:49], v13 offset:12288
    ds_read_b64_tr_b16 v[50:51], v13 offset:12800
    s_mul_i32 s56, s46, 663552
    s_add_u32 s56, s56, s50
    s_add_u32 m0, s53, 110592
    s_add_u32 s56, s56, 128
    buffer_load_dwordx4 v4, s[12:15], s56 offen offset:0 lds
    s_waitcnt lgkmcnt(4)
    v_mfma_f32_32x32x16_bf16 v[80:95], v[40:43], v[112:115], v[80:95]
    ds_read_b64_tr_b16 v[52:53], v13 offset:14336
    ds_read_b64_tr_b16 v[54:55], v13 offset:14848
    s_waitcnt lgkmcnt(4)
    v_mfma_f32_32x32x16_bf16 v[80:95], v[44:47], v[116:119], v[80:95]
    ds_read_b64_tr_b16 v[40:41], v13 offset:16384
    ds_read_b64_tr_b16 v[42:43], v13 offset:16896
    s_waitcnt lgkmcnt(4)
    v_mfma_f32_32x32x16_bf16 v[80:95], v[48:51], v[120:123], v[80:95]
    ds_read_b64_tr_b16 v[44:45], v13 offset:18432
    ds_read_b64_tr_b16 v[46:47], v13 offset:18944
    buffer_load_dwordx4 v5, s[12:15], s56 offen offset:1024 lds
    s_waitcnt lgkmcnt(4)
    v_mfma_f32_32x32x16_bf16 v[80:95], v[52:55], v[124:127], v[80:95]
    ds_read_b64_tr_b16 v[48:49], v13 offset:20480
    ds_read_b64_tr_b16 v[50:51], v13 offset:20992
    s_waitcnt lgkmcnt(4)
    v_mfma_f32_32x32x16_bf16 v[80:95], v[40:43], v[128:131], v[80:95]
    ds_read_b64_tr_b16 v[52:53], v13 offset:22528
    ds_read_b64_tr_b16 v[54:55], v13 offset:23040
    s_waitcnt lgkmcnt(4)
    v_mfma_f32_32x32x16_bf16 v[80:95], v[44:47], v[132:135], v[80:95]
    ds_read_b64_tr_b16 v[40:41], v13 offset:24576
    ds_read_b64_tr_b16 v[42:43], v13 offset:25088
    buffer_load_dwordx4 v6, s[12:15], s56 offen offset:2048 lds
    s_waitcnt lgkmcnt(4)
    v_mfma_f32_32x32x16_bf16 v[80:95], v[48:51], v[136:139], v[80:95]
    ds_read_b64_tr_b16 v[44:45], v13 offset:26624
    ds_read_b64_tr_b16 v[46:47], v13 offset:27136
    s_waitcnt lgkmcnt(4)
    v_mfma_f32_32x32x16_bf16 v[80:95], v[52:55], v[140:143], v[80:95]
    ds_read_b64_tr_b16 v[48:49], v13 offset:28672
    ds_read_b64_tr_b16 v[50:51], v13 offset:29184
    s_waitcnt lgkmcnt(4)
    v_mfma_f32_32x32x16_bf16 v[80:95], v[40:43], v[144:147], v[80:95]
    ds_read_b64_tr_b16 v[52:53], v13 offset:30720
    ds_read_b64_tr_b16 v[54:55], v13 offset:31232
    s_add_u32 m0, s53, 113664
    s_add_u32 s56, s56, 221184
    buffer_load_dwordx4 v4, s[12:15], s56 offen offset:0 lds
    s_waitcnt lgkmcnt(4)
    v_mfma_f32_32x32x16_bf16 v[80:95], v[44:47], v[148:151], v[80:95]
    ds_read_b64_tr_b16 v[40:41], v13 offset:32768
    ds_read_b64_tr_b16 v[42:43], v13 offset:33280
    s_waitcnt lgkmcnt(4)
    v_mfma_f32_32x32x16_bf16 v[80:95], v[48:51], v[152:155], v[80:95]
    ds_read_b64_tr_b16 v[44:45], v13 offset:34816
    ds_read_b64_tr_b16 v[46:47], v13 offset:35328
    s_waitcnt lgkmcnt(4)
    v_mfma_f32_32x32x16_bf16 v[80:95], v[52:55], v[156:159], v[80:95]
    s_barrier
    v_add_u32 v13, 73728, v10
    ds_read_b64_tr_b16 v[48:49], v13 offset:0
    ds_read_b64_tr_b16 v[50:51], v13 offset:512
    buffer_load_dwordx4 v5, s[12:15], s56 offen offset:1024 lds
    s_waitcnt lgkmcnt(4)
    v_mfma_f32_32x32x16_bf16 v[80:95], v[40:43], v[160:163], v[80:95]
    ds_read_b64_tr_b16 v[52:53], v13 offset:2048
    ds_read_b64_tr_b16 v[54:55], v13 offset:2560
    s_waitcnt lgkmcnt(4)
    v_mfma_f32_32x32x16_bf16 v[80:95], v[44:47], v[164:167], v[80:95]
    ds_read_b64_tr_b16 v[40:41], v13 offset:4096
    ds_read_b64_tr_b16 v[42:43], v13 offset:4608
    s_waitcnt lgkmcnt(4)
    v_mfma_f32_32x32x16_bf16 v[80:95], v[48:51], v[168:171], v[80:95]
    ds_read_b64_tr_b16 v[44:45], v13 offset:6144
    ds_read_b64_tr_b16 v[46:47], v13 offset:6656
    buffer_load_dwordx4 v6, s[12:15], s56 offen offset:2048 lds
    s_waitcnt lgkmcnt(4)
    v_mfma_f32_32x32x16_bf16 v[80:95], v[52:55], v[172:175], v[80:95]
    ds_read_b64_tr_b16 v[48:49], v13 offset:8192
    ds_read_b64_tr_b16 v[50:51], v13 offset:8704
    s_waitcnt lgkmcnt(4)
    v_mfma_f32_32x32x16_bf16 v[80:95], v[40:43], v[176:179], v[80:95]
    ds_read_b64_tr_b16 v[52:53], v13 offset:10240
    ds_read_b64_tr_b16 v[54:55], v13 offset:10752
    s_waitcnt lgkmcnt(4)
    v_mfma_f32_32x32x16_bf16 v[80:95], v[44:47], v[180:183], v[80:95]
    ds_read_b64_tr_b16 v[40:41], v13 offset:12288
    ds_read_b64_tr_b16 v[42:43], v13 offset:12800
    s_add_u32 m0, s53, 116736
    s_add_u32 s56, s56, 221184
    buffer_load_dwordx4 v4, s[12:15], s56 offen offset:0 lds
    s_waitcnt lgkmcnt(4)
    v_mfma_f32_32x32x16_bf16 v[80:95], v[48:51], v[184:187], v[80:95]
    ds_read_b64_tr_b16 v[44:45], v13 offset:14336
    ds_read_b64_tr_b16 v[46:47], v13 offset:14848
    s_waitcnt lgkmcnt(4)
    v_mfma_f32_32x32x16_bf16 v[80:95], v[52:55], v[188:191], v[80:95]
    ds_read_b64_tr_b16 v[48:49], v13 offset:16384
    ds_read_b64_tr_b16 v[50:51], v13 offset:16896
    s_waitcnt lgkmcnt(4)
    v_mfma_f32_32x32x16_bf16 v[80:95], v[40:43], v[192:195], v[80:95]
    ds_read_b64_tr_b16 v[52:53], v13 offset:18432
    ds_read_b64_tr_b16 v[54:55], v13 offset:18944
    buffer_load_dwordx4 v5, s[12:15], s56 offen offset:1024 lds
    s_waitcnt lgkmcnt(4)
    v_mfma_f32_32x32x16_bf16 v[80:95], v[44:47], v[196:199], v[80:95]
    ds_read_b64_tr_b16 v[40:41], v13 offset:20480
    ds_read_b64_tr_b16 v[42:43], v13 offset:20992
    s_waitcnt lgkmcnt(4)
    v_mfma_f32_32x32x16_bf16 v[80:95], v[48:51], v[200:203], v[80:95]
    ds_read_b64_tr_b16 v[44:45], v13 offset:22528
    ds_read_b64_tr_b16 v[46:47], v13 offset:23040
    s_waitcnt lgkmcnt(4)
    v_mfma_f32_32x32x16_bf16 v[80:95], v[52:55], v[204:207], v[80:95]
    ds_read_b64_tr_b16 v[48:49], v13 offset:24576
    ds_read_b64_tr_b16 v[50:51], v13 offset:25088
    buffer_load_dwordx4 v6, s[12:15], s56 offen offset:2048 lds
    s_waitcnt lgkmcnt(4)
    v_mfma_f32_32x32x16_bf16 v[80:95], v[40:43], v[208:211], v[80:95]
    ds_read_b64_tr_b16 v[52:53], v13 offset:26624
    ds_read_b64_tr_b16 v[54:55], v13 offset:27136
    s_waitcnt lgkmcnt(4)
    v_mfma_f32_32x32x16_bf16 v[80:95], v[44:47], v[212:215], v[80:95]
    ds_read_b64_tr_b16 v[40:41], v13 offset:28672
    ds_read_b64_tr_b16 v[42:43], v13 offset:29184
    s_waitcnt lgkmcnt(4)
    v_mfma_f32_32x32x16_bf16 v[80:95], v[48:51], v[216:219], v[80:95]
    ds_read_b64_tr_b16 v[44:45], v13 offset:30720
    ds_read_b64_tr_b16 v[46:47], v13 offset:31232
    s_waitcnt lgkmcnt(4)
    v_mfma_f32_32x32x16_bf16 v[80:95], v[52:55], v[220:223], v[80:95]
    ds_read_b64_tr_b16 v[48:49], v13 offset:32768
    ds_read_b64_tr_b16 v[50:51], v13 offset:33280
    s_waitcnt lgkmcnt(4)
    v_mfma_f32_32x32x16_bf16 v[80:95], v[40:43], v[224:227], v[80:95]
    ds_read_b64_tr_b16 v[52:53], v13 offset:34816
    ds_read_b64_tr_b16 v[54:55], v13 offset:35328
    s_waitcnt lgkmcnt(0)
    s_barrier
    v_mfma_f32_32x32x16_bf16 v[80:95], v[44:47], v[228:231], v[80:95]
    v_mfma_f32_32x32x16_bf16 v[80:95], v[48:51], v[232:235], v[80:95]
    v_mfma_f32_32x32x16_bf16 v[80:95], v[52:55], v[236:239], v[80:95]
    s_setprio 0
    s_waitcnt vmcnt(0)
    s_nop 9
    v_mul_f32 v20, v80, v80
    v_mul_f32 v21, v81, v81
    v_mul_f32 v22, v82, v82
    v_mul_f32 v23, v83, v83
    v_fma_f32 v20, v20, v0, v17
    v_fma_f32 v21, v21, v0, v17
    v_fma_f32 v22, v22, v0, v17
    v_fma_f32 v23, v23, v0, v17
    v_mul_f32 v20, v20, v80
    s_mul_i32 s56, s46, 663552
    s_add_u32 s56, s56, s50
    s_add_u32 m0, s53, 0
    s_add_u32 s56, s56, 2654336
    buffer_load_dwordx4 v4, s[12:15], s56 offen offset:0 lds
    v_mul_f32 v21, v21, v81
    v_mul_f32 v22, v22, v82
    v_mul_f32 v23, v23, v83
    v_exp_f32 v20, v20
    v_exp_f32 v21, v21
    v_exp_f32 v22, v22
    v_exp_f32 v23, v23
    v_fma_f32 v20, v20, v2, v2
    buffer_load_dwordx4 v5, s[12:15], s56 offen offset:1024 lds
    v_fma_f32 v21, v21, v2, v2
    v_fma_f32 v22, v22, v2, v2
    v_fma_f32 v23, v23, v2, v2
    v_rcp_f32 v20, v20
    v_rcp_f32 v21, v21
    v_rcp_f32 v22, v22
    v_rcp_f32 v23, v23
    v_mul_f32 v80, v80, v20
    buffer_load_dwordx4 v6, s[12:15], s56 offen offset:2048 lds
    v_mul_f32 v81, v81, v21
    v_mul_f32 v82, v82, v22
    v_mul_f32 v83, v83, v23
    v_cvt_pk_bf16_f32 v28, v80, v81
    v_cvt_pk_bf16_f32 v29, v82, v83
    v_mul_f32 v24, v88, v88
    v_mul_f32 v25, v89, v89
    v_mul_f32 v26, v90, v90
    s_add_u32 m0, s53, 3072
    s_add_u32 s56, s56, 221184
    buffer_load_dwordx4 v4, s[12:15], s56 offen offset:0 lds
    v_mul_f32 v27, v91, v91
    v_fma_f32 v24, v24, v0, v17
    v_fma_f32 v25, v25, v0, v17
    v_fma_f32 v26, v26, v0, v17
    v_fma_f32 v27, v27, v0, v17
    v_mul_f32 v24, v24, v88
    v_mul_f32 v25, v25, v89
    v_mul_f32 v26, v26, v90
    buffer_load_dwordx4 v5, s[12:15], s56 offen offset:1024 lds
    v_mul_f32 v27, v27, v91
    v_exp_f32 v24, v24
    v_exp_f32 v25, v25
    v_exp_f32 v26, v26
    v_exp_f32 v27, v27
    v_fma_f32 v24, v24, v2, v2
    v_fma_f32 v25, v25, v2, v2
    v_fma_f32 v26, v26, v2, v2
    buffer_load_dwordx4 v6, s[12:15], s56 offen offset:2048 lds
    v_fma_f32 v27, v27, v2, v2
    v_rcp_f32 v24, v24
    v_rcp_f32 v25, v25
    v_rcp_f32 v26, v26
    v_rcp_f32 v27, v27
    v_mul_f32 v88, v88, v24
    v_mul_f32 v89, v89, v25
    v_mul_f32 v90, v90, v26
    s_add_u32 m0, s53, 6144
    s_add_u32 s56, s56, 221184
    buffer_load_dwordx4 v4, s[12:15], s56 offen offset:0 lds
    v_mul_f32 v91, v91, v27
    v_cvt_pk_bf16_f32 v30, v88, v89
    v_cvt_pk_bf16_f32 v31, v90, v91
    buffer_store_dwordx4 v[28:31], v15, s[20:23], s64 offen offset:0
    v_mul_f32 v20, v84, v84
    v_mul_f32 v21, v85, v85
    v_mul_f32 v22, v86, v86
    v_mul_f32 v23, v87, v87
    buffer_load_dwordx4 v5, s[12:15], s56 offen offset:1024 lds
    v_fma_f32 v20, v20, v0, v17
    v_fma_f32 v21, v21, v0, v17
    v_fma_f32 v22, v22, v0, v17
    v_fma_f32 v23, v23, v0, v17
    v_mul_f32 v20, v20, v84
    v_mul_f32 v21, v21, v85
    v_mul_f32 v22, v22, v86
    v_mul_f32 v23, v23, v87
    buffer_load_dwordx4 v6, s[12:15], s56 offen offset:2048 lds
    v_exp_f32 v20, v20
    v_exp_f32 v21, v21
    v_exp_f32 v22, v22
    v_exp_f32 v23, v23
    v_fma_f32 v20, v20, v2, v2
    v_fma_f32 v21, v21, v2, v2
    v_fma_f32 v22, v22, v2, v2
    v_fma_f32 v23, v23, v2, v2
    v_rcp_f32 v20, v20
    v_rcp_f32 v21, v21
    v_rcp_f32 v22, v22
    v_rcp_f32 v23, v23
    v_mul_f32 v84, v84, v20
    v_mul_f32 v85, v85, v21
    v_mul_f32 v86, v86, v22
    v_mul_f32 v87, v87, v23
    v_cvt_pk_bf16_f32 v32, v84, v85
    v_cvt_pk_bf16_f32 v33, v86, v87
    v_mul_f32 v24, v92, v92
    v_mul_f32 v25, v93, v93
    v_mul_f32 v26, v94, v94
    v_mul_f32 v27, v95, v95
    v_fma_f32 v24, v24, v0, v17
    v_fma_f32 v25, v25, v0, v17
    v_fma_f32 v26, v26, v0, v17
    v_fma_f32 v27, v27, v0, v17
    v_mul_f32 v24, v24, v92
    v_mul_f32 v25, v25, v93
    v_mul_f32 v26, v26, v94
    v_mul_f32 v27, v27, v95
    v_exp_f32 v24, v24
    v_exp_f32 v25, v25
    v_exp_f32 v26, v26
    v_exp_f32 v27, v27
    v_fma_f32 v24, v24, v2, v2
    v_fma_f32 v25, v25, v2, v2
    v_fma_f32 v26, v26, v2, v2
    v_fma_f32 v27, v27, v2, v2
    v_rcp_f32 v24, v24
    v_rcp_f32 v25, v25
    v_rcp_f32 v26, v26
    v_rcp_f32 v27, v27
    v_mul_f32 v92, v92, v24
    v_mul_f32 v93, v93, v25
    v_mul_f32 v94, v94, v26
    v_mul_f32 v95, v95, v27
    v_cvt_pk_bf16_f32 v34, v92, v93
    v_cvt_pk_bf16_f32 v35, v94, v95
    buffer_store_dwordx4 v[32:35], v15, s[20:23], s64 offen offset:512
    s_waitcnt lgkmcnt(0)
    s_barrier
    s_setprio 1
    v_add_u32 v13, 110592, v10
    ds_read_b64_tr_b16 v[40:41], v13 offset:0
    ds_read_b64_tr_b16 v[42:43], v13 offset:512
    ds_read_b64_tr_b16 v[44:45], v13 offset:2048
    ds_read_b64_tr_b16 v[46:47], v13 offset:2560
    ds_read_b64_tr_b16 v[48:49], v13 offset:4096
    ds_read_b64_tr_b16 v[50:51], v13 offset:4608
    s_waitcnt lgkmcnt(4)
    v_mfma_f32_32x32x16_bf16 v[80:95], v[40:43], v[96:99], 0
    ds_read_b64_tr_b16 v[52:53], v13 offset:6144
    ds_read_b64_tr_b16 v[54:55], v13 offset:6656
    s_waitcnt lgkmcnt(4)
    v_mfma_f32_32x32x16_bf16 v[80:95], v[44:47], v[100:103], v[80:95]
    ds_read_b64_tr_b16 v[40:41], v13 offset:8192
    ds_read_b64_tr_b16 v[42:43], v13 offset:8704
    s_waitcnt lgkmcnt(4)
    v_mfma_f32_32x32x16_bf16 v[80:95], v[48:51], v[104:107], v[80:95]
    ds_read_b64_tr_b16 v[44:45], v13 offset:10240
    ds_read_b64_tr_b16 v[46:47], v13 offset:10752
    s_waitcnt lgkmcnt(4)
    v_mfma_f32_32x32x16_bf16 v[80:95], v[52:55], v[108:111], v[80:95]
    ds_read_b64_tr_b16 v[48:49], v13 offset:12288
    ds_read_b64_tr_b16 v[50:51], v13 offset:12800
    s_cmp_lg_u32 s40, 4
    s_cbranch_scc1 L1_f2
    s_lshl_b32 s43, s2, 2
    s_add_u32 s43, s43, 46743552
    v_lshlrev_b32 v252, 10, v1
    v_mov_b32 v253, s26
    s_mov_b64 exec, 0xff
    buffer_store_dword v253, v252, s[20:23], s43 offen sc1
    s_mov_b64 exec, -1
L1_f2:
    s_waitcnt lgkmcnt(4)
    v_mfma_f32_32x32x16_bf16 v[80:95], v[40:43], v[112:115], v[80:95]
    ds_read_b64_tr_b16 v[52:53], v13 offset:14336
    ds_read_b64_tr_b16 v[54:55], v13 offset:14848
    s_waitcnt lgkmcnt(4)
    v_mfma_f32_32x32x16_bf16 v[80:95], v[44:47], v[116:119], v[80:95]
    ds_read_b64_tr_b16 v[40:41], v13 offset:16384
    ds_read_b64_tr_b16 v[42:43], v13 offset:16896
    s_waitcnt lgkmcnt(4)
    v_mfma_f32_32x32x16_bf16 v[80:95], v[48:51], v[120:123], v[80:95]
    ds_read_b64_tr_b16 v[44:45], v13 offset:18432
    ds_read_b64_tr_b16 v[46:47], v13 offset:18944
    s_waitcnt lgkmcnt(4)
    v_mfma_f32_32x32x16_bf16 v[80:95], v[52:55], v[124:127], v[80:95]
    ds_read_b64_tr_b16 v[48:49], v13 offset:20480
    ds_read_b64_tr_b16 v[50:51], v13 offset:20992
    s_waitcnt lgkmcnt(4)
    v_mfma_f32_32x32x16_bf16 v[80:95], v[40:43], v[128:131], v[80:95]
    ds_read_b64_tr_b16 v[52:53], v13 offset:22528
    ds_read_b64_tr_b16 v[54:55], v13 offset:23040
    s_waitcnt lgkmcnt(4)
    v_mfma_f32_32x32x16_bf16 v[80:95], v[44:47], v[132:135], v[80:95]
    ds_read_b64_tr_b16 v[40:41], v13 offset:24576
    ds_read_b64_tr_b16 v[42:43], v13 offset:25088
    s_waitcnt lgkmcnt(4)
    v_mfma_f32_32x32x16_bf16 v[80:95], v[48:51], v[136:139], v[80:95]
    ds_read_b64_tr_b16 v[44:45], v13 offset:26624
    ds_read_b64_tr_b16 v[46:47], v13 offset:27136
    s_waitcnt lgkmcnt(4)
    v_mfma_f32_32x32x16_bf16 v[80:95], v[52:55], v[140:143], v[80:95]
    ds_read_b64_tr_b16 v[48:49], v13 offset:28672
    ds_read_b64_tr_b16 v[50:51], v13 offset:29184
    s_waitcnt lgkmcnt(4)
    v_mfma_f32_32x32x16_bf16 v[80:95], v[40:43], v[144:147], v[80:95]
    ds_read_b64_tr_b16 v[52:53], v13 offset:30720
    ds_read_b64_tr_b16 v[54:55], v13 offset:31232
    s_waitcnt lgkmcnt(4)
    v_mfma_f32_32x32x16_bf16 v[80:95], v[44:47], v[148:151], v[80:95]
    ds_read_b64_tr_b16 v[40:41], v13 offset:32768
    ds_read_b64_tr_b16 v[42:43], v13 offset:33280
    s_waitcnt lgkmcnt(4)
    v_mfma_f32_32x32x16_bf16 v[80:95], v[48:51], v[152:155], v[80:95]
    ds_read_b64_tr_b16 v[44:45], v13 offset:34816
    ds_read_b64_tr_b16 v[46:47], v13 offset:35328
    s_waitcnt lgkmcnt(4)
    v_mfma_f32_32x32x16_bf16 v[80:95], v[52:55], v[156:159], v[80:95]
    s_waitcnt vmcnt(1)
    s_barrier
    v_add_u32 v13, 0, v10
    ds_read_b64_tr_b16 v[48:49], v13 offset:0
    ds_read_b64_tr_b16 v[50:51], v13 offset:512
    s_waitcnt lgkmcnt(4)
    v_mfma_f32_32x32x16_bf16 v[80:95], v[40:43], v[160:163], v[80:95]
    ds_read_b64_tr_b16 v[52:53], v13 offset:2048
    ds_read_b64_tr_b16 v[54:55], v13 offset:2560
    s_waitcnt lgkmcnt(4)
    v_mfma_f32_32x32x16_bf16 v[80:95], v[44:47], v[164:167], v[80:95]
    ds_read_b64_tr_b16 v[40:41], v13 offset:4096
    ds_read_b64_tr_b16 v[42:43], v13 offset:4608
    s_waitcnt lgkmcnt(4)
    v_mfma_f32_32x32x16_bf16 v[80:95], v[48:51], v[168:171], v[80:95]
    ds_read_b64_tr_b16 v[44:45], v13 offset:6144
    ds_read_b64_tr_b16 v[46:47], v13 offset:6656
    s_waitcnt lgkmcnt(4)
    v_mfma_f32_32x32x16_bf16 v[80:95], v[52:55], v[172:175], v[80:95]
    ds_read_b64_tr_b16 v[48:49], v13 offset:8192
    ds_read_b64_tr_b16 v[50:51], v13 offset:8704
    s_waitcnt lgkmcnt(4)
    v_mfma_f32_32x32x16_bf16 v[80:95], v[40:43], v[176:179], v[80:95]
    ds_read_b64_tr_b16 v[52:53], v13 offset:10240
    ds_read_b64_tr_b16 v[54:55], v13 offset:10752
    s_waitcnt lgkmcnt(4)
    v_mfma_f32_32x32x16_bf16 v[80:95], v[44:47], v[180:183], v[80:95]
    ds_read_b64_tr_b16 v[40:41], v13 offset:12288
    ds_read_b64_tr_b16 v[42:43], v13 offset:12800
    s_waitcnt lgkmcnt(4)
    v_mfma_f32_32x32x16_bf16 v[80:95], v[48:51], v[184:187], v[80:95]
    ds_read_b64_tr_b16 v[44:45], v13 offset:14336
    ds_read_b64_tr_b16 v[46:47], v13 offset:14848
    s_waitcnt lgkmcnt(4)
    v_mfma_f32_32x32x16_bf16 v[80:95], v[52:55], v[188:191], v[80:95]
    ds_read_b64_tr_b16 v[48:49], v13 offset:16384
    ds_read_b64_tr_b16 v[50:51], v13 offset:16896
    s_waitcnt lgkmcnt(4)
    v_mfma_f32_32x32x16_bf16 v[80:95], v[40:43], v[192:195], v[80:95]
    ds_read_b64_tr_b16 v[52:53], v13 offset:18432
    ds_read_b64_tr_b16 v[54:55], v13 offset:18944
    s_waitcnt lgkmcnt(4)
    v_mfma_f32_32x32x16_bf16 v[80:95], v[44:47], v[196:199], v[80:95]
    ds_read_b64_tr_b16 v[40:41], v13 offset:20480
    ds_read_b64_tr_b16 v[42:43], v13 offset:20992
    s_waitcnt lgkmcnt(4)
    v_mfma_f32_32x32x16_bf16 v[80:95], v[48:51], v[200:203], v[80:95]
    ds_read_b64_tr_b16 v[44:45], v13 offset:22528
    ds_read_b64_tr_b16 v[46:47], v13 offset:23040
    s_waitcnt lgkmcnt(4)
    v_mfma_f32_32x32x16_bf16 v[80:95], v[52:55], v[204:207], v[80:95]
    ds_read_b64_tr_b16 v[48:49], v13 offset:24576
    ds_read_b64_tr_b16 v[50:51], v13 offset:25088
    s_waitcnt lgkmcnt(4)
    v_mfma_f32_32x32x16_bf16 v[80:95], v[40:43], v[208:211], v[80:95]
    ds_read_b64_tr_b16 v[52:53], v13 offset:26624
    ds_read_b64_tr_b16 v[54:55], v13 offset:27136
    s_waitcnt lgkmcnt(4)
    v_mfma_f32_32x32x16_bf16 v[80:95], v[44:47], v[212:215], v[80:95]
    ds_read_b64_tr_b16 v[40:41], v13 offset:28672
    ds_read_b64_tr_b16 v[42:43], v13 offset:29184
    s_waitcnt lgkmcnt(4)
    v_mfma_f32_32x32x16_bf16 v[80:95], v[48:51], v[216:219], v[80:95]
    ds_read_b64_tr_b16 v[44:45], v13 offset:30720
    ds_read_b64_tr_b16 v[46:47], v13 offset:31232
    s_waitcnt lgkmcnt(4)
    v_mfma_f32_32x32x16_bf16 v[80:95], v[52:55], v[220:223], v[80:95]
    ds_read_b64_tr_b16 v[48:49], v13 offset:32768
    ds_read_b64_tr_b16 v[50:51], v13 offset:33280
    s_waitcnt lgkmcnt(4)
    v_mfma_f32_32x32x16_bf16 v[80:95], v[40:43], v[224:227], v[80:95]
    ds_read_b64_tr_b16 v[52:53], v13 offset:34816
    ds_read_b64_tr_b16 v[54:55], v13 offset:35328
    s_load_dwordx4 s[32:35], s[0:1], 40
    s_load_dwordx2 s[36:37], s[0:1], 56
    s_load_dwordx2 s[38:39], s[0:1], 16
    s_waitcnt lgkmcnt(0)
    s_barrier
    v_mfma_f32_32x32x16_bf16 v[80:95], v[44:47], v[228:231], v[80:95]
    v_mfma_f32_32x32x16_bf16 v[80:95], v[48:51], v[232:235], v[80:95]
    v_mfma_f32_32x32x16_bf16 v[80:95], v[52:55], v[236:239], v[80:95]
    s_setprio 0
    s_mov_b32 s70, s65
    s_mov_b32 s49, s46
    v_lshrrev_b32 v240, 4, v1
    v_and_b32 v241, 7, v1
    v_xor_b32 v240, v240, v241
    v_lshlrev_b32 v240, 4, v240
    v_lshrrev_b32 v241, 3, v1
    v_lshlrev_b32 v241, 12, v241
    v_add_u32 v244, v240, v241
    v_xor_b32 v245, 64, v244
    v_add_u32 v246, 63488, v244
    v_add_u32 v247, 95232, v245
    v_add_u32 v245, 31744, v245
    s_lshl_b32 s46, s41, 19
    s_lshl_b32 s43, s49, 17
    s_add_u32 s46, s46, s43
    s_lshl_b32 s53, s49, 12
    s_add_u32 s53, s53, 36864
    s_mov_b32 s12, s32
    s_and_b32 s13, s33, 0xffff
    s_mov_b32 s14, 8388608
    s_mov_b32 s15, 0x20000
    s_add_u32 m0, s53, 0
    s_nop 0
    buffer_load_dwordx4 v244, s[12:15], s46 offen offset:0  lds
    buffer_load_dwordx4 v245, s[12:15], s46 offen offset:1024  lds
    buffer_load_dwordx4 v246, s[12:15], s46 offen offset:2048  lds
    buffer_load_dwordx4 v247, s[12:15], s46 offen offset:3072  lds
    s_mov_b32 s8, s28
    s_and_b32 s9, s29, 0xffff
    s_mov_b32 s10, 51380224
    s_mov_b32 s11, 0x20000
    v_lshlrev_b32 v248, 4, v1
    v_add_u32 v249, 64512, v248
    s_lshl_b32 s45, s42, 3
    s_lshl_b32 s47, s49, 1
    s_add_u32 s47, s47, s45
    s_mul_i32 s47, s47, 66560
    s_add_u32 s54, s53, 16384
    v_bfe_u32 v241, v1, 4, 1
    v_lshlrev_b32 v241, 1, v241
    v_xor_b32 v251, v241, v1
    v_lshlrev_b32 v251, 4, v251
    v_lshrrev_b32 v241, 5, v1
    v_lshlrev_b32 v241, 30, v241
    v_lshlrev_b32 v240, 4, v1
    v_add_u32 v240, v240, v241
    s_add_u32 s43, s42, 128
    s_mul_i32 s43, s43, 66560
    s_mul_i32 s50, s42, 294912
    s_add_u32 s50, s50, 33554432
    s_and_b32 s44, s41, 1
    s_lshl_b32 s45, s44, 10
    s_mul_i32 s44, s44, 1024
    s_add_u32 s44, s44, 2048
    s_cmp_eq_u32 s49, 2
    s_cselect_b32 s45, s44, s45
    s_cselect_b64 vcc, -1, 0
    v_cndmask_b32 v250, v248, v251, vcc
    s_cmp_eq_u32 s49, 3
    s_cselect_b32 s45, 4096, s45
    s_cselect_b64 vcc, -1, 0
    v_cndmask_b32 v250, v250, v240, vcc
    s_add_u32 s50, s50, s45
    s_mov_b32 s52, 9216
    s_mov_b32 s45, 3584
    s_cmp_eq_u32 s49, 0
    s_cselect_b32 s50, s43, s50
    s_cselect_b32 s52, 2048, s52
    s_cselect_b32 s45, 0, s45
    v_add_u32 v251, s45, v250
    s_lshl_b32 s55, s49, 11
    s_add_u32 s55, s55, 69632
    s_add_u32 s45, s55, 128
    s_cmp_eq_u32 s49, 3
    s_cselect_b32 s55, s45, s55
    v_mul_f32 v20, v80, v80
    v_mul_f32 v21, v81, v81
    v_mul_f32 v22, v82, v82
    v_mul_f32 v23, v83, v83
    v_fma_f32 v20, v20, v0, v17
    v_fma_f32 v21, v21, v0, v17
    v_fma_f32 v22, v22, v0, v17
    v_fma_f32 v23, v23, v0, v17
    v_mul_f32 v20, v20, v80
    v_mul_f32 v21, v21, v81
    v_mul_f32 v22, v22, v82
    v_mul_f32 v23, v23, v83
    v_exp_f32 v20, v20
    v_exp_f32 v21, v21
    v_exp_f32 v22, v22
    v_exp_f32 v23, v23
    v_fma_f32 v20, v20, v2, v2
    v_fma_f32 v21, v21, v2, v2
    v_fma_f32 v22, v22, v2, v2
    v_fma_f32 v23, v23, v2, v2
    v_rcp_f32 v20, v20
    v_rcp_f32 v21, v21
    v_rcp_f32 v22, v22
    v_rcp_f32 v23, v23
    v_mul_f32 v80, v80, v20
    v_mul_f32 v81, v81, v21
    v_mul_f32 v82, v82, v22
    v_mul_f32 v83, v83, v23
    v_cvt_pk_bf16_f32 v28, v80, v81
    v_cvt_pk_bf16_f32 v29, v82, v83
    v_mul_f32 v24, v88, v88
    v_mul_f32 v25, v89, v89
    v_mul_f32 v26, v90, v90
    v_mul_f32 v27, v91, v91
    v_fma_f32 v24, v24, v0, v17
    v_fma_f32 v25, v25, v0, v17
    v_fma_f32 v26, v26, v0, v17
    v_fma_f32 v27, v27, v0, v17
    v_mul_f32 v24, v24, v88
    v_mul_f32 v25, v25, v89
    v_mul_f32 v26, v26, v90
    v_mul_f32 v27, v27, v91
    v_exp_f32 v24, v24
    v_exp_f32 v25, v25
    v_exp_f32 v26, v26
    v_exp_f32 v27, v27
    v_fma_f32 v24, v24, v2, v2
    v_fma_f32 v25, v25, v2, v2
    v_fma_f32 v26, v26, v2, v2
    v_fma_f32 v27, v27, v2, v2
    v_rcp_f32 v24, v24
    v_rcp_f32 v25, v25
    v_rcp_f32 v26, v26
    v_rcp_f32 v27, v27
    v_mul_f32 v88, v88, v24
    v_mul_f32 v89, v89, v25
    v_mul_f32 v90, v90, v26
    v_mul_f32 v91, v91, v27
    v_cvt_pk_bf16_f32 v30, v88, v89
    v_cvt_pk_bf16_f32 v31, v90, v91
    buffer_store_dwordx4 v[28:31], v15, s[20:23], s70 offen offset:0
    v_mul_f32 v20, v84, v84
    v_mul_f32 v21, v85, v85
    v_mul_f32 v22, v86, v86
    v_mul_f32 v23, v87, v87
    v_fma_f32 v20, v20, v0, v17
    v_fma_f32 v21, v21, v0, v17
    v_fma_f32 v22, v22, v0, v17
    v_fma_f32 v23, v23, v0, v17
    v_mul_f32 v20, v20, v84
    v_mul_f32 v21, v21, v85
    v_mul_f32 v22, v22, v86
    v_mul_f32 v23, v23, v87
    v_exp_f32 v20, v20
    v_exp_f32 v21, v21
    v_exp_f32 v22, v22
    v_exp_f32 v23, v23
    v_fma_f32 v20, v20, v2, v2
    v_fma_f32 v21, v21, v2, v2
    v_fma_f32 v22, v22, v2, v2
    v_fma_f32 v23, v23, v2, v2
    v_rcp_f32 v20, v20
    v_rcp_f32 v21, v21
    v_rcp_f32 v22, v22
    v_rcp_f32 v23, v23
    v_mul_f32 v84, v84, v20
    v_mul_f32 v85, v85, v21
    v_mul_f32 v86, v86, v22
    v_mul_f32 v87, v87, v23
    v_cvt_pk_bf16_f32 v32, v84, v85
    v_cvt_pk_bf16_f32 v33, v86, v87
    v_mul_f32 v24, v92, v92
    v_mul_f32 v25, v93, v93
    v_mul_f32 v26, v94, v94
    v_mul_f32 v27, v95, v95
    v_fma_f32 v24, v24, v0, v17
    v_fma_f32 v25, v25, v0, v17
    v_fma_f32 v26, v26, v0, v17
    v_fma_f32 v27, v27, v0, v17
    v_mul_f32 v24, v24, v92
    v_mul_f32 v25, v25, v93
    v_mul_f32 v26, v26, v94
    v_mul_f32 v27, v27, v95
    v_exp_f32 v24, v24
    v_exp_f32 v25, v25
    v_exp_f32 v26, v26
    v_exp_f32 v27, v27
    v_fma_f32 v24, v24, v2, v2
    v_fma_f32 v25, v25, v2, v2
    v_fma_f32 v26, v26, v2, v2
    v_fma_f32 v27, v27, v2, v2
    v_rcp_f32 v24, v24
    v_rcp_f32 v25, v25
    v_rcp_f32 v26, v26
    v_rcp_f32 v27, v27
    v_mul_f32 v92, v92, v24
    v_mul_f32 v93, v93, v25
    v_mul_f32 v94, v94, v26
    v_mul_f32 v95, v95, v27
    v_cvt_pk_bf16_f32 v34, v92, v93
    v_cvt_pk_bf16_f32 v35, v94, v95
    buffer_store_dwordx4 v[32:35], v15, s[20:23], s70 offen offset:512
    s_cmp_lg_u32 s40, 4
    s_cbranch_scc1 L1_p2
    s_and_b32 s43, s2, 7
    s_lshl_b32 s43, s43, 10
    s_add_u32 s43, s43, 46743552
    v_lshlrev_b32 v24, 4, v1
    s_mov_b32 s45, 0
L1_q2l:
    buffer_load_dwordx4 v[20:23], v24, s[20:23], s43 offen sc1
    s_waitcnt vmcnt(0)
    v_xor_b32 v20, s26, v20
    v_xor_b32 v21, s26, v21
    v_xor_b32 v22, s26, v22
    v_xor_b32 v23, s26, v23
    v_or_b32 v20, v20, v21
    v_or3_b32 v20, v20, v22, v23
    v_cmp_ne_u32 vcc, 0, v20
    s_nop 4
    s_cbranch_vccz L1_q2d
    s_sleep 2
    s_add_u32 s45, s45, 1
    s_cmp_lt_u32 s45, 0x4000
    s_cbranch_scc1 L1_q2l
L1_q2d:
L1_p2:
    s_waitcnt lgkmcnt(0)
    s_barrier
    s_branch L2_attn
L1_end:
    s_endpgm
.p2align 4
L1_table:
.long 39845888
.long 39846400
.long 39847936
.long 39847168
.long 39846144
.long 39846656
.long 39846912
.long 39847424
.long 39847680
.long 40141056
.long 40141568
.long 40141824
.long 40140800
.long 40141312
.long 40142848
.long 40142080
.long 40142336
.long 40435712
.long 40436224
.long 40437760
.long 40142592
.long 40435968
.long 40436480
.long 40436736
.long 40436992
.long 40437504
.long 40730880
.long 40731392
.long 40437248
.long 40730624
.long 40731136
.long 40732672
.long 40731648
.long 40732160
.long 41025536
.long 41026048
.long 40731904
.long 40732416
.long 41025792
.long 41026304
.long 41027584
.long 41026816
.long 41027328
.long 41320704
.long 41026560
.long 41027072
.long 41320448
.long 41320960
.long 41321216
.long 41321472
.long 41321984
.long 41615360
.long 41322496
.long 41321728
.long 41322240
.long 41615616
.long 41615872
.long 41617408
.long 41616640
.long 41617152
.long 41616128
.long 41616384
.long 41616896
.long 41910272
.long 41910528
.long 41911040
.long 41911296
.long 41911808
.long 41910784
.long 41912320
.long 41911552
.long 41912064
.long 42205184
.long 42205696
.long 42207232
.long 42206464
.long 42205440
.long 42205952
.long 42206208
.long 42206720
.long 42206976
.long 42500352
.long 42500864
.long 42501120
.long 42500096
.long 42500608
.long 42502144
.long 42501376
.long 42501632
.long 42795008
.long 42795520
.long 42797056
.long 42501888
.long 42795264
.long 42795776
.long 42796032
.long 42796288
.long 42796800
.long 43090176
.long 43090688
.long 42796544
.long 43089920
.long 43090432
.long 43091968
.long 43090944
.long 43091456
.long 43384832
.long 43385344
.long 43091200
.long 43091712
.long 43385088
.long 43385600
.long 43386880
.long 43386112
.long 43386624
.long 43680000
.long 43385856
.long 43386368
.long 43679744
.long 43680256
.long 43680512
.long 43680768
.long 43681280
.long 43974656
.long 43681792
.long 43681024
.long 43681536
.long 43974912
.long 43975168
.long 43976704
.long 43975936
.long 43976448
.long 43975424
.long 43975680
.long 43976192
.long 44269568
.long 44269824
.long 44270336
.long 44270592
.long 44271104
.long 44270080
.long 44271616
.long 44270848
.long 44271360
.long 33554432
.long 33554944
.long 33558528
.long 33555712
.long 33554688
.long 33555200
.long 33555456
.long 33555968
.long 33556224
.long 33849600
.long 33850112
.long 33850368
.long 33849344
.long 33849856
.long 33853440
.long 33850624
.long 33850880
.long 34144256
.long 34144768
.long 34148352
.long 33851136
.long 34144512
.long 34145024
.long 34145280
.long 34145536
.long 34146048
.long 34439424
.long 34439936
.long 34145792
.long 34439168
.long 34439680
.long 34443264
.long 34440192
.long 34440704
.long 34734080
.long 34734592
.long 34440448
.long 34440960
.long 34734336
.long 34734848
.long 34738176
.long 34735360
.long 34735872
.long 35029248
.long 34735104
.long 34735616
.long 35028992
.long 35029504
.long 35029760
.long 35030016
.long 35030528
.long 35323904
.long 35033088
.long 35030272
.long 35030784
.long 35324160
.long 35324416
.long 35328000
.long 35325184
.long 35325696
.long 35324672
.long 35324928
.long 35325440
.long 35618816
.long 35619072
.long 35619584
.long 35619840
.long 35620352
.long 35619328
.long 35622912
.long 35620096
.long 35620608
.long 35913728
.long 35914240
.long 35917824
.long 35915008
.long 35913984
.long 35914496
.long 35914752
.long 35915264
.long 35915520
.long 36208896
.long 36209408
.long 36209664
.long 36208640
.long 36209152
.long 36212736
.long 36209920
.long 36210176
.long 36503552
.long 36504064
.long 36507648
.long 36210432
.long 36503808
.long 36504320
.long 36504576
.long 36504832
.long 36505344
.long 36798720
.long 36799232
.long 36505088
.long 36798464
.long 36798976
.long 36802560
.long 36799488
.long 36800000
.long 37093376
.long 37093888
.long 36799744
.long 36800256
.long 37093632
.long 37094144
.long 37097472
.long 37094656
.long 37095168
.long 37388544
.long 37094400
.long 37094912
.long 37388288
.long 37388800
.long 37389056
.long 37389312
.long 37389824
.long 37683200
.long 37392384
.long 37389568
.long 37390080
.long 37683456
.long 37683712
.long 37687296
.long 37684480
.long 37684992
.long 37683968
.long 37684224
.long 37684736
.long 37978112
.long 37978368
.long 37978880
.long 37979136
.long 37979648
.long 37978624
.long 37982208
.long 37979392
.long 37979904
.long 33556480
.long 33556992
.long 33558784
.long 33557760
.long 33556736
.long 33557248
.long 33557504
.long 33558016
.long 33558272
.long 33851648
.long 33852160
.long 33852416
.long 33851392
.long 33851904
.long 33853696
.long 33852672
.long 33852928
.long 34146304
.long 34146816
.long 34148608
.long 33853184
.long 34146560
.long 34147072
.long 34147328
.long 34147584
.long 34148096
.long 34441472
.long 34441984
.long 34147840
.long 34441216
.long 34441728
.long 34443520
.long 34442240
.long 34442752
.long 34736128
.long 34736640
.long 34442496
.long 34443008
.long 34736384
.long 34736896
.long 34738432
.long 34737408
.long 34737920
.long 35031296
.long 34737152
.long 34737664
.long 35031040
.long 35031552
.long 35031808
.long 35032064
.long 35032576
.long 35325952
.long 35033344
.long 35032320
.long 35032832
.long 35326208
.long 35326464
.long 35328256
.long 35327232
.long 35327744
.long 35326720
.long 35326976
.long 35327488
.long 35620864
.long 35621120
.long 35621632
.long 35621888
.long 35622400
.long 35621376
.long 35623168
.long 35622144
.long 35622656
.long 35915776
.long 35916288
.long 35918080
.long 35917056
.long 35916032
.long 35916544
.long 35916800
.long 35917312
.long 35917568
.long 36210944
.long 36211456
.long 36211712
.long 36210688
.long 36211200
.long 36212992
.long 36211968
.long 36212224
.long 36505600
.long 36506112
.long 36507904
.long 36212480
.long 36505856
.long 36506368
.long 36506624
.long 36506880
.long 36507392
.long 36800768
.long 36801280
.long 36507136
.long 36800512
.long 36801024
.long 36802816
.long 36801536
.long 36802048
.long 37095424
.long 37095936
.long 36801792
.long 36802304
.long 37095680
.long 37096192
.long 37097728
.long 37096704
.long 37097216
.long 37390592
.long 37096448
.long 37096960
.long 37390336
.long 37390848
.long 37391104
.long 37391360
.long 37391872
.long 37685248
.long 37392640
.long 37391616
.long 37392128
.long 37685504
.long 37685760
.long 37687552
.long 37686528
.long 37687040
.long 37686016
.long 37686272
.long 37686784
.long 37980160
.long 37980416
.long 37980928
.long 37981184
.long 37981696
.long 37980672
.long 37982464
.long 37981440
.long 37981952
L1_codeend:
.p2align 6
L2_gemm:
    s_waitcnt vmcnt(2)
    v_lshlrev_b32 v4, 16, v252
    v_mov_b32 v5, v4
    v_mov_b32 v6, v4
    v_mov_b32 v7, v4
    v_lshlrev_b32 v8, 16, v253
    v_mov_b32 v9, v8
    v_mov_b32 v10, v8
    v_mov_b32 v11, v8
    v_lshlrev_b32 v12, 16, v254
    v_mov_b32 v13, v12
    v_mov_b32 v14, v12
    v_mov_b32 v15, v12
    v_lshlrev_b32 v16, 16, v255
    v_mov_b32 v17, v16
    v_mov_b32 v18, v16
    v_mov_b32 v19, v16
    s_barrier
    ds_read_b128 v[152:155], v56 offset:0
    ds_read_b64_tr_b16 v[168:169], v68 offset:0
    ds_read_b64_tr_b16 v[170:171], v68 offset:512
    ds_read_b128 v[156:159], v56 offset:2048
    ds_read_b128 v[160:163], v57 offset:0
    ds_read_b128 v[164:167], v57 offset:2048
    ds_read_b64_tr_b16 v[172:173], v68 offset:2048
    ds_read_b64_tr_b16 v[174:175], v68 offset:2560
    ds_read_b64_tr_b16 v[176:177], v68 offset:4096
    ds_read_b64_tr_b16 v[178:179], v68 offset:4608
    ds_read_b64_tr_b16 v[180:181], v68 offset:6144
    ds_read_b64_tr_b16 v[182:183], v68 offset:6656
    ds_read_b64_tr_b16 v[184:185], v69 offset:0
    ds_read_b64_tr_b16 v[186:187], v69 offset:512
    s_waitcnt lgkmcnt(0)
    v_mfma_f32_16x16x32_bf16 v[80:83], v[168:171], v[152:155], v[4:7]
    ds_read_b128 v[188:191], v58 offset:0
    v_mfma_f32_16x16x32_bf16 v[84:87], v[168:171], v[156:159], v[8:11]
    ds_read_b64_tr_b16 v[204:205], v68 offset:1024
    v_mfma_f32_16x16x32_bf16 v[88:91], v[168:171], v[160:163], v[12:15]
    ds_read_b64_tr_b16 v[206:207], v68 offset:1536
    ds_read_b128 v[192:195], v58 offset:2048
    v_mfma_f32_16x16x32_bf16 v[92:95], v[168:171], v[164:167], v[16:19]
    ds_read_b128 v[196:199], v59 offset:0
    v_mfma_f32_16x16x32_bf16 v[108:111], v[172:175], v[164:167], v[16:19]
    ds_read_b128 v[200:203], v59 offset:2048
    ds_read_b64_tr_b16 v[208:209], v68 offset:3072
    v_mfma_f32_16x16x32_bf16 v[104:107], v[172:175], v[160:163], v[12:15]
    ds_read_b64_tr_b16 v[210:211], v68 offset:3584
    v_mfma_f32_16x16x32_bf16 v[100:103], v[172:175], v[156:159], v[8:11]
    ds_read_b64_tr_b16 v[212:213], v68 offset:5120
    v_mfma_f32_16x16x32_bf16 v[96:99], v[172:175], v[152:155], v[4:7]
    ds_read_b64_tr_b16 v[214:215], v68 offset:5632
    ds_read_b64_tr_b16 v[216:217], v68 offset:7168
    v_mfma_f32_16x16x32_bf16 v[112:115], v[176:179], v[152:155], v[4:7]
    ds_read_b64_tr_b16 v[218:219], v68 offset:7680
    v_mfma_f32_16x16x32_bf16 v[116:119], v[176:179], v[156:159], v[8:11]
    ds_read_b64_tr_b16 v[220:221], v69 offset:1024
    ds_read_b64_tr_b16 v[222:223], v69 offset:1536
    v_mfma_f32_16x16x32_bf16 v[120:123], v[176:179], v[160:163], v[12:15]
    s_add_u32 m0, s53, 82432
    s_nop 0
    buffer_load_dwordx4 v244, s[12:15], s46 offen offset:0  lds
    v_mfma_f32_16x16x32_bf16 v[124:127], v[176:179], v[164:167], v[16:19]
    buffer_load_dwordx4 v245, s[12:15], s46 offen offset:1024  lds
    v_mfma_f32_16x16x32_bf16 v[140:143], v[180:183], v[164:167], v[16:19]
    buffer_load_dwordx4 v246, s[12:15], s46 offen offset:2048  lds
    buffer_load_dwordx4 v247, s[12:15], s46 offen offset:3072  lds
    v_mfma_f32_16x16x32_bf16 v[136:139], v[180:183], v[160:163], v[12:15]
    s_add_u32 m0, s54, 82432
    s_add_u32 s46, s46, 128
    buffer_load_dwordx4 v248, s[8:11], s47 offen offset:0 sc1 lds
    v_mfma_f32_16x16x32_bf16 v[132:135], v[180:183], v[156:159], v[8:11]
    buffer_load_dwordx4 v248, s[8:11], s47 offen offset:1024 sc1 lds
    buffer_load_dwordx4 v249, s[8:11], s47 offen offset:2048 sc1 lds
    v_mfma_f32_16x16x32_bf16 v[128:131], v[180:183], v[152:155], v[4:7]
    buffer_load_dwordx4 v249, s[8:11], s47 offen offset:3072 sc1 lds
    v_mfma_f32_16x16x32_bf16 v[144:147], v[184:187], v[152:155], v[4:7]
    s_add_u32 m0, s55, 82432
    s_add_u32 s47, s47, 2048
    buffer_load_dwordx4 v250, s[8:11], s50 offen offset:0 sc1 lds
    buffer_load_dwordx4 v251, s[8:11], s50 offen offset:1024 sc1 lds
    s_add_u32 s50, s50, s52
    v_mfma_f32_16x16x32_bf16 v[148:151], v[184:187], v[156:159], v[8:11]
    s_waitcnt lgkmcnt(0)
    s_barrier
    v_mfma_f32_16x16x32_bf16 v[80:83], v[204:207], v[188:191], v[80:83]
    ds_read_b128 v[152:155], v60 offset:0
    v_mfma_f32_16x16x32_bf16 v[84:87], v[204:207], v[192:195], v[84:87]
    ds_read_b64_tr_b16 v[168:169], v70 offset:0
    v_mfma_f32_16x16x32_bf16 v[88:91], v[204:207], v[196:199], v[88:91]
    ds_read_b64_tr_b16 v[170:171], v70 offset:512
    v_mfma_f32_16x16x32_bf16 v[92:95], v[204:207], v[200:203], v[92:95]
    ds_read_b128 v[156:159], v60 offset:2048
    v_mfma_f32_16x16x32_bf16 v[108:111], v[208:211], v[200:203], v[108:111]
    ds_read_b128 v[160:163], v61 offset:0
    v_mfma_f32_16x16x32_bf16 v[104:107], v[208:211], v[196:199], v[104:107]
    ds_read_b128 v[164:167], v61 offset:2048
    ds_read_b64_tr_b16 v[172:173], v70 offset:2048
    v_mfma_f32_16x16x32_bf16 v[100:103], v[208:211], v[192:195], v[100:103]
    ds_read_b64_tr_b16 v[174:175], v70 offset:2560
    v_mfma_f32_16x16x32_bf16 v[96:99], v[208:211], v[188:191], v[96:99]
    ds_read_b64_tr_b16 v[176:177], v70 offset:4096
    v_mfma_f32_16x16x32_bf16 v[112:115], v[212:215], v[188:191], v[112:115]
    ds_read_b64_tr_b16 v[178:179], v70 offset:4608
    v_mfma_f32_16x16x32_bf16 v[116:119], v[212:215], v[192:195], v[116:119]
    ds_read_b64_tr_b16 v[180:181], v70 offset:6144
    v_mfma_f32_16x16x32_bf16 v[120:123], v[212:215], v[196:199], v[120:123]
    ds_read_b64_tr_b16 v[182:183], v70 offset:6656
    v_mfma_f32_16x16x32_bf16 v[124:127], v[212:215], v[200:203], v[124:127]
    ds_read_b64_tr_b16 v[184:185], v71 offset:0
    ds_read_b64_tr_b16 v[186:187], v71 offset:512
    v_mfma_f32_16x16x32_bf16 v[140:143], v[216:219], v[200:203], v[140:143]
    s_add_u32 m0, s53, 0
    s_nop 0
    buffer_load_dwordx4 v244, s[12:15], s46 offen offset:0  lds
    v_mfma_f32_16x16x32_bf16 v[136:139], v[216:219], v[196:199], v[136:139]
    buffer_load_dwordx4 v245, s[12:15], s46 offen offset:1024  lds
    v_mfma_f32_16x16x32_bf16 v[132:135], v[216:219], v[192:195], v[132:135]
    buffer_load_dwordx4 v246, s[12:15], s46 offen offset:2048  lds
    v_mfma_f32_16x16x32_bf16 v[128:131], v[216:219], v[188:191], v[128:131]
    buffer_load_dwordx4 v247, s[12:15], s46 offen offset:3072  lds
    v_mfma_f32_16x16x32_bf16 v[144:147], v[220:223], v[188:191], v[144:147]
    s_add_u32 m0, s54, 0
    s_add_u32 s46, s46, 128
    buffer_load_dwordx4 v248, s[8:11], s47 offen offset:0 sc1 lds
    buffer_load_dwordx4 v248, s[8:11], s47 offen offset:1024 sc1 lds
    v_mfma_f32_16x16x32_bf16 v[148:151], v[220:223], v[192:195], v[148:151]
    s_waitcnt lgkmcnt(0)
    v_mfma_f32_16x16x32_bf16 v[80:83], v[168:171], v[152:155], v[80:83]
    ds_read_b128 v[188:191], v62 offset:0
    v_mfma_f32_16x16x32_bf16 v[84:87], v[168:171], v[156:159], v[84:87]
    ds_read_b64_tr_b16 v[204:205], v70 offset:1024
    ds_read_b64_tr_b16 v[206:207], v70 offset:1536
    v_mfma_f32_16x16x32_bf16 v[88:91], v[168:171], v[160:163], v[88:91]
    ds_read_b128 v[192:195], v62 offset:2048
    v_mfma_f32_16x16x32_bf16 v[92:95], v[168:171], v[164:167], v[92:95]
    ds_read_b128 v[196:199], v63 offset:0
    ds_read_b128 v[200:203], v63 offset:2048
    v_mfma_f32_16x16x32_bf16 v[108:111], v[172:175], v[164:167], v[108:111]
    ds_read_b64_tr_b16 v[208:209], v70 offset:3072
    v_mfma_f32_16x16x32_bf16 v[104:107], v[172:175], v[160:163], v[104:107]
    ds_read_b64_tr_b16 v[210:211], v70 offset:3584
    ds_read_b64_tr_b16 v[212:213], v70 offset:5120
    v_mfma_f32_16x16x32_bf16 v[100:103], v[172:175], v[156:159], v[100:103]
    ds_read_b64_tr_b16 v[214:215], v70 offset:5632
    v_mfma_f32_16x16x32_bf16 v[96:99], v[172:175], v[152:155], v[96:99]
    ds_read_b64_tr_b16 v[216:217], v70 offset:7168
    ds_read_b64_tr_b16 v[218:219], v70 offset:7680
    v_mfma_f32_16x16x32_bf16 v[112:115], v[176:179], v[152:155], v[112:115]
    ds_read_b64_tr_b16 v[220:221], v71 offset:1024
    v_mfma_f32_16x16x32_bf16 v[116:119], v[176:179], v[156:159], v[116:119]
    ds_read_b64_tr_b16 v[222:223], v71 offset:1536
    buffer_load_dwordx4 v249, s[8:11], s47 offen offset:2048 sc1 lds
    v_mfma_f32_16x16x32_bf16 v[120:123], v[176:179], v[160:163], v[120:123]
    buffer_load_dwordx4 v249, s[8:11], s47 offen offset:3072 sc1 lds
    v_mfma_f32_16x16x32_bf16 v[124:127], v[176:179], v[164:167], v[124:127]
    s_add_u32 m0, s55, 0
    s_add_u32 s47, s47, 2048
    buffer_load_dwordx4 v250, s[8:11], s50 offen offset:0 sc1 lds
    buffer_load_dwordx4 v251, s[8:11], s50 offen offset:1024 sc1 lds
    s_add_u32 s50, s50, s52
    v_mfma_f32_16x16x32_bf16 v[140:143], v[180:183], v[164:167], v[140:143]
    v_mfma_f32_16x16x32_bf16 v[136:139], v[180:183], v[160:163], v[136:139]
    v_mfma_f32_16x16x32_bf16 v[132:135], v[180:183], v[156:159], v[132:135]
    v_mfma_f32_16x16x32_bf16 v[128:131], v[180:183], v[152:155], v[128:131]
    v_mfma_f32_16x16x32_bf16 v[144:147], v[184:187], v[152:155], v[144:147]
    v_mfma_f32_16x16x32_bf16 v[148:151], v[184:187], v[156:159], v[148:151]
    s_waitcnt vmcnt(10) lgkmcnt(0)
    s_barrier
    s_mov_b32 s48, 9
.p2align 6
L2g_loop:
    v_mfma_f32_16x16x32_bf16 v[80:83], v[204:207], v[188:191], v[80:83]
    ds_read_b128 v[152:155], v64 offset:0
    v_mfma_f32_16x16x32_bf16 v[84:87], v[204:207], v[192:195], v[84:87]
    ds_read_b64_tr_b16 v[168:169], v72 offset:0
    v_mfma_f32_16x16x32_bf16 v[88:91], v[204:207], v[196:199], v[88:91]
    ds_read_b64_tr_b16 v[170:171], v72 offset:512
    v_mfma_f32_16x16x32_bf16 v[92:95], v[204:207], v[200:203], v[92:95]
    ds_read_b128 v[156:159], v64 offset:2048
    v_mfma_f32_16x16x32_bf16 v[108:111], v[208:211], v[200:203], v[108:111]
    ds_read_b128 v[160:163], v65 offset:0
    v_mfma_f32_16x16x32_bf16 v[104:107], v[208:211], v[196:199], v[104:107]
    ds_read_b128 v[164:167], v65 offset:2048
    ds_read_b64_tr_b16 v[172:173], v72 offset:2048
    v_mfma_f32_16x16x32_bf16 v[100:103], v[208:211], v[192:195], v[100:103]
    ds_read_b64_tr_b16 v[174:175], v72 offset:2560
    v_mfma_f32_16x16x32_bf16 v[96:99], v[208:211], v[188:191], v[96:99]
    ds_read_b64_tr_b16 v[176:177], v72 offset:4096
    v_mfma_f32_16x16x32_bf16 v[112:115], v[212:215], v[188:191], v[112:115]
    ds_read_b64_tr_b16 v[178:179], v72 offset:4608
    v_mfma_f32_16x16x32_bf16 v[116:119], v[212:215], v[192:195], v[116:119]
    ds_read_b64_tr_b16 v[180:181], v72 offset:6144
    v_mfma_f32_16x16x32_bf16 v[120:123], v[212:215], v[196:199], v[120:123]
    ds_read_b64_tr_b16 v[182:183], v72 offset:6656
    v_mfma_f32_16x16x32_bf16 v[124:127], v[212:215], v[200:203], v[124:127]
    ds_read_b64_tr_b16 v[184:185], v73 offset:0
    ds_read_b64_tr_b16 v[186:187], v73 offset:512
    v_mfma_f32_16x16x32_bf16 v[140:143], v[216:219], v[200:203], v[140:143]
    s_add_u32 m0, s53, 41216
    s_nop 0
    buffer_load_dwordx4 v244, s[12:15], s46 offen offset:0  lds
    v_mfma_f32_16x16x32_bf16 v[136:139], v[216:219], v[196:199], v[136:139]
    buffer_load_dwordx4 v245, s[12:15], s46 offen offset:1024  lds
    v_mfma_f32_16x16x32_bf16 v[132:135], v[216:219], v[192:195], v[132:135]
    buffer_load_dwordx4 v246, s[12:15], s46 offen offset:2048  lds
    v_mfma_f32_16x16x32_bf16 v[128:131], v[216:219], v[188:191], v[128:131]
    buffer_load_dwordx4 v247, s[12:15], s46 offen offset:3072  lds
    v_mfma_f32_16x16x32_bf16 v[144:147], v[220:223], v[188:191], v[144:147]
    s_add_u32 m0, s54, 41216
    s_add_u32 s46, s46, 128
    buffer_load_dwordx4 v248, s[8:11], s47 offen offset:0 sc1 lds
    buffer_load_dwordx4 v248, s[8:11], s47 offen offset:1024 sc1 lds
    v_mfma_f32_16x16x32_bf16 v[148:151], v[220:223], v[192:195], v[148:151]
    s_waitcnt lgkmcnt(0)
    v_mfma_f32_16x16x32_bf16 v[80:83], v[168:171], v[152:155], v[80:83]
    ds_read_b128 v[188:191], v66 offset:0
    v_mfma_f32_16x16x32_bf16 v[84:87], v[168:171], v[156:159], v[84:87]
    ds_read_b64_tr_b16 v[204:205], v72 offset:1024
    ds_read_b64_tr_b16 v[206:207], v72 offset:1536
    v_mfma_f32_16x16x32_bf16 v[88:91], v[168:171], v[160:163], v[88:91]
    ds_read_b128 v[192:195], v66 offset:2048
    v_mfma_f32_16x16x32_bf16 v[92:95], v[168:171], v[164:167], v[92:95]
    ds_read_b128 v[196:199], v67 offset:0
    ds_read_b128 v[200:203], v67 offset:2048
    v_mfma_f32_16x16x32_bf16 v[108:111], v[172:175], v[164:167], v[108:111]
    ds_read_b64_tr_b16 v[208:209], v72 offset:3072
    v_mfma_f32_16x16x32_bf16 v[104:107], v[172:175], v[160:163], v[104:107]
    ds_read_b64_tr_b16 v[210:211], v72 offset:3584
    ds_read_b64_tr_b16 v[212:213], v72 offset:5120
    v_mfma_f32_16x16x32_bf16 v[100:103], v[172:175], v[156:159], v[100:103]
    ds_read_b64_tr_b16 v[214:215], v72 offset:5632
    ds_read_b64_tr_b16 v[216:217], v72 offset:7168
    v_mfma_f32_16x16x32_bf16 v[96:99], v[172:175], v[152:155], v[96:99]
    ds_read_b64_tr_b16 v[218:219], v72 offset:7680
    v_mfma_f32_16x16x32_bf16 v[112:115], v[176:179], v[152:155], v[112:115]
    ds_read_b64_tr_b16 v[220:221], v73 offset:1024
    ds_read_b64_tr_b16 v[222:223], v73 offset:1536
    v_mfma_f32_16x16x32_bf16 v[116:119], v[176:179], v[156:159], v[116:119]
    buffer_load_dwordx4 v249, s[8:11], s47 offen offset:2048 sc1 lds
    v_mfma_f32_16x16x32_bf16 v[120:123], v[176:179], v[160:163], v[120:123]
    buffer_load_dwordx4 v249, s[8:11], s47 offen offset:3072 sc1 lds
    s_add_u32 m0, s55, 41216
    s_add_u32 s47, s47, 2048
    buffer_load_dwordx4 v250, s[8:11], s50 offen offset:0 sc1 lds
    v_mfma_f32_16x16x32_bf16 v[124:127], v[176:179], v[164:167], v[124:127]
    buffer_load_dwordx4 v251, s[8:11], s50 offen offset:1024 sc1 lds
    s_add_u32 s50, s50, s52
    buffer_load_dword v3, v76, s[12:15], s58 offen
    s_add_u32 s58, s58, 384
    v_mfma_f32_16x16x32_bf16 v[140:143], v[180:183], v[164:167], v[140:143]
    v_mfma_f32_16x16x32_bf16 v[136:139], v[180:183], v[160:163], v[136:139]
    v_mfma_f32_16x16x32_bf16 v[132:135], v[180:183], v[156:159], v[132:135]
    v_mfma_f32_16x16x32_bf16 v[128:131], v[180:183], v[152:155], v[128:131]
    v_mfma_f32_16x16x32_bf16 v[144:147], v[184:187], v[152:155], v[144:147]
    v_mfma_f32_16x16x32_bf16 v[148:151], v[184:187], v[156:159], v[148:151]
    s_waitcnt vmcnt(11) lgkmcnt(0)
    s_barrier
    v_mfma_f32_16x16x32_bf16 v[80:83], v[204:207], v[188:191], v[80:83]
    ds_read_b128 v[152:155], v56 offset:0
    v_mfma_f32_16x16x32_bf16 v[84:87], v[204:207], v[192:195], v[84:87]
    ds_read_b64_tr_b16 v[168:169], v68 offset:0
    v_mfma_f32_16x16x32_bf16 v[88:91], v[204:207], v[196:199], v[88:91]
    ds_read_b64_tr_b16 v[170:171], v68 offset:512
    v_mfma_f32_16x16x32_bf16 v[92:95], v[204:207], v[200:203], v[92:95]
    ds_read_b128 v[156:159], v56 offset:2048
    v_mfma_f32_16x16x32_bf16 v[108:111], v[208:211], v[200:203], v[108:111]
    ds_read_b128 v[160:163], v57 offset:0
    v_mfma_f32_16x16x32_bf16 v[104:107], v[208:211], v[196:199], v[104:107]
    ds_read_b128 v[164:167], v57 offset:2048
    ds_read_b64_tr_b16 v[172:173], v68 offset:2048
    v_mfma_f32_16x16x32_bf16 v[100:103], v[208:211], v[192:195], v[100:103]
    ds_read_b64_tr_b16 v[174:175], v68 offset:2560
    v_mfma_f32_16x16x32_bf16 v[96:99], v[208:211], v[188:191], v[96:99]
    ds_read_b64_tr_b16 v[176:177], v68 offset:4096
    v_mfma_f32_16x16x32_bf16 v[112:115], v[212:215], v[188:191], v[112:115]
    ds_read_b64_tr_b16 v[178:179], v68 offset:4608
    v_mfma_f32_16x16x32_bf16 v[116:119], v[212:215], v[192:195], v[116:119]
    ds_read_b64_tr_b16 v[180:181], v68 offset:6144
    v_mfma_f32_16x16x32_bf16 v[120:123], v[212:215], v[196:199], v[120:123]
    ds_read_b64_tr_b16 v[182:183], v68 offset:6656
    v_mfma_f32_16x16x32_bf16 v[124:127], v[212:215], v[200:203], v[124:127]
    ds_read_b64_tr_b16 v[184:185], v69 offset:0
    ds_read_b64_tr_b16 v[186:187], v69 offset:512
    v_mfma_f32_16x16x32_bf16 v[140:143], v[216:219], v[200:203], v[140:143]
    s_add_u32 m0, s53, 82432
    s_nop 0
    buffer_load_dwordx4 v244, s[12:15], s46 offen offset:0  lds
    v_mfma_f32_16x16x32_bf16 v[136:139], v[216:219], v[196:199], v[136:139]
    buffer_load_dwordx4 v245, s[12:15], s46 offen offset:1024  lds
    v_mfma_f32_16x16x32_bf16 v[132:135], v[216:219], v[192:195], v[132:135]
    buffer_load_dwordx4 v246, s[12:15], s46 offen offset:2048  lds
    v_mfma_f32_16x16x32_bf16 v[128:131], v[216:219], v[188:191], v[128:131]
    buffer_load_dwordx4 v247, s[12:15], s46 offen offset:3072  lds
    v_mfma_f32_16x16x32_bf16 v[144:147], v[220:223], v[188:191], v[144:147]
    s_add_u32 m0, s54, 82432
    s_add_u32 s46, s46, 128
    buffer_load_dwordx4 v248, s[8:11], s47 offen offset:0 sc1 lds
    buffer_load_dwordx4 v248, s[8:11], s47 offen offset:1024 sc1 lds
    v_mfma_f32_16x16x32_bf16 v[148:151], v[220:223], v[192:195], v[148:151]
    s_waitcnt lgkmcnt(0)
    v_mfma_f32_16x16x32_bf16 v[80:83], v[168:171], v[152:155], v[80:83]
    ds_read_b128 v[188:191], v58 offset:0
    v_mfma_f32_16x16x32_bf16 v[84:87], v[168:171], v[156:159], v[84:87]
    ds_read_b64_tr_b16 v[204:205], v68 offset:1024
    ds_read_b64_tr_b16 v[206:207], v68 offset:1536
    v_mfma_f32_16x16x32_bf16 v[88:91], v[168:171], v[160:163], v[88:91]
    ds_read_b128 v[192:195], v58 offset:2048
    v_mfma_f32_16x16x32_bf16 v[92:95], v[168:171], v[164:167], v[92:95]
    ds_read_b128 v[196:199], v59 offset:0
    ds_read_b128 v[200:203], v59 offset:2048
    v_mfma_f32_16x16x32_bf16 v[108:111], v[172:175], v[164:167], v[108:111]
    ds_read_b64_tr_b16 v[208:209], v68 offset:3072
    v_mfma_f32_16x16x32_bf16 v[104:107], v[172:175], v[160:163], v[104:107]
    ds_read_b64_tr_b16 v[210:211], v68 offset:3584
    ds_read_b64_tr_b16 v[212:213], v68 offset:5120
    v_mfma_f32_16x16x32_bf16 v[100:103], v[172:175], v[156:159], v[100:103]
    ds_read_b64_tr_b16 v[214:215], v68 offset:5632
    v_mfma_f32_16x16x32_bf16 v[96:99], v[172:175], v[152:155], v[96:99]
    ds_read_b64_tr_b16 v[216:217], v68 offset:7168
    ds_read_b64_tr_b16 v[218:219], v68 offset:7680
    v_mfma_f32_16x16x32_bf16 v[112:115], v[176:179], v[152:155], v[112:115]
    ds_read_b64_tr_b16 v[220:221], v69 offset:1024
    v_mfma_f32_16x16x32_bf16 v[116:119], v[176:179], v[156:159], v[116:119]
    ds_read_b64_tr_b16 v[222:223], v69 offset:1536
    buffer_load_dwordx4 v249, s[8:11], s47 offen offset:2048 sc1 lds
    v_mfma_f32_16x16x32_bf16 v[120:123], v[176:179], v[160:163], v[120:123]
    buffer_load_dwordx4 v249, s[8:11], s47 offen offset:3072 sc1 lds
    v_mfma_f32_16x16x32_bf16 v[124:127], v[176:179], v[164:167], v[124:127]
    s_add_u32 m0, s55, 82432
    s_add_u32 s47, s47, 2048
    buffer_load_dwordx4 v250, s[8:11], s50 offen offset:0 sc1 lds
    buffer_load_dwordx4 v251, s[8:11], s50 offen offset:1024 sc1 lds
    s_add_u32 s50, s50, s52
    v_mfma_f32_16x16x32_bf16 v[140:143], v[180:183], v[164:167], v[140:143]
    v_mfma_f32_16x16x32_bf16 v[136:139], v[180:183], v[160:163], v[136:139]
    v_mfma_f32_16x16x32_bf16 v[132:135], v[180:183], v[156:159], v[132:135]
    v_mfma_f32_16x16x32_bf16 v[128:131], v[180:183], v[152:155], v[128:131]
    v_mfma_f32_16x16x32_bf16 v[144:147], v[184:187], v[152:155], v[144:147]
    v_mfma_f32_16x16x32_bf16 v[148:151], v[184:187], v[156:159], v[148:151]
    s_waitcnt vmcnt(11) lgkmcnt(0)
    s_barrier
    v_mfma_f32_16x16x32_bf16 v[80:83], v[204:207], v[188:191], v[80:83]
    ds_read_b128 v[152:155], v60 offset:0
    v_mfma_f32_16x16x32_bf16 v[84:87], v[204:207], v[192:195], v[84:87]
    ds_read_b64_tr_b16 v[168:169], v70 offset:0
    v_mfma_f32_16x16x32_bf16 v[88:91], v[204:207], v[196:199], v[88:91]
    ds_read_b64_tr_b16 v[170:171], v70 offset:512
    v_mfma_f32_16x16x32_bf16 v[92:95], v[204:207], v[200:203], v[92:95]
    ds_read_b128 v[156:159], v60 offset:2048
    v_mfma_f32_16x16x32_bf16 v[108:111], v[208:211], v[200:203], v[108:111]
    ds_read_b128 v[160:163], v61 offset:0
    v_mfma_f32_16x16x32_bf16 v[104:107], v[208:211], v[196:199], v[104:107]
    ds_read_b128 v[164:167], v61 offset:2048
    ds_read_b64_tr_b16 v[172:173], v70 offset:2048
    v_mfma_f32_16x16x32_bf16 v[100:103], v[208:211], v[192:195], v[100:103]
    ds_read_b64_tr_b16 v[174:175], v70 offset:2560
    v_mfma_f32_16x16x32_bf16 v[96:99], v[208:211], v[188:191], v[96:99]
    ds_read_b64_tr_b16 v[176:177], v70 offset:4096
    v_mfma_f32_16x16x32_bf16 v[112:115], v[212:215], v[188:191], v[112:115]
    ds_read_b64_tr_b16 v[178:179], v70 offset:4608
    v_mfma_f32_16x16x32_bf16 v[116:119], v[212:215], v[192:195], v[116:119]
    ds_read_b64_tr_b16 v[180:181], v70 offset:6144
    v_mfma_f32_16x16x32_bf16 v[120:123], v[212:215], v[196:199], v[120:123]
    ds_read_b64_tr_b16 v[182:183], v70 offset:6656
    v_mfma_f32_16x16x32_bf16 v[124:127], v[212:215], v[200:203], v[124:127]
    ds_read_b64_tr_b16 v[184:185], v71 offset:0
    ds_read_b64_tr_b16 v[186:187], v71 offset:512
    v_mfma_f32_16x16x32_bf16 v[140:143], v[216:219], v[200:203], v[140:143]
    s_add_u32 m0, s53, 0
    s_nop 0
    buffer_load_dwordx4 v244, s[12:15], s46 offen offset:0  lds
    v_mfma_f32_16x16x32_bf16 v[136:139], v[216:219], v[196:199], v[136:139]
    buffer_load_dwordx4 v245, s[12:15], s46 offen offset:1024  lds
    v_mfma_f32_16x16x32_bf16 v[132:135], v[216:219], v[192:195], v[132:135]
    buffer_load_dwordx4 v246, s[12:15], s46 offen offset:2048  lds
    v_mfma_f32_16x16x32_bf16 v[128:131], v[216:219], v[188:191], v[128:131]
    buffer_load_dwordx4 v247, s[12:15], s46 offen offset:3072  lds
    v_mfma_f32_16x16x32_bf16 v[144:147], v[220:223], v[188:191], v[144:147]
    s_add_u32 m0, s54, 0
    s_add_u32 s46, s46, 128
    buffer_load_dwordx4 v248, s[8:11], s47 offen offset:0 sc1 lds
    buffer_load_dwordx4 v248, s[8:11], s47 offen offset:1024 sc1 lds
    v_mfma_f32_16x16x32_bf16 v[148:151], v[220:223], v[192:195], v[148:151]
    s_waitcnt lgkmcnt(0)
    v_mfma_f32_16x16x32_bf16 v[80:83], v[168:171], v[152:155], v[80:83]
    ds_read_b128 v[188:191], v62 offset:0
    v_mfma_f32_16x16x32_bf16 v[84:87], v[168:171], v[156:159], v[84:87]
    ds_read_b64_tr_b16 v[204:205], v70 offset:1024
    ds_read_b64_tr_b16 v[206:207], v70 offset:1536
    v_mfma_f32_16x16x32_bf16 v[88:91], v[168:171], v[160:163], v[88:91]
    ds_read_b128 v[192:195], v62 offset:2048
    v_mfma_f32_16x16x32_bf16 v[92:95], v[168:171], v[164:167], v[92:95]
    ds_read_b128 v[196:199], v63 offset:0
    ds_read_b128 v[200:203], v63 offset:2048
    v_mfma_f32_16x16x32_bf16 v[108:111], v[172:175], v[164:167], v[108:111]
    ds_read_b64_tr_b16 v[208:209], v70 offset:3072
    v_mfma_f32_16x16x32_bf16 v[104:107], v[172:175], v[160:163], v[104:107]
    ds_read_b64_tr_b16 v[210:211], v70 offset:3584
    ds_read_b64_tr_b16 v[212:213], v70 offset:5120
    v_mfma_f32_16x16x32_bf16 v[100:103], v[172:175], v[156:159], v[100:103]
    ds_read_b64_tr_b16 v[214:215], v70 offset:5632
    v_mfma_f32_16x16x32_bf16 v[96:99], v[172:175], v[152:155], v[96:99]
    ds_read_b64_tr_b16 v[216:217], v70 offset:7168
    ds_read_b64_tr_b16 v[218:219], v70 offset:7680
    v_mfma_f32_16x16x32_bf16 v[112:115], v[176:179], v[152:155], v[112:115]
    ds_read_b64_tr_b16 v[220:221], v71 offset:1024
    v_mfma_f32_16x16x32_bf16 v[116:119], v[176:179], v[156:159], v[116:119]
    ds_read_b64_tr_b16 v[222:223], v71 offset:1536
    buffer_load_dwordx4 v249, s[8:11], s47 offen offset:2048 sc1 lds
    v_mfma_f32_16x16x32_bf16 v[120:123], v[176:179], v[160:163], v[120:123]
    buffer_load_dwordx4 v249, s[8:11], s47 offen offset:3072 sc1 lds
    v_mfma_f32_16x16x32_bf16 v[124:127], v[176:179], v[164:167], v[124:127]
    s_add_u32 m0, s55, 0
    s_add_u32 s47, s47, 2048
    buffer_load_dwordx4 v250, s[8:11], s50 offen offset:0 sc1 lds
    buffer_load_dwordx4 v251, s[8:11], s50 offen offset:1024 sc1 lds
    s_add_u32 s50, s50, s52
    v_mfma_f32_16x16x32_bf16 v[140:143], v[180:183], v[164:167], v[140:143]
    v_mfma_f32_16x16x32_bf16 v[136:139], v[180:183], v[160:163], v[136:139]
    v_mfma_f32_16x16x32_bf16 v[132:135], v[180:183], v[156:159], v[132:135]
    v_mfma_f32_16x16x32_bf16 v[128:131], v[180:183], v[152:155], v[128:131]
    v_mfma_f32_16x16x32_bf16 v[144:147], v[184:187], v[152:155], v[144:147]
    v_mfma_f32_16x16x32_bf16 v[148:151], v[184:187], v[156:159], v[148:151]
    s_waitcnt vmcnt(10) lgkmcnt(0)
    s_barrier
    s_sub_u32 s48, s48, 1
    s_cmp_lg_u32 s48, 0
    s_cbranch_scc1 L2g_loop
    v_mfma_f32_16x16x32_bf16 v[80:83], v[204:207], v[188:191], v[80:83]
    ds_read_b128 v[152:155], v64 offset:0
    v_mfma_f32_16x16x32_bf16 v[84:87], v[204:207], v[192:195], v[84:87]
    ds_read_b64_tr_b16 v[168:169], v72 offset:0
    v_mfma_f32_16x16x32_bf16 v[88:91], v[204:207], v[196:199], v[88:91]
    ds_read_b64_tr_b16 v[170:171], v72 offset:512
    v_mfma_f32_16x16x32_bf16 v[92:95], v[204:207], v[200:203], v[92:95]
    ds_read_b128 v[156:159], v64 offset:2048
    v_mfma_f32_16x16x32_bf16 v[108:111], v[208:211], v[200:203], v[108:111]
    ds_read_b128 v[160:163], v65 offset:0
    v_mfma_f32_16x16x32_bf16 v[104:107], v[208:211], v[196:199], v[104:107]
    ds_read_b128 v[164:167], v65 offset:2048
    ds_read_b64_tr_b16 v[172:173], v72 offset:2048
    v_mfma_f32_16x16x32_bf16 v[100:103], v[208:211], v[192:195], v[100:103]
    ds_read_b64_tr_b16 v[174:175], v72 offset:2560
    v_mfma_f32_16x16x32_bf16 v[96:99], v[208:211], v[188:191], v[96:99]
    ds_read_b64_tr_b16 v[176:177], v72 offset:4096
    v_mfma_f32_16x16x32_bf16 v[112:115], v[212:215], v[188:191], v[112:115]
    ds_read_b64_tr_b16 v[178:179], v72 offset:4608
    v_mfma_f32_16x16x32_bf16 v[116:119], v[212:215], v[192:195], v[116:119]
    ds_read_b64_tr_b16 v[180:181], v72 offset:6144
    v_mfma_f32_16x16x32_bf16 v[120:123], v[212:215], v[196:199], v[120:123]
    ds_read_b64_tr_b16 v[182:183], v72 offset:6656
    v_mfma_f32_16x16x32_bf16 v[124:127], v[212:215], v[200:203], v[124:127]
    ds_read_b64_tr_b16 v[184:185], v73 offset:0
    ds_read_b64_tr_b16 v[186:187], v73 offset:512
    v_mfma_f32_16x16x32_bf16 v[140:143], v[216:219], v[200:203], v[140:143]
    s_add_u32 m0, s53, 41216
    s_nop 0
    buffer_load_dwordx4 v244, s[12:15], s46 offen offset:0  lds
    v_mfma_f32_16x16x32_bf16 v[136:139], v[216:219], v[196:199], v[136:139]
    buffer_load_dwordx4 v245, s[12:15], s46 offen offset:1024  lds
    v_mfma_f32_16x16x32_bf16 v[132:135], v[216:219], v[192:195], v[132:135]
    buffer_load_dwordx4 v246, s[12:15], s46 offen offset:2048  lds
    v_mfma_f32_16x16x32_bf16 v[128:131], v[216:219], v[188:191], v[128:131]
    buffer_load_dwordx4 v247, s[12:15], s46 offen offset:3072  lds
    v_mfma_f32_16x16x32_bf16 v[144:147], v[220:223], v[188:191], v[144:147]
    s_add_u32 m0, s54, 41216
    s_add_u32 s46, s46, 128
    buffer_load_dwordx4 v248, s[8:11], s47 offen offset:0 sc1 lds
    buffer_load_dwordx4 v248, s[8:11], s47 offen offset:1024 sc1 lds
    v_mfma_f32_16x16x32_bf16 v[148:151], v[220:223], v[192:195], v[148:151]
    s_waitcnt lgkmcnt(0)
    v_mfma_f32_16x16x32_bf16 v[80:83], v[168:171], v[152:155], v[80:83]
    ds_read_b128 v[188:191], v66 offset:0
    v_mfma_f32_16x16x32_bf16 v[84:87], v[168:171], v[156:159], v[84:87]
    ds_read_b64_tr_b16 v[204:205], v72 offset:1024
    ds_read_b64_tr_b16 v[206:207], v72 offset:1536
    v_mfma_f32_16x16x32_bf16 v[88:91], v[168:171], v[160:163], v[88:91]
    ds_read_b128 v[192:195], v66 offset:2048
    v_mfma_f32_16x16x32_bf16 v[92:95], v[168:171], v[164:167], v[92:95]
    ds_read_b128 v[196:199], v67 offset:0
    ds_read_b128 v[200:203], v67 offset:2048
    v_mfma_f32_16x16x32_bf16 v[108:111], v[172:175], v[164:167], v[108:111]
    ds_read_b64_tr_b16 v[208:209], v72 offset:3072
    v_mfma_f32_16x16x32_bf16 v[104:107], v[172:175], v[160:163], v[104:107]
    ds_read_b64_tr_b16 v[210:211], v72 offset:3584
    ds_read_b64_tr_b16 v[212:213], v72 offset:5120
    v_mfma_f32_16x16x32_bf16 v[100:103], v[172:175], v[156:159], v[100:103]
    ds_read_b64_tr_b16 v[214:215], v72 offset:5632
    ds_read_b64_tr_b16 v[216:217], v72 offset:7168
    v_mfma_f32_16x16x32_bf16 v[96:99], v[172:175], v[152:155], v[96:99]
    ds_read_b64_tr_b16 v[218:219], v72 offset:7680
    v_mfma_f32_16x16x32_bf16 v[112:115], v[176:179], v[152:155], v[112:115]
    ds_read_b64_tr_b16 v[220:221], v73 offset:1024
    ds_read_b64_tr_b16 v[222:223], v73 offset:1536
    v_mfma_f32_16x16x32_bf16 v[116:119], v[176:179], v[156:159], v[116:119]
    buffer_load_dwordx4 v249, s[8:11], s47 offen offset:2048 sc1 lds
    v_mfma_f32_16x16x32_bf16 v[120:123], v[176:179], v[160:163], v[120:123]
    buffer_load_dwordx4 v249, s[8:11], s47 offen offset:3072 sc1 lds
    s_add_u32 m0, s55, 41216
    s_add_u32 s47, s47, 2048
    buffer_load_dwordx4 v250, s[8:11], s50 offen offset:0 sc1 lds
    v_mfma_f32_16x16x32_bf16 v[124:127], v[176:179], v[164:167], v[124:127]
    buffer_load_dwordx4 v251, s[8:11], s50 offen offset:1024 sc1 lds
    s_add_u32 s50, s50, s52
    s_cmp_lg_u32 s49, 0
    s_cbranch_scc1 L2_nonxa
    s_getpc_b64 s[24:25]
L2_pca:
    s_lshr_b32 s43, s2, 3
    s_mul_i32 s43, s43, 512
    s_add_u32 s43, s43, k3_out_kernel-L2_pca
    v_lshlrev_b32 v2, 7, v1
    v_add_u32 v2, s43, v2
    v_min_u32 v2, L_allend-L2_pca-4, v2
    s_mov_b64 exec, 0xf
    global_load_dword v3, v2, s[24:25]
    s_mov_b64 exec, -1
L2_nonxa:
    v_mfma_f32_16x16x32_bf16 v[140:143], v[180:183], v[164:167], v[140:143]
    v_mfma_f32_16x16x32_bf16 v[136:139], v[180:183], v[160:163], v[136:139]
    v_mfma_f32_16x16x32_bf16 v[132:135], v[180:183], v[156:159], v[132:135]
    v_mfma_f32_16x16x32_bf16 v[128:131], v[180:183], v[152:155], v[128:131]
    v_mfma_f32_16x16x32_bf16 v[144:147], v[184:187], v[152:155], v[144:147]
    v_mfma_f32_16x16x32_bf16 v[148:151], v[184:187], v[156:159], v[148:151]
    s_waitcnt vmcnt(10) lgkmcnt(0)
    s_barrier
    v_mfma_f32_16x16x32_bf16 v[80:83], v[204:207], v[188:191], v[80:83]
    ds_read_b128 v[152:155], v56 offset:0
    v_mfma_f32_16x16x32_bf16 v[84:87], v[204:207], v[192:195], v[84:87]
    ds_read_b64_tr_b16 v[168:169], v68 offset:0
    v_mfma_f32_16x16x32_bf16 v[88:91], v[204:207], v[196:199], v[88:91]
    ds_read_b64_tr_b16 v[170:171], v68 offset:512
    v_mfma_f32_16x16x32_bf16 v[92:95], v[204:207], v[200:203], v[92:95]
    ds_read_b128 v[156:159], v56 offset:2048
    v_mfma_f32_16x16x32_bf16 v[108:111], v[208:211], v[200:203], v[108:111]
    ds_read_b128 v[160:163], v57 offset:0
    v_mfma_f32_16x16x32_bf16 v[104:107], v[208:211], v[196:199], v[104:107]
    ds_read_b128 v[164:167], v57 offset:2048
    ds_read_b64_tr_b16 v[172:173], v68 offset:2048
    v_mfma_f32_16x16x32_bf16 v[100:103], v[208:211], v[192:195], v[100:103]
    ds_read_b64_tr_b16 v[174:175], v68 offset:2560
    v_mfma_f32_16x16x32_bf16 v[96:99], v[208:211], v[188:191], v[96:99]
    ds_read_b64_tr_b16 v[176:177], v68 offset:4096
    v_mfma_f32_16x16x32_bf16 v[112:115], v[212:215], v[188:191], v[112:115]
    ds_read_b64_tr_b16 v[178:179], v68 offset:4608
    v_mfma_f32_16x16x32_bf16 v[116:119], v[212:215], v[192:195], v[116:119]
    ds_read_b64_tr_b16 v[180:181], v68 offset:6144
    v_mfma_f32_16x16x32_bf16 v[120:123], v[212:215], v[196:199], v[120:123]
    ds_read_b64_tr_b16 v[182:183], v68 offset:6656
    v_mfma_f32_16x16x32_bf16 v[124:127], v[212:215], v[200:203], v[124:127]
    ds_read_b64_tr_b16 v[184:185], v69 offset:0
    ds_read_b64_tr_b16 v[186:187], v69 offset:512
    v_mfma_f32_16x16x32_bf16 v[140:143], v[216:219], v[200:203], v[140:143]
    buffer_load_dwordx4 v[4:7], v74, s[8:11], s64 offen offset:0
    v_mfma_f32_16x16x32_bf16 v[136:139], v[216:219], v[196:199], v[136:139]
    buffer_load_dwordx4 v[8:11], v74, s[8:11], s64 offen offset:1024
    v_mfma_f32_16x16x32_bf16 v[132:135], v[216:219], v[192:195], v[132:135]
    buffer_load_dwordx4 v[12:15], v74, s[8:11], s65 offen offset:0
    v_mfma_f32_16x16x32_bf16 v[128:131], v[216:219], v[188:191], v[128:131]
    buffer_load_dwordx4 v[16:19], v74, s[8:11], s65 offen offset:1024
    v_mfma_f32_16x16x32_bf16 v[144:147], v[220:223], v[188:191], v[144:147]
    buffer_load_dwordx4 v[20:23], v74, s[8:11], s66 offen offset:0
    buffer_load_dwordx4 v[24:27], v74, s[8:11], s66 offen offset:1024
    v_mfma_f32_16x16x32_bf16 v[148:151], v[220:223], v[192:195], v[148:151]
    s_waitcnt lgkmcnt(0)
    v_mfma_f32_16x16x32_bf16 v[80:83], v[168:171], v[152:155], v[80:83]
    ds_read_b128 v[188:191], v58 offset:0
    v_mfma_f32_16x16x32_bf16 v[84:87], v[168:171], v[156:159], v[84:87]
    ds_read_b64_tr_b16 v[204:205], v68 offset:1024
    ds_read_b64_tr_b16 v[206:207], v68 offset:1536
    v_mfma_f32_16x16x32_bf16 v[88:91], v[168:171], v[160:163], v[88:91]
    ds_read_b128 v[192:195], v58 offset:2048
    v_mfma_f32_16x16x32_bf16 v[92:95], v[168:171], v[164:167], v[92:95]
    ds_read_b128 v[196:199], v59 offset:0
    ds_read_b128 v[200:203], v59 offset:2048
    v_mfma_f32_16x16x32_bf16 v[108:111], v[172:175], v[164:167], v[108:111]
    ds_read_b64_tr_b16 v[208:209], v68 offset:3072
    v_mfma_f32_16x16x32_bf16 v[104:107], v[172:175], v[160:163], v[104:107]
    ds_read_b64_tr_b16 v[210:211], v68 offset:3584
    ds_read_b64_tr_b16 v[212:213], v68 offset:5120
    v_mfma_f32_16x16x32_bf16 v[100:103], v[172:175], v[156:159], v[100:103]
    ds_read_b64_tr_b16 v[214:215], v68 offset:5632
    v_mfma_f32_16x16x32_bf16 v[96:99], v[172:175], v[152:155], v[96:99]
    ds_read_b64_tr_b16 v[216:217], v68 offset:7168
    ds_read_b64_tr_b16 v[218:219], v68 offset:7680
    v_mfma_f32_16x16x32_bf16 v[112:115], v[176:179], v[152:155], v[112:115]
    ds_read_b64_tr_b16 v[220:221], v69 offset:1024
    v_mfma_f32_16x16x32_bf16 v[116:119], v[176:179], v[156:159], v[116:119]
    ds_read_b64_tr_b16 v[222:223], v69 offset:1536
    buffer_load_dwordx4 v[28:31], v74, s[8:11], s67 offen offset:0
    v_mfma_f32_16x16x32_bf16 v[120:123], v[176:179], v[160:163], v[120:123]
    buffer_load_dwordx4 v[32:35], v74, s[8:11], s67 offen offset:1024
    v_mfma_f32_16x16x32_bf16 v[124:127], v[176:179], v[164:167], v[124:127]
    buffer_load_dwordx2 v[36:37], v75, s[8:11], s64 offen sc1
    buffer_load_dwordx2 v[38:39], v75, s[8:11], s65 offen sc1
    v_mfma_f32_16x16x32_bf16 v[140:143], v[180:183], v[164:167], v[140:143]
    v_mfma_f32_16x16x32_bf16 v[136:139], v[180:183], v[160:163], v[136:139]
    v_mfma_f32_16x16x32_bf16 v[132:135], v[180:183], v[156:159], v[132:135]
    v_mfma_f32_16x16x32_bf16 v[128:131], v[180:183], v[152:155], v[128:131]
    v_mfma_f32_16x16x32_bf16 v[144:147], v[184:187], v[152:155], v[144:147]
    v_mfma_f32_16x16x32_bf16 v[148:151], v[184:187], v[156:159], v[148:151]
    s_waitcnt vmcnt(10) lgkmcnt(0)
    s_barrier
    v_mfma_f32_16x16x32_bf16 v[80:83], v[204:207], v[188:191], v[80:83]
    v_mfma_f32_16x16x32_bf16 v[84:87], v[204:207], v[192:195], v[84:87]
    ds_read_b128 v[152:155], v60 offset:0
    v_mfma_f32_16x16x32_bf16 v[88:91], v[204:207], v[196:199], v[88:91]
    ds_read_b64_tr_b16 v[168:169], v70 offset:0
    v_mfma_f32_16x16x32_bf16 v[92:95], v[204:207], v[200:203], v[92:95]
    ds_read_b64_tr_b16 v[170:171], v70 offset:512
    v_mfma_f32_16x16x32_bf16 v[108:111], v[208:211], v[200:203], v[108:111]
    ds_read_b128 v[156:159], v60 offset:2048
    v_mfma_f32_16x16x32_bf16 v[104:107], v[208:211], v[196:199], v[104:107]
    v_mfma_f32_16x16x32_bf16 v[100:103], v[208:211], v[192:195], v[100:103]
    ds_read_b128 v[160:163], v61 offset:0
    v_mfma_f32_16x16x32_bf16 v[96:99], v[208:211], v[188:191], v[96:99]
    ds_read_b128 v[164:167], v61 offset:2048
    v_mfma_f32_16x16x32_bf16 v[112:115], v[212:215], v[188:191], v[112:115]
    ds_read_b64_tr_b16 v[172:173], v70 offset:2048
    v_mfma_f32_16x16x32_bf16 v[116:119], v[212:215], v[192:195], v[116:119]
    ds_read_b64_tr_b16 v[174:175], v70 offset:2560
    v_mfma_f32_16x16x32_bf16 v[120:123], v[212:215], v[196:199], v[120:123]
    ds_read_b64_tr_b16 v[176:177], v70 offset:4096
    v_mfma_f32_16x16x32_bf16 v[124:127], v[212:215], v[200:203], v[124:127]
    v_mfma_f32_16x16x32_bf16 v[140:143], v[216:219], v[200:203], v[140:143]
    ds_read_b64_tr_b16 v[178:179], v70 offset:4608
    v_mfma_f32_16x16x32_bf16 v[136:139], v[216:219], v[196:199], v[136:139]
    ds_read_b64_tr_b16 v[180:181], v70 offset:6144
    v_mfma_f32_16x16x32_bf16 v[132:135], v[216:219], v[192:195], v[132:135]
    ds_read_b64_tr_b16 v[182:183], v70 offset:6656
    v_mfma_f32_16x16x32_bf16 v[128:131], v[216:219], v[188:191], v[128:131]
    ds_read_b64_tr_b16 v[184:185], v71 offset:0
    v_mfma_f32_16x16x32_bf16 v[144:147], v[220:223], v[188:191], v[144:147]
    ds_read_b64_tr_b16 v[186:187], v71 offset:512
    v_mfma_f32_16x16x32_bf16 v[148:151], v[220:223], v[192:195], v[148:151]
    s_waitcnt lgkmcnt(0)
    v_mfma_f32_16x16x32_bf16 v[80:83], v[168:171], v[152:155], v[80:83]
    v_mfma_f32_16x16x32_bf16 v[84:87], v[168:171], v[156:159], v[84:87]
    ds_read_b128 v[188:191], v62 offset:0
    v_mfma_f32_16x16x32_bf16 v[88:91], v[168:171], v[160:163], v[88:91]
    ds_read_b64_tr_b16 v[204:205], v70 offset:1024
    v_mfma_f32_16x16x32_bf16 v[92:95], v[168:171], v[164:167], v[92:95]
    ds_read_b64_tr_b16 v[206:207], v70 offset:1536
    v_mfma_f32_16x16x32_bf16 v[108:111], v[172:175], v[164:167], v[108:111]
    ds_read_b128 v[192:195], v62 offset:2048
    v_mfma_f32_16x16x32_bf16 v[104:107], v[172:175], v[160:163], v[104:107]
    v_mfma_f32_16x16x32_bf16 v[100:103], v[172:175], v[156:159], v[100:103]
    ds_read_b128 v[196:199], v63 offset:0
    v_mfma_f32_16x16x32_bf16 v[96:99], v[172:175], v[152:155], v[96:99]
    ds_read_b128 v[200:203], v63 offset:2048
    v_mfma_f32_16x16x32_bf16 v[112:115], v[176:179], v[152:155], v[112:115]
    ds_read_b64_tr_b16 v[208:209], v70 offset:3072
    v_mfma_f32_16x16x32_bf16 v[116:119], v[176:179], v[156:159], v[116:119]
    ds_read_b64_tr_b16 v[210:211], v70 offset:3584
    v_mfma_f32_16x16x32_bf16 v[120:123], v[176:179], v[160:163], v[120:123]
    ds_read_b64_tr_b16 v[212:213], v70 offset:5120
    v_mfma_f32_16x16x32_bf16 v[124:127], v[176:179], v[164:167], v[124:127]
    v_mfma_f32_16x16x32_bf16 v[140:143], v[180:183], v[164:167], v[140:143]
    ds_read_b64_tr_b16 v[214:215], v70 offset:5632
    v_mfma_f32_16x16x32_bf16 v[136:139], v[180:183], v[160:163], v[136:139]
    ds_read_b64_tr_b16 v[216:217], v70 offset:7168
    v_mfma_f32_16x16x32_bf16 v[132:135], v[180:183], v[156:159], v[132:135]
    ds_read_b64_tr_b16 v[218:219], v70 offset:7680
    v_mfma_f32_16x16x32_bf16 v[128:131], v[180:183], v[152:155], v[128:131]
    ds_read_b64_tr_b16 v[220:221], v71 offset:1024
    v_mfma_f32_16x16x32_bf16 v[144:147], v[184:187], v[152:155], v[144:147]
    ds_read_b64_tr_b16 v[222:223], v71 offset:1536
    v_mfma_f32_16x16x32_bf16 v[148:151], v[184:187], v[156:159], v[148:151]
    s_waitcnt lgkmcnt(0)
    v_mfma_f32_16x16x32_bf16 v[80:83], v[204:207], v[188:191], v[80:83]
    v_mfma_f32_16x16x32_bf16 v[84:87], v[204:207], v[192:195], v[84:87]
    v_mfma_f32_16x16x32_bf16 v[88:91], v[204:207], v[196:199], v[88:91]
    v_mfma_f32_16x16x32_bf16 v[92:95], v[204:207], v[200:203], v[92:95]
    v_mfma_f32_16x16x32_bf16 v[108:111], v[208:211], v[200:203], v[108:111]
    v_mfma_f32_16x16x32_bf16 v[104:107], v[208:211], v[196:199], v[104:107]
    v_mfma_f32_16x16x32_bf16 v[100:103], v[208:211], v[192:195], v[100:103]
    v_mfma_f32_16x16x32_bf16 v[96:99], v[208:211], v[188:191], v[96:99]
    v_mfma_f32_16x16x32_bf16 v[112:115], v[212:215], v[188:191], v[112:115]
    v_mfma_f32_16x16x32_bf16 v[116:119], v[212:215], v[192:195], v[116:119]
    v_mfma_f32_16x16x32_bf16 v[120:123], v[212:215], v[196:199], v[120:123]
    v_mfma_f32_16x16x32_bf16 v[124:127], v[212:215], v[200:203], v[124:127]
    v_mfma_f32_16x16x32_bf16 v[140:143], v[216:219], v[200:203], v[140:143]
    v_mfma_f32_16x16x32_bf16 v[136:139], v[216:219], v[196:199], v[136:139]
    v_mfma_f32_16x16x32_bf16 v[132:135], v[216:219], v[192:195], v[132:135]
    v_mfma_f32_16x16x32_bf16 v[128:131], v[216:219], v[188:191], v[128:131]
    v_mfma_f32_16x16x32_bf16 v[144:147], v[220:223], v[188:191], v[144:147]
    v_mfma_f32_16x16x32_bf16 v[148:151], v[220:223], v[192:195], v[148:151]
    s_waitcnt vmcnt(0)
    v_lshlrev_b32 v240, 16, v4
    v_and_b32 v241, 0xffff0000, v4
    v_mul_f32 v240, v240, v80
    v_mul_f32 v241, v241, v81
    v_cvt_pk_bf16_f32 v4, v240, v241
    v_lshlrev_b32 v242, 16, v5
    v_and_b32 v243, 0xffff0000, v5
    v_mul_f32 v242, v242, v82
    v_mul_f32 v243, v243, v83
    v_cvt_pk_bf16_f32 v5, v242, v243
    v_lshlrev_b32 v240, 16, v6
    v_and_b32 v241, 0xffff0000, v6
    v_mul_f32 v240, v240, v96
    v_mul_f32 v241, v241, v97
    v_cvt_pk_bf16_f32 v6, v240, v241
    v_lshlrev_b32 v242, 16, v7
    v_and_b32 v243, 0xffff0000, v7
    v_mul_f32 v242, v242, v98
    v_mul_f32 v243, v243, v99
    v_cvt_pk_bf16_f32 v7, v242, v243
    buffer_store_dwordx4 v[4:7], v74, s[8:11], s68 offen offset:0
    v_lshlrev_b32 v240, 16, v12
    v_and_b32 v241, 0xffff0000, v12
    v_mul_f32 v240, v240, v84
    v_mul_f32 v241, v241, v85
    v_cvt_pk_bf16_f32 v12, v240, v241
    v_lshlrev_b32 v242, 16, v13
    v_and_b32 v243, 0xffff0000, v13
    v_mul_f32 v242, v242, v86
    v_mul_f32 v243, v243, v87
    v_cvt_pk_bf16_f32 v13, v242, v243
    v_lshlrev_b32 v240, 16, v14
    v_and_b32 v241, 0xffff0000, v14
    v_mul_f32 v240, v240, v100
    v_mul_f32 v241, v241, v101
    v_cvt_pk_bf16_f32 v14, v240, v241
    v_lshlrev_b32 v242, 16, v15
    v_and_b32 v243, 0xffff0000, v15
    v_mul_f32 v242, v242, v102
    v_mul_f32 v243, v243, v103
    v_cvt_pk_bf16_f32 v15, v242, v243
    buffer_store_dwordx4 v[12:15], v74, s[8:11], s69 offen offset:0
    v_lshlrev_b32 v240, 16, v20
    v_and_b32 v241, 0xffff0000, v20
    v_mul_f32 v240, v240, v88
    v_mul_f32 v241, v241, v89
    v_cvt_pk_bf16_f32 v20, v240, v241
    v_lshlrev_b32 v242, 16, v21
    v_and_b32 v243, 0xffff0000, v21
    v_mul_f32 v242, v242, v90
    v_mul_f32 v243, v243, v91
    v_cvt_pk_bf16_f32 v21, v242, v243
    v_lshlrev_b32 v240, 16, v22
    v_and_b32 v241, 0xffff0000, v22
    v_mul_f32 v240, v240, v104
    v_mul_f32 v241, v241, v105
    v_cvt_pk_bf16_f32 v22, v240, v241
    v_lshlrev_b32 v242, 16, v23
    v_and_b32 v243, 0xffff0000, v23
    v_mul_f32 v242, v242, v106
    v_mul_f32 v243, v243, v107
    v_cvt_pk_bf16_f32 v23, v242, v243
    buffer_store_dwordx4 v[20:23], v74, s[8:11], s56 offen offset:0
    v_lshlrev_b32 v240, 16, v28
    v_and_b32 v241, 0xffff0000, v28
    v_mul_f32 v240, v240, v92
    v_mul_f32 v241, v241, v93
    v_cvt_pk_bf16_f32 v28, v240, v241
    v_lshlrev_b32 v242, 16, v29
    v_and_b32 v243, 0xffff0000, v29
    v_mul_f32 v242, v242, v94
    v_mul_f32 v243, v243, v95
    v_cvt_pk_bf16_f32 v29, v242, v243
    v_lshlrev_b32 v240, 16, v30
    v_and_b32 v241, 0xffff0000, v30
    v_mul_f32 v240, v240, v108
    v_mul_f32 v241, v241, v109
    v_cvt_pk_bf16_f32 v30, v240, v241
    v_lshlrev_b32 v242, 16, v31
    v_and_b32 v243, 0xffff0000, v31
    v_mul_f32 v242, v242, v110
    v_mul_f32 v243, v243, v111
    v_cvt_pk_bf16_f32 v31, v242, v243
    buffer_store_dwordx4 v[28:31], v74, s[8:11], s57 offen offset:0
    v_lshlrev_b32 v240, 16, v8
    v_and_b32 v241, 0xffff0000, v8
    v_mul_f32 v240, v240, v112
    v_mul_f32 v241, v241, v113
    v_cvt_pk_bf16_f32 v8, v240, v241
    v_lshlrev_b32 v242, 16, v9
    v_and_b32 v243, 0xffff0000, v9
    v_mul_f32 v242, v242, v114
    v_mul_f32 v243, v243, v115
    v_cvt_pk_bf16_f32 v9, v242, v243
    v_lshlrev_b32 v240, 16, v10
    v_and_b32 v241, 0xffff0000, v10
    v_mul_f32 v240, v240, v128
    v_mul_f32 v241, v241, v129
    v_cvt_pk_bf16_f32 v10, v240, v241
    v_lshlrev_b32 v242, 16, v11
    v_and_b32 v243, 0xffff0000, v11
    v_mul_f32 v242, v242, v130
    v_mul_f32 v243, v243, v131
    v_cvt_pk_bf16_f32 v11, v242, v243
    buffer_store_dwordx4 v[8:11], v74, s[8:11], s68 offen offset:1024
    v_lshlrev_b32 v240, 16, v16
    v_and_b32 v241, 0xffff0000, v16
    v_mul_f32 v240, v240, v116
    v_mul_f32 v241, v241, v117
    v_cvt_pk_bf16_f32 v16, v240, v241
    v_lshlrev_b32 v242, 16, v17
    v_and_b32 v243, 0xffff0000, v17
    v_mul_f32 v242, v242, v118
    v_mul_f32 v243, v243, v119
    v_cvt_pk_bf16_f32 v17, v242, v243
    v_lshlrev_b32 v240, 16, v18
    v_and_b32 v241, 0xffff0000, v18
    v_mul_f32 v240, v240, v132
    v_mul_f32 v241, v241, v133
    v_cvt_pk_bf16_f32 v18, v240, v241
    v_lshlrev_b32 v242, 16, v19
    v_and_b32 v243, 0xffff0000, v19
    v_mul_f32 v242, v242, v134
    v_mul_f32 v243, v243, v135
    v_cvt_pk_bf16_f32 v19, v242, v243
    buffer_store_dwordx4 v[16:19], v74, s[8:11], s69 offen offset:1024
    v_lshlrev_b32 v240, 16, v24
    v_and_b32 v241, 0xffff0000, v24
    v_mul_f32 v240, v240, v120
    v_mul_f32 v241, v241, v121
    v_cvt_pk_bf16_f32 v24, v240, v241
    v_lshlrev_b32 v242, 16, v25
    v_and_b32 v243, 0xffff0000, v25
    v_mul_f32 v242, v242, v122
    v_mul_f32 v243, v243, v123
    v_cvt_pk_bf16_f32 v25, v242, v243
    v_lshlrev_b32 v240, 16, v26
    v_and_b32 v241, 0xffff0000, v26
    v_mul_f32 v240, v240, v136
    v_mul_f32 v241, v241, v137
    v_cvt_pk_bf16_f32 v26, v240, v241
    v_lshlrev_b32 v242, 16, v27
    v_and_b32 v243, 0xffff0000, v27
    v_mul_f32 v242, v242, v138
    v_mul_f32 v243, v243, v139
    v_cvt_pk_bf16_f32 v27, v242, v243
    buffer_store_dwordx4 v[24:27], v74, s[8:11], s56 offen offset:1024
    v_lshlrev_b32 v240, 16, v32
    v_and_b32 v241, 0xffff0000, v32
    v_mul_f32 v240, v240, v124
    v_mul_f32 v241, v241, v125
    v_cvt_pk_bf16_f32 v32, v240, v241
    v_lshlrev_b32 v242, 16, v33
    v_and_b32 v243, 0xffff0000, v33
    v_mul_f32 v242, v242, v126
    v_mul_f32 v243, v243, v127
    v_cvt_pk_bf16_f32 v33, v242, v243
    v_lshlrev_b32 v240, 16, v34
    v_and_b32 v241, 0xffff0000, v34
    v_mul_f32 v240, v240, v140
    v_mul_f32 v241, v241, v141
    v_cvt_pk_bf16_f32 v34, v240, v241
    v_lshlrev_b32 v242, 16, v35
    v_and_b32 v243, 0xffff0000, v35
    v_mul_f32 v242, v242, v142
    v_mul_f32 v243, v243, v143
    v_cvt_pk_bf16_f32 v35, v242, v243
    buffer_store_dwordx4 v[32:35], v74, s[8:11], s57 offen offset:1024
    v_lshlrev_b32 v240, 16, v36
    v_and_b32 v241, 0xffff0000, v36
    v_mul_f32 v240, v240, v144
    v_mul_f32 v241, v241, v145
    v_cvt_pk_bf16_f32 v36, v240, v241
    v_lshlrev_b32 v242, 16, v37
    v_and_b32 v243, 0xffff0000, v37
    v_mul_f32 v242, v242, v146
    v_mul_f32 v243, v243, v147
    v_cvt_pk_bf16_f32 v37, v242, v243
    buffer_store_dwordx2 v[36:37], v75, s[8:11], s68 offen
    v_lshlrev_b32 v240, 16, v38
    v_and_b32 v241, 0xffff0000, v38
    v_mul_f32 v240, v240, v148
    v_mul_f32 v241, v241, v149
    v_cvt_pk_bf16_f32 v38, v240, v241
    v_lshlrev_b32 v242, 16, v39
    v_and_b32 v243, 0xffff0000, v39
    v_mul_f32 v242, v242, v150
    v_mul_f32 v243, v243, v151
    v_cvt_pk_bf16_f32 v39, v242, v243
    buffer_store_dwordx2 v[38:39], v75, s[8:11], s69 offen
    s_endpgm
L2_attn:
    s_add_u32 m0, s54, 0
    s_add_u32 s46, s46, 128
    buffer_load_dwordx4 v248, s[8:11], s47 offen offset:0 sc1 lds
    buffer_load_dwordx4 v248, s[8:11], s47 offen offset:1024 sc1 lds
    buffer_load_dwordx4 v249, s[8:11], s47 offen offset:2048 sc1 lds
    buffer_load_dwordx4 v249, s[8:11], s47 offen offset:3072 sc1 lds
    s_add_u32 m0, s55, 0
    s_add_u32 s47, s47, 2048
    buffer_load_dwordx4 v250, s[8:11], s50 offen offset:0 sc1 lds
    buffer_load_dwordx4 v251, s[8:11], s50 offen offset:1024 sc1 lds
    s_add_u32 s50, s50, s52
    s_setprio 1
    s_mov_b32 s62, s49
    s_and_b32 s63, s41, 1
    v_lshlrev_b32 v12, 4, v1
    s_waitcnt lgkmcnt(0)
    s_mov_b32 s8, s28
    s_and_b32 s9, s29, 0xffff
    s_mov_b32 s10, 51380224
    s_mov_b32 s11, 0x20000
    s_mul_i32 s43, s42, 294912
    s_add_u32 s65, s43, 33554432
    s_mul_i32 s43, s42, 294912
    s_lshr_b32 s44, s41, 1
    s_lshl_b32 s44, s44, 3
    s_lshl_b32 s45, s62, 1
    s_add_u32 s66, s44, s45
    s_mul_i32 s44, s66, 4608
    s_add_u32 s43, s43, s44
    s_add_u32 s43, s43, 39845888
    s_lshl_b32 s44, s63, 10
    s_add_u32 s44, s44, s43
    s_add_u32 s45, s44, 4608
    v_and_b32 v4, 31, v1
    v_lshlrev_b32 v4, 3, v4
    v_lshrrev_b32 v13, 5, v1
    v_lshlrev_b32 v13, 9, v13
    v_add_u32 v13, v13, v4
    buffer_load_dwordx2 v[40:41], v13, s[8:11], s44 offen offset:0 sc1
    buffer_load_dwordx2 v[42:43], v13, s[8:11], s44 offen offset:256 sc1
    buffer_load_dwordx2 v[44:45], v13, s[8:11], s45 offen offset:0 sc1
    buffer_load_dwordx2 v[46:47], v13, s[8:11], s45 offen offset:256 sc1
    s_lshl_b32 s44, s63, 2
    s_add_u32 s44, s44, s43
    s_add_u32 s45, s44, 4608
    buffer_load_dword v6, v4, s[8:11], s44 offen offset:2048 sc1
    buffer_load_dword v7, v4, s[8:11], s45 offen offset:2048 sc1
    v_mov_b32 v66, 0
    v_mov_b32 v67, 0
    v_mov_b32 v70, 0
    v_mov_b32 v71, 0
    s_add_u32 m0, s53, 41216
    s_nop 0
    buffer_load_dwordx4 v244, s[12:15], s46 offen offset:0  lds
    buffer_load_dwordx4 v245, s[12:15], s46 offen offset:1024  lds
    buffer_load_dwordx4 v246, s[12:15], s46 offen offset:2048  lds
    buffer_load_dwordx4 v247, s[12:15], s46 offen offset:3072  lds
    s_add_u32 m0, s54, 41216
    s_add_u32 s46, s46, 128
    buffer_load_dwordx4 v248, s[8:11], s47 offen offset:0 sc1 lds
    buffer_load_dwordx4 v248, s[8:11], s47 offen offset:1024 sc1 lds
    buffer_load_dwordx4 v249, s[8:11], s47 offen offset:2048 sc1 lds
    buffer_load_dwordx4 v249, s[8:11], s47 offen offset:3072 sc1 lds
    s_add_u32 m0, s55, 41216
    s_add_u32 s47, s47, 2048
    buffer_load_dwordx4 v250, s[8:11], s50 offen offset:0 sc1 lds
    buffer_load_dwordx4 v251, s[8:11], s50 offen offset:1024 sc1 lds
    s_add_u32 s50, s50, s52
    s_mov_b32 s58, 0
    s_mov_b32 s59, -1
    s_cmp_eq_u32 s63, 1
    s_cselect_b64 s[56:57], -1, 0
    v_and_b32 v5, 3, v1
    v_mov_b32 v8, 0
    v_mov_b32 v9, 0
    v_mov_b32 v10, 0
    v_mov_b32 v11, 0
    v_cmp_eq_u32 vcc, 1, v5
    v_mov_b32 v37, 0x3f803f80
    s_nop 0
    v_cndmask_b32 v8, v8, v37, vcc
    v_cmp_eq_u32 vcc, 0, v5
    v_mov_b32 v37, 0x3f80
    s_nop 0
    v_cndmask_b32 v10, v10, v37, vcc
    v_add_u32 v37, 160512, v12
    ds_write_b128 v37, v[8:11]
    v_add_u32 v14, 4224, v4
    v_mov_b32 v37, 160528
    v_cndmask_b32 v14, v14, v37, s[58:59]
    v_cndmask_b32 v16, 1, 0, s[58:59]
    v_lshrrev_b32 v8, 5, v1
    v_lshlrev_b32 v8, 2, v8
    v_bfe_u32 v9, v1, 2, 2
    v_add_u32 v8, v8, v9
    v_lshlrev_b32 v8, 3, v8
    v_and_b32 v10, 1, v1
    v_lshlrev_b32 v15, 5, v10
    v_xor_b32 v15, v15, v8
    v_lshlrev_b32 v9, 8, v5
    v_add_u32 v15, v9, v15
    v_add_u32 v15, 2048, v15
    v_add_u32 v8, 4480, v8
    v_lshlrev_b32 v9, 2, v5
    v_and_b32 v9, 8, v9
    v_add_u32 v9, 160512, v9
    v_cmp_eq_u32 vcc, 0, v5
    v_mov_b32 v17, 1
    s_nop 0
    v_cndmask_b32 v8, v9, v8, vcc
    v_cndmask_b32 v9, 0, v17, vcc
    v_and_b32 v10, 16, v1
    v_cmp_eq_u32 vcc, 0, v10
    s_nop 0
    s_nop 0
    v_cndmask_b32 v15, v8, v15, vcc
    v_cndmask_b32 v17, v9, v17, vcc
    v_bfe_u32 v8, v1, 4, 1
    v_mul_u32_u24 v8, 92160, v8
    v_and_b32 v9, 15, v1
    v_lshlrev_b32 v9, 4, v9
    v_add_u32 v8, v8, v9
    s_mul_i32 s43, s66, 184320
    s_add_u32 s43, s43, 20971520
    s_add_u32 s44, s42, 72
    s_lshl_b32 s44, s44, 10
    s_lshl_b32 s45, s63, 9
    s_add_u32 s44, s44, s45
    s_add_u32 s44, s44, s43
    v_lshrrev_b32 v9, 5, v1
    v_lshlrev_b32 v9, 8, v9
    v_add3_u32 v33, v8, v9, s44
    v_add_u32 v34, 184320, v33
    s_lshr_b32 s44, s42, 3
    s_add_u32 s44, s44, 88
    s_lshl_b32 s44, s44, 10
    s_add_u32 s43, s43, s44
    s_bfe_u32 s44, s42, 0x20001
    s_lshl_b32 s44, s44, 8
    s_add_u32 s43, s43, s44
    s_and_b32 s44, s42, 1
    s_lshl_b32 s44, s44, 3
    s_add_u32 s43, s43, s44
    s_lshl_b32 s44, s63, 2
    s_add_u32 s43, s43, s44
    v_add_u32 v35, s43, v8
    v_mov_b32 v9, 0x7f000000
    v_cndmask_b32 v35, v35, v9, s[58:59]
    v_add_u32 v36, 184320, v35
    s_waitcnt vmcnt(10)
    v_cndmask_b32 v6, v6, 0, s[58:59]
    v_cndmask_b32 v48, v6, 0, s[56:57]
    v_cndmask_b32 v49, 0, v6, s[56:57]
    v_mov_b32 v50, 0
    v_mov_b32 v51, 0
    v_cndmask_b32 v7, v7, 0, s[58:59]
    v_cndmask_b32 v52, v7, 0, s[56:57]
    v_cndmask_b32 v53, 0, v7, s[56:57]
    v_mov_b32 v54, 0
    v_mov_b32 v55, 0
    s_lshl_b32 s46, s2, 2
    s_add_u32 s46, s46, s62
    s_mul_i32 s47, s46, 7282
    s_lshr_b32 s47, s47, 16
    s_mul_i32 s49, s47, 9
    s_sub_u32 s49, s46, s49
    s_lshl_b32 s49, s49, 7
    s_mul_i32 s50, s62, 5376
    s_add_u32 s50, s50, 0
    v_lshrrev_b32 v176, 4, v1
    v_lshlrev_b32 v176, 1, v176
    v_and_b32 v177, 7, v1
    v_xor_b32 v176, v176, v177
    v_lshlrev_b32 v176, 4, v176
    v_lshrrev_b32 v177, 3, v1
    v_and_b32 v178, 3, v177
    v_lshrrev_b32 v179, 5, v1
    v_mul_u32_u24 v179, 72, v179
    v_add_u32 v178, v178, v179
    s_cmp_ge_u32 s47, 88
    s_cselect_b64 vcc, -1, 0
    v_cndmask_b32 v177, v177, v178, vcc
    v_mul_u32_u24 v177, 1152, v177
    v_add3_u32 v176, v176, v177, s49
    s_cmp_lt_u32 s47, 72
    s_cselect_b32 s4, s36, s38
    s_cselect_b32 s5, s37, s39
    s_and_b32 s5, s5, 0xffff
    s_mov_b32 s6, 663552
    s_cmp_lt_u32 s47, 72
    s_cselect_b32 s6, 2654208, s6
    s_mov_b32 s7, 0x20000
    s_lshl_b32 s51, s47, 5
    s_sub_u32 s52, s47, 72
    s_mul_i32 s52, s52, 36
    s_sub_u32 s53, s47, 88
    s_mul_i32 s53, s53, 288
    s_add_u32 s43, s51, 0
    s_add_u32 s44, s52, 0
    s_cmp_lt_u32 s47, 72
    s_cselect_b32 s43, s43, s44
    s_add_u32 s44, s53, 16
    s_cmp_lt_u32 s47, 88
    s_cselect_b32 s43, s43, s44
    s_mul_i32 s68, s43, 1152
    s_add_u32 s43, s51, 8
    s_add_u32 s44, s52, 20
    s_cmp_lt_u32 s47, 72
    s_cselect_b32 s43, s43, s44
    s_add_u32 s44, s53, 160
    s_cmp_lt_u32 s47, 88
    s_cselect_b32 s43, s43, s44
    s_mul_i32 s69, s43, 1152
    s_add_u32 s43, s51, 16
    s_add_u32 s44, s52, 8
    s_cmp_lt_u32 s47, 72
    s_cselect_b32 s43, s43, s44
    s_add_u32 s44, s53, 52
    s_cmp_lt_u32 s47, 88
    s_cselect_b32 s43, s43, s44
    s_mul_i32 s70, s43, 1152
    s_add_u32 s43, s51, 24
    s_add_u32 s44, s52, 28
    s_cmp_lt_u32 s47, 72
    s_cselect_b32 s43, s43, s44
    s_add_u32 s44, s53, 196
    s_cmp_lt_u32 s47, 88
    s_cselect_b32 s43, s43, s44
    s_mul_i32 s71, s43, 1152
    v_lshrrev_b32 v179, 2, v1
    v_lshlrev_b32 v177, 7, v179
    v_bfe_u32 v179, v1, 3, 2
    v_lshlrev_b32 v179, 5, v179
    v_and_b32 v178, 3, v1
    v_lshlrev_b32 v178, 3, v178
    v_add3_u32 v178, v179, v177, v178
    v_add_u32 v178, s50, v178
    v_xor_b32 v179, 32, v178
    v_xor_b32 v180, 64, v178
    v_xor_b32 v181, 96, v178
    s_cmp_lt_u32 s46, 810
    s_lshl_b32 s43, s46, 12
    s_add_u32 s43, s43, 47185920
    s_cmp_lt_u32 s46, 810
    s_cselect_b32 s46, s43, 0x7f000000
    s_mov_b32 s60, 71680
    s_add_u32 s61, s60, 1024
    v_add_u32 v18, s60, v13
    v_mad_u32_u24 v21, v16, s60, v14
    v_mad_u32_u24 v27, v17, s60, v15
    v_mad_u32_u24 v22, v16, s61, v14
    v_mad_u32_u24 v28, v17, s61, v15
    s_mov_b32 s60, 112896
    s_add_u32 s61, s60, 1024
    v_add_u32 v19, s60, v13
    v_mad_u32_u24 v23, v16, s60, v14
    v_mad_u32_u24 v29, v17, s60, v15
    v_mad_u32_u24 v24, v16, s61, v14
    v_mad_u32_u24 v30, v17, s61, v15
    s_mov_b32 s60, 154112
    s_add_u32 s61, s60, 1024
    v_add_u32 v20, s60, v13
    v_mad_u32_u24 v25, v16, s60, v14
    v_mad_u32_u24 v31, v17, s60, v15
    v_mad_u32_u24 v26, v16, s61, v14
    v_mad_u32_u24 v32, v17, s61, v15
    s_waitcnt lgkmcnt(0)
    s_barrier
    ds_read_b64 v[64:65], v21
    ds_read2_b64 v[56:59], v18 offset0:0 offset1:32
    ds_read_b64 v[68:69], v22
    ds_read2_b64 v[60:63], v18 offset0:128 offset1:160
    ds_read_b64_tr_b16 v[72:73], v27 offset:0
    ds_read_b64_tr_b16 v[74:75], v27 offset:64
    ds_read_b64_tr_b16 v[76:77], v27 offset:128
    ds_read_b64_tr_b16 v[78:79], v27 offset:192
    ds_read_b64_tr_b16 v[80:81], v28 offset:0
    ds_read_b64_tr_b16 v[82:83], v28 offset:64
    ds_read_b64_tr_b16 v[84:85], v28 offset:128
    ds_read_b64_tr_b16 v[86:87], v28 offset:192
    s_waitcnt lgkmcnt(8)
    v_mfma_f32_32x32x16_bf16 v[96:111], v[64:67], v[48:51], 0
    v_mfma_f32_32x32x16_bf16 v[96:111], v[56:59], v[40:43], v[96:111]
    v_mfma_f32_32x32x16_bf16 v[112:127], v[64:67], v[52:55], 0
    v_mfma_f32_32x32x16_bf16 v[112:127], v[56:59], v[44:47], v[112:127]
    s_nop 9
    v_max3_f32 v37, v96, v97, v98
    v_max3_f32 v37, v99, v100, v37
    v_max3_f32 v37, v101, v102, v37
    v_max3_f32 v37, v103, v104, v37
    v_max3_f32 v37, v105, v106, v37
    v_max3_f32 v37, v107, v108, v37
    v_max3_f32 v37, v109, v110, v37
    v_max_f32 v37, v111, v37
    v_max3_f32 v38, v112, v113, v114
    v_max3_f32 v38, v115, v116, v38
    v_max3_f32 v38, v117, v118, v38
    v_max3_f32 v38, v119, v120, v38
    v_max3_f32 v38, v121, v122, v38
    v_max3_f32 v38, v123, v124, v38
    v_max3_f32 v38, v125, v126, v38
    v_max_f32 v38, v127, v38
    v_mfma_f32_32x32x16_bf16 v[96:111], v[68:71], v[48:51], 0
    v_mfma_f32_32x32x16_bf16 v[96:111], v[60:63], v[40:43], v[96:111]
    v_mfma_f32_32x32x16_bf16 v[112:127], v[68:71], v[52:55], 0
    v_mfma_f32_32x32x16_bf16 v[112:127], v[60:63], v[44:47], v[112:127]
    s_nop 9
    v_max3_f32 v37, v96, v97, v37
    v_max3_f32 v37, v98, v99, v37
    v_max3_f32 v37, v100, v101, v37
    v_max3_f32 v37, v102, v103, v37
    v_max3_f32 v37, v104, v105, v37
    v_max3_f32 v37, v106, v107, v37
    v_max3_f32 v37, v108, v109, v37
    v_max3_f32 v37, v110, v111, v37
    v_max3_f32 v38, v112, v113, v38
    v_max3_f32 v38, v114, v115, v38
    v_max3_f32 v38, v116, v117, v38
    v_max3_f32 v38, v118, v119, v38
    v_max3_f32 v38, v120, v121, v38
    v_max3_f32 v38, v122, v123, v38
    v_max3_f32 v38, v124, v125, v38
    v_max3_f32 v38, v126, v127, v38
    v_mov_b32 v4, v37
    s_nop 1
    v_permlane32_swap_b32 v4, v37
    v_max_f32 v4, v4, v37
    v_add_f32 v4, 1119879168, v4
    v_sub_f32 v4, 0, v4
    v_cvt_pk_bf16_f32 v5, v4, v4
    v_and_b32 v5, 0xffff0000, v5
    v_sub_f32 v4, v4, v5
    v_cvt_pk_bf16_f32 v4, v5, v4
    v_cndmask_b32 v48, v48, v4, s[58:59]
    v_mov_b32 v4, v38
    s_nop 1
    v_permlane32_swap_b32 v4, v38
    v_max_f32 v4, v4, v38
    v_add_f32 v4, 1119879168, v4
    v_sub_f32 v4, 0, v4
    v_cvt_pk_bf16_f32 v5, v4, v4
    v_and_b32 v5, 0xffff0000, v5
    v_sub_f32 v4, v4, v5
    v_cvt_pk_bf16_f32 v4, v5, v4
    v_cndmask_b32 v52, v52, v4, s[58:59]
    s_waitcnt lgkmcnt(0)
    v_mfma_f32_32x32x16_bf16 v[96:111], v[64:67], v[48:51], 0
    v_mfma_f32_32x32x16_bf16 v[96:111], v[56:59], v[40:43], v[96:111]
    s_waitcnt lgkmcnt(0)
    v_mfma_f32_32x32x16_bf16 v[112:127], v[64:67], v[52:55], 0
    s_nop 9
    v_exp_f32 v96, v96
    v_exp_f32 v97, v97
    v_exp_f32 v98, v98
    v_exp_f32 v99, v99
    v_cvt_pk_bf16_f32 v88, v96, v97
    v_cvt_pk_bf16_f32 v89, v98, v99
    v_exp_f32 v100, v100
    v_exp_f32 v101, v101
    v_exp_f32 v102, v102
    v_exp_f32 v103, v103
    v_cvt_pk_bf16_f32 v90, v100, v101
    v_cvt_pk_bf16_f32 v91, v102, v103
    v_mfma_f32_32x32x16_bf16 v[112:127], v[56:59], v[44:47], v[112:127]
    v_exp_f32 v104, v104
    v_exp_f32 v105, v105
    v_exp_f32 v106, v106
    v_exp_f32 v107, v107
    v_cvt_pk_bf16_f32 v92, v104, v105
    v_cvt_pk_bf16_f32 v93, v106, v107
    v_mfma_f32_32x32x16_bf16 v[128:143], v[72:75], v[88:91], 0
    v_exp_f32 v108, v108
    v_exp_f32 v109, v109
    v_exp_f32 v110, v110
    v_exp_f32 v111, v111
    v_cvt_pk_bf16_f32 v94, v108, v109
    v_cvt_pk_bf16_f32 v95, v110, v111
    v_mfma_f32_32x32x16_bf16 v[96:111], v[68:71], v[48:51], 0
    v_exp_f32 v112, v112
    v_exp_f32 v113, v113
    v_exp_f32 v114, v114
    v_exp_f32 v115, v115
    v_cvt_pk_bf16_f32 v88, v112, v113
    v_cvt_pk_bf16_f32 v89, v114, v115
    v_mfma_f32_32x32x16_bf16 v[128:143], v[76:79], v[92:95], v[128:143]
    v_exp_f32 v116, v116
    v_exp_f32 v117, v117
    v_exp_f32 v118, v118
    v_exp_f32 v119, v119
    v_cvt_pk_bf16_f32 v90, v116, v117
    v_cvt_pk_bf16_f32 v91, v118, v119
    v_mfma_f32_32x32x16_bf16 v[96:111], v[60:63], v[40:43], v[96:111]
    v_exp_f32 v120, v120
    v_exp_f32 v121, v121
    v_exp_f32 v122, v122
    v_exp_f32 v123, v123
    v_cvt_pk_bf16_f32 v92, v120, v121
    v_cvt_pk_bf16_f32 v93, v122, v123
    v_mfma_f32_32x32x16_bf16 v[144:159], v[72:75], v[88:91], 0
    v_exp_f32 v124, v124
    v_exp_f32 v125, v125
    v_exp_f32 v126, v126
    v_exp_f32 v127, v127
    v_cvt_pk_bf16_f32 v94, v124, v125
    v_cvt_pk_bf16_f32 v95, v126, v127
    s_waitcnt vmcnt(0)
    s_barrier
    v_mfma_f32_32x32x16_bf16 v[112:127], v[68:71], v[52:55], 0
    ds_read_b64 v[64:65], v23
    ds_read2_b64 v[56:59], v19 offset0:0 offset1:32
    v_exp_f32 v96, v96
    v_exp_f32 v97, v97
    v_exp_f32 v98, v98
    v_exp_f32 v99, v99
    v_cvt_pk_bf16_f32 v88, v96, v97
    v_cvt_pk_bf16_f32 v89, v98, v99
    v_mfma_f32_32x32x16_bf16 v[144:159], v[76:79], v[92:95], v[144:159]
    ds_read_b64_tr_b16 v[76:77], v29 offset:128
    ds_read_b64_tr_b16 v[78:79], v29 offset:192
    v_exp_f32 v100, v100
    v_exp_f32 v101, v101
    v_exp_f32 v102, v102
    v_exp_f32 v103, v103
    v_cvt_pk_bf16_f32 v90, v100, v101
    v_cvt_pk_bf16_f32 v91, v102, v103
    v_mfma_f32_32x32x16_bf16 v[112:127], v[60:63], v[44:47], v[112:127]
    ds_read_b64_tr_b16 v[72:73], v29 offset:0
    ds_read_b64_tr_b16 v[74:75], v29 offset:64
    v_exp_f32 v104, v104
    v_exp_f32 v105, v105
    v_exp_f32 v106, v106
    v_exp_f32 v107, v107
    v_cvt_pk_bf16_f32 v92, v104, v105
    v_cvt_pk_bf16_f32 v93, v106, v107
    v_mfma_f32_32x32x16_bf16 v[128:143], v[80:83], v[88:91], v[128:143]
    s_add_u32 m0, s50, 0
    s_nop 0
    buffer_load_dwordx4 v176, s[4:7], s68 offen lds
    v_exp_f32 v108, v108
    v_exp_f32 v109, v109
    v_exp_f32 v110, v110
    v_exp_f32 v111, v111
    v_cvt_pk_bf16_f32 v94, v108, v109
    v_cvt_pk_bf16_f32 v95, v110, v111
    s_waitcnt lgkmcnt(0)
    v_mfma_f32_32x32x16_bf16 v[96:111], v[64:67], v[48:51], 0
    ds_read_b64 v[68:69], v24
    ds_read2_b64 v[60:63], v19 offset0:128 offset1:160
    v_exp_f32 v112, v112
    v_exp_f32 v113, v113
    v_exp_f32 v114, v114
    v_exp_f32 v115, v115
    v_cvt_pk_bf16_f32 v88, v112, v113
    v_cvt_pk_bf16_f32 v89, v114, v115
    v_mfma_f32_32x32x16_bf16 v[128:143], v[84:87], v[92:95], v[128:143]
    v_exp_f32 v116, v116
    v_exp_f32 v117, v117
    v_exp_f32 v118, v118
    v_exp_f32 v119, v119
    v_cvt_pk_bf16_f32 v90, v116, v117
    v_cvt_pk_bf16_f32 v91, v118, v119
    v_mfma_f32_32x32x16_bf16 v[96:111], v[56:59], v[40:43], v[96:111]
    s_add_u32 m0, s50, 1024
    s_nop 0
    buffer_load_dwordx4 v176, s[4:7], s69 offen lds
    v_exp_f32 v120, v120
    v_exp_f32 v121, v121
    v_exp_f32 v122, v122
    v_exp_f32 v123, v123
    v_cvt_pk_bf16_f32 v92, v120, v121
    v_cvt_pk_bf16_f32 v93, v122, v123
    v_mfma_f32_32x32x16_bf16 v[144:159], v[80:83], v[88:91], v[144:159]
    v_exp_f32 v124, v124
    v_exp_f32 v125, v125
    v_exp_f32 v126, v126
    v_exp_f32 v127, v127
    v_cvt_pk_bf16_f32 v94, v124, v125
    v_cvt_pk_bf16_f32 v95, v126, v127
    v_mfma_f32_32x32x16_bf16 v[112:127], v[64:67], v[52:55], 0
    ds_read_b64_tr_b16 v[80:81], v30 offset:0
    ds_read_b64_tr_b16 v[82:83], v30 offset:64
    v_exp_f32 v96, v96
    v_exp_f32 v97, v97
    v_exp_f32 v98, v98
    v_exp_f32 v99, v99
    v_cvt_pk_bf16_f32 v88, v96, v97
    v_cvt_pk_bf16_f32 v89, v98, v99
    v_mfma_f32_32x32x16_bf16 v[144:159], v[84:87], v[92:95], v[144:159]
    ds_read_b64_tr_b16 v[84:85], v30 offset:128
    ds_read_b64_tr_b16 v[86:87], v30 offset:192
    v_exp_f32 v100, v100
    v_exp_f32 v101, v101
    v_exp_f32 v102, v102
    v_exp_f32 v103, v103
    v_cvt_pk_bf16_f32 v90, v100, v101
    v_cvt_pk_bf16_f32 v91, v102, v103
    v_mfma_f32_32x32x16_bf16 v[112:127], v[56:59], v[44:47], v[112:127]
    v_exp_f32 v104, v104
    v_exp_f32 v105, v105
    v_exp_f32 v106, v106
    v_exp_f32 v107, v107
    v_cvt_pk_bf16_f32 v92, v104, v105
    v_cvt_pk_bf16_f32 v93, v106, v107
    v_mfma_f32_32x32x16_bf16 v[128:143], v[72:75], v[88:91], v[128:143]
    s_add_u32 m0, s50, 2048
    s_nop 0
    buffer_load_dwordx4 v176, s[4:7], s70 offen lds
    v_exp_f32 v108, v108
    v_exp_f32 v109, v109
    v_exp_f32 v110, v110
    v_exp_f32 v111, v111
    v_cvt_pk_bf16_f32 v94, v108, v109
    v_cvt_pk_bf16_f32 v95, v110, v111
    s_waitcnt lgkmcnt(0)
    v_mfma_f32_32x32x16_bf16 v[96:111], v[68:71], v[48:51], 0
    v_exp_f32 v112, v112
    v_exp_f32 v113, v113
    v_exp_f32 v114, v114
    v_exp_f32 v115, v115
    v_cvt_pk_bf16_f32 v88, v112, v113
    v_cvt_pk_bf16_f32 v89, v114, v115
    v_mfma_f32_32x32x16_bf16 v[128:143], v[76:79], v[92:95], v[128:143]
    v_exp_f32 v116, v116
    v_exp_f32 v117, v117
    v_exp_f32 v118, v118
    v_exp_f32 v119, v119
    v_cvt_pk_bf16_f32 v90, v116, v117
    v_cvt_pk_bf16_f32 v91, v118, v119
    v_mfma_f32_32x32x16_bf16 v[96:111], v[60:63], v[40:43], v[96:111]
    s_add_u32 m0, s50, 3072
    s_nop 0
    buffer_load_dwordx4 v176, s[4:7], s71 offen lds
    v_exp_f32 v120, v120
    v_exp_f32 v121, v121
    v_exp_f32 v122, v122
    v_exp_f32 v123, v123
    v_cvt_pk_bf16_f32 v92, v120, v121
    v_cvt_pk_bf16_f32 v93, v122, v123
    v_mfma_f32_32x32x16_bf16 v[144:159], v[72:75], v[88:91], v[144:159]
    v_exp_f32 v124, v124
    v_exp_f32 v125, v125
    v_exp_f32 v126, v126
    v_exp_f32 v127, v127
    v_cvt_pk_bf16_f32 v94, v124, v125
    v_cvt_pk_bf16_f32 v95, v126, v127
    s_barrier
    s_mov_b32 s48, 9
.p2align 6
L2a_loop:
    v_mfma_f32_32x32x16_bf16 v[112:127], v[68:71], v[52:55], 0
    ds_read_b64 v[64:65], v25
    ds_read2_b64 v[56:59], v20 offset0:0 offset1:32
    v_exp_f32 v96, v96
    v_exp_f32 v97, v97
    v_exp_f32 v98, v98
    v_exp_f32 v99, v99
    v_cvt_pk_bf16_f32 v88, v96, v97
    v_cvt_pk_bf16_f32 v89, v98, v99
    v_mfma_f32_32x32x16_bf16 v[144:159], v[76:79], v[92:95], v[144:159]
    ds_read_b64_tr_b16 v[76:77], v31 offset:128
    ds_read_b64_tr_b16 v[78:79], v31 offset:192
    v_exp_f32 v100, v100
    v_exp_f32 v101, v101
    v_exp_f32 v102, v102
    v_exp_f32 v103, v103
    v_cvt_pk_bf16_f32 v90, v100, v101
    v_cvt_pk_bf16_f32 v91, v102, v103
    v_mfma_f32_32x32x16_bf16 v[112:127], v[60:63], v[44:47], v[112:127]
    ds_read_b64_tr_b16 v[72:73], v31 offset:0
    ds_read_b64_tr_b16 v[74:75], v31 offset:64
    v_exp_f32 v104, v104
    v_exp_f32 v105, v105
    v_exp_f32 v106, v106
    v_exp_f32 v107, v107
    v_cvt_pk_bf16_f32 v92, v104, v105
    v_cvt_pk_bf16_f32 v93, v106, v107
    v_mfma_f32_32x32x16_bf16 v[128:143], v[80:83], v[88:91], v[128:143]
    v_exp_f32 v108, v108
    v_exp_f32 v109, v109
    v_exp_f32 v110, v110
    v_exp_f32 v111, v111
    v_cvt_pk_bf16_f32 v94, v108, v109
    v_cvt_pk_bf16_f32 v95, v110, v111
    s_waitcnt lgkmcnt(0)
    v_mfma_f32_32x32x16_bf16 v[96:111], v[64:67], v[48:51], 0
    ds_read_b64 v[68:69], v26
    ds_read2_b64 v[60:63], v20 offset0:128 offset1:160
    v_exp_f32 v112, v112
    v_exp_f32 v113, v113
    v_exp_f32 v114, v114
    v_exp_f32 v115, v115
    v_cvt_pk_bf16_f32 v88, v112, v113
    v_cvt_pk_bf16_f32 v89, v114, v115
    v_mfma_f32_32x32x16_bf16 v[128:143], v[84:87], v[92:95], v[128:143]
    v_exp_f32 v116, v116
    v_exp_f32 v117, v117
    v_exp_f32 v118, v118
    v_exp_f32 v119, v119
    v_cvt_pk_bf16_f32 v90, v116, v117
    v_cvt_pk_bf16_f32 v91, v118, v119
    v_mfma_f32_32x32x16_bf16 v[96:111], v[56:59], v[40:43], v[96:111]
    v_exp_f32 v120, v120
    v_exp_f32 v121, v121
    v_exp_f32 v122, v122
    v_exp_f32 v123, v123
    v_cvt_pk_bf16_f32 v92, v120, v121
    v_cvt_pk_bf16_f32 v93, v122, v123
    v_mfma_f32_32x32x16_bf16 v[144:159], v[80:83], v[88:91], v[144:159]
    v_exp_f32 v124, v124
    v_exp_f32 v125, v125
    v_exp_f32 v126, v126
    v_exp_f32 v127, v127
    v_cvt_pk_bf16_f32 v94, v124, v125
    v_cvt_pk_bf16_f32 v95, v126, v127
    v_mfma_f32_32x32x16_bf16 v[112:127], v[64:67], v[52:55], 0
    ds_read_b64_tr_b16 v[80:81], v32 offset:0
    ds_read_b64_tr_b16 v[82:83], v32 offset:64
    v_exp_f32 v96, v96
    v_exp_f32 v97, v97
    v_exp_f32 v98, v98
    v_exp_f32 v99, v99
    v_cvt_pk_bf16_f32 v88, v96, v97
    v_cvt_pk_bf16_f32 v89, v98, v99
    v_mfma_f32_32x32x16_bf16 v[144:159], v[84:87], v[92:95], v[144:159]
    ds_read_b64_tr_b16 v[84:85], v32 offset:128
    ds_read_b64_tr_b16 v[86:87], v32 offset:192
    v_exp_f32 v100, v100
    v_exp_f32 v101, v101
    v_exp_f32 v102, v102
    v_exp_f32 v103, v103
    v_cvt_pk_bf16_f32 v90, v100, v101
    v_cvt_pk_bf16_f32 v91, v102, v103
    v_mfma_f32_32x32x16_bf16 v[112:127], v[56:59], v[44:47], v[112:127]
    v_exp_f32 v104, v104
    v_exp_f32 v105, v105
    v_exp_f32 v106, v106
    v_exp_f32 v107, v107
    v_cvt_pk_bf16_f32 v92, v104, v105
    v_cvt_pk_bf16_f32 v93, v106, v107
    v_mfma_f32_32x32x16_bf16 v[128:143], v[72:75], v[88:91], v[128:143]
    v_exp_f32 v108, v108
    v_exp_f32 v109, v109
    v_exp_f32 v110, v110
    v_exp_f32 v111, v111
    v_cvt_pk_bf16_f32 v94, v108, v109
    v_cvt_pk_bf16_f32 v95, v110, v111
    s_waitcnt lgkmcnt(0)
    v_mfma_f32_32x32x16_bf16 v[96:111], v[68:71], v[48:51], 0
    v_exp_f32 v112, v112
    v_exp_f32 v113, v113
    v_exp_f32 v114, v114
    v_exp_f32 v115, v115
    v_cvt_pk_bf16_f32 v88, v112, v113
    v_cvt_pk_bf16_f32 v89, v114, v115
    v_mfma_f32_32x32x16_bf16 v[128:143], v[76:79], v[92:95], v[128:143]
    v_exp_f32 v116, v116
    v_exp_f32 v117, v117
    v_exp_f32 v118, v118
    v_exp_f32 v119, v119
    v_cvt_pk_bf16_f32 v90, v116, v117
    v_cvt_pk_bf16_f32 v91, v118, v119
    v_mfma_f32_32x32x16_bf16 v[96:111], v[60:63], v[40:43], v[96:111]
    v_exp_f32 v120, v120
    v_exp_f32 v121, v121
    v_exp_f32 v122, v122
    v_exp_f32 v123, v123
    v_cvt_pk_bf16_f32 v92, v120, v121
    v_cvt_pk_bf16_f32 v93, v122, v123
    v_mfma_f32_32x32x16_bf16 v[144:159], v[72:75], v[88:91], v[144:159]
    v_exp_f32 v124, v124
    v_exp_f32 v125, v125
    v_exp_f32 v126, v126
    v_exp_f32 v127, v127
    v_cvt_pk_bf16_f32 v94, v124, v125
    v_cvt_pk_bf16_f32 v95, v126, v127
    s_barrier
    v_mfma_f32_32x32x16_bf16 v[112:127], v[68:71], v[52:55], 0
    ds_read_b64 v[64:65], v21
    ds_read2_b64 v[56:59], v18 offset0:0 offset1:32
    v_exp_f32 v96, v96
    v_exp_f32 v97, v97
    v_exp_f32 v98, v98
    v_exp_f32 v99, v99
    v_cvt_pk_bf16_f32 v88, v96, v97
    v_cvt_pk_bf16_f32 v89, v98, v99
    v_mfma_f32_32x32x16_bf16 v[144:159], v[76:79], v[92:95], v[144:159]
    ds_read_b64_tr_b16 v[76:77], v27 offset:128
    ds_read_b64_tr_b16 v[78:79], v27 offset:192
    v_exp_f32 v100, v100
    v_exp_f32 v101, v101
    v_exp_f32 v102, v102
    v_exp_f32 v103, v103
    v_cvt_pk_bf16_f32 v90, v100, v101
    v_cvt_pk_bf16_f32 v91, v102, v103
    v_mfma_f32_32x32x16_bf16 v[112:127], v[60:63], v[44:47], v[112:127]
    ds_read_b64_tr_b16 v[72:73], v27 offset:0
    ds_read_b64_tr_b16 v[74:75], v27 offset:64
    v_exp_f32 v104, v104
    v_exp_f32 v105, v105
    v_exp_f32 v106, v106
    v_exp_f32 v107, v107
    v_cvt_pk_bf16_f32 v92, v104, v105
    v_cvt_pk_bf16_f32 v93, v106, v107
    v_mfma_f32_32x32x16_bf16 v[128:143], v[80:83], v[88:91], v[128:143]
    v_exp_f32 v108, v108
    v_exp_f32 v109, v109
    v_exp_f32 v110, v110
    v_exp_f32 v111, v111
    v_cvt_pk_bf16_f32 v94, v108, v109
    v_cvt_pk_bf16_f32 v95, v110, v111
    s_waitcnt lgkmcnt(0)
    v_mfma_f32_32x32x16_bf16 v[96:111], v[64:67], v[48:51], 0
    ds_read_b64 v[68:69], v22
    ds_read2_b64 v[60:63], v18 offset0:128 offset1:160
    v_exp_f32 v112, v112
    v_exp_f32 v113, v113
    v_exp_f32 v114, v114
    v_exp_f32 v115, v115
    v_cvt_pk_bf16_f32 v88, v112, v113
    v_cvt_pk_bf16_f32 v89, v114, v115
    v_mfma_f32_32x32x16_bf16 v[128:143], v[84:87], v[92:95], v[128:143]
    v_exp_f32 v116, v116
    v_exp_f32 v117, v117
    v_exp_f32 v118, v118
    v_exp_f32 v119, v119
    v_cvt_pk_bf16_f32 v90, v116, v117
    v_cvt_pk_bf16_f32 v91, v118, v119
    v_mfma_f32_32x32x16_bf16 v[96:111], v[56:59], v[40:43], v[96:111]
    v_exp_f32 v120, v120
    v_exp_f32 v121, v121
    v_exp_f32 v122, v122
    v_exp_f32 v123, v123
    v_cvt_pk_bf16_f32 v92, v120, v121
    v_cvt_pk_bf16_f32 v93, v122, v123
    v_mfma_f32_32x32x16_bf16 v[144:159], v[80:83], v[88:91], v[144:159]
    v_exp_f32 v124, v124
    v_exp_f32 v125, v125
    v_exp_f32 v126, v126
    v_exp_f32 v127, v127
    v_cvt_pk_bf16_f32 v94, v124, v125
    v_cvt_pk_bf16_f32 v95, v126, v127
    v_mfma_f32_32x32x16_bf16 v[112:127], v[64:67], v[52:55], 0
    ds_read_b64_tr_b16 v[80:81], v28 offset:0
    ds_read_b64_tr_b16 v[82:83], v28 offset:64
    v_exp_f32 v96, v96
    v_exp_f32 v97, v97
    v_exp_f32 v98, v98
    v_exp_f32 v99, v99
    v_cvt_pk_bf16_f32 v88, v96, v97
    v_cvt_pk_bf16_f32 v89, v98, v99
    v_mfma_f32_32x32x16_bf16 v[144:159], v[84:87], v[92:95], v[144:159]
    ds_read_b64_tr_b16 v[84:85], v28 offset:128
    ds_read_b64_tr_b16 v[86:87], v28 offset:192
    v_exp_f32 v100, v100
    v_exp_f32 v101, v101
    v_exp_f32 v102, v102
    v_exp_f32 v103, v103
    v_cvt_pk_bf16_f32 v90, v100, v101
    v_cvt_pk_bf16_f32 v91, v102, v103
    v_mfma_f32_32x32x16_bf16 v[112:127], v[56:59], v[44:47], v[112:127]
    v_exp_f32 v104, v104
    v_exp_f32 v105, v105
    v_exp_f32 v106, v106
    v_exp_f32 v107, v107
    v_cvt_pk_bf16_f32 v92, v104, v105
    v_cvt_pk_bf16_f32 v93, v106, v107
    v_mfma_f32_32x32x16_bf16 v[128:143], v[72:75], v[88:91], v[128:143]
    v_exp_f32 v108, v108
    v_exp_f32 v109, v109
    v_exp_f32 v110, v110
    v_exp_f32 v111, v111
    v_cvt_pk_bf16_f32 v94, v108, v109
    v_cvt_pk_bf16_f32 v95, v110, v111
    s_waitcnt lgkmcnt(0)
    v_mfma_f32_32x32x16_bf16 v[96:111], v[68:71], v[48:51], 0
    v_exp_f32 v112, v112
    v_exp_f32 v113, v113
    v_exp_f32 v114, v114
    v_exp_f32 v115, v115
    v_cvt_pk_bf16_f32 v88, v112, v113
    v_cvt_pk_bf16_f32 v89, v114, v115
    v_mfma_f32_32x32x16_bf16 v[128:143], v[76:79], v[92:95], v[128:143]
    v_exp_f32 v116, v116
    v_exp_f32 v117, v117
    v_exp_f32 v118, v118
    v_exp_f32 v119, v119
    v_cvt_pk_bf16_f32 v90, v116, v117
    v_cvt_pk_bf16_f32 v91, v118, v119
    v_mfma_f32_32x32x16_bf16 v[96:111], v[60:63], v[40:43], v[96:111]
    v_exp_f32 v120, v120
    v_exp_f32 v121, v121
    v_exp_f32 v122, v122
    v_exp_f32 v123, v123
    v_cvt_pk_bf16_f32 v92, v120, v121
    v_cvt_pk_bf16_f32 v93, v122, v123
    v_mfma_f32_32x32x16_bf16 v[144:159], v[72:75], v[88:91], v[144:159]
    v_exp_f32 v124, v124
    v_exp_f32 v125, v125
    v_exp_f32 v126, v126
    v_exp_f32 v127, v127
    v_cvt_pk_bf16_f32 v94, v124, v125
    v_cvt_pk_bf16_f32 v95, v126, v127
    s_barrier
    v_mfma_f32_32x32x16_bf16 v[112:127], v[68:71], v[52:55], 0
    ds_read_b64 v[64:65], v23
    ds_read2_b64 v[56:59], v19 offset0:0 offset1:32
    v_exp_f32 v96, v96
    v_exp_f32 v97, v97
    v_exp_f32 v98, v98
    v_exp_f32 v99, v99
    v_cvt_pk_bf16_f32 v88, v96, v97
    v_cvt_pk_bf16_f32 v89, v98, v99
    v_mfma_f32_32x32x16_bf16 v[144:159], v[76:79], v[92:95], v[144:159]
    ds_read_b64_tr_b16 v[76:77], v29 offset:128
    ds_read_b64_tr_b16 v[78:79], v29 offset:192
    v_exp_f32 v100, v100
    v_exp_f32 v101, v101
    v_exp_f32 v102, v102
    v_exp_f32 v103, v103
    v_cvt_pk_bf16_f32 v90, v100, v101
    v_cvt_pk_bf16_f32 v91, v102, v103
    v_mfma_f32_32x32x16_bf16 v[112:127], v[60:63], v[44:47], v[112:127]
    ds_read_b64_tr_b16 v[72:73], v29 offset:0
    ds_read_b64_tr_b16 v[74:75], v29 offset:64
    v_exp_f32 v104, v104
    v_exp_f32 v105, v105
    v_exp_f32 v106, v106
    v_exp_f32 v107, v107
    v_cvt_pk_bf16_f32 v92, v104, v105
    v_cvt_pk_bf16_f32 v93, v106, v107
    v_mfma_f32_32x32x16_bf16 v[128:143], v[80:83], v[88:91], v[128:143]
    v_exp_f32 v108, v108
    v_exp_f32 v109, v109
    v_exp_f32 v110, v110
    v_exp_f32 v111, v111
    v_cvt_pk_bf16_f32 v94, v108, v109
    v_cvt_pk_bf16_f32 v95, v110, v111
    s_waitcnt lgkmcnt(0)
    v_mfma_f32_32x32x16_bf16 v[96:111], v[64:67], v[48:51], 0
    ds_read_b64 v[68:69], v24
    ds_read2_b64 v[60:63], v19 offset0:128 offset1:160
    v_exp_f32 v112, v112
    v_exp_f32 v113, v113
    v_exp_f32 v114, v114
    v_exp_f32 v115, v115
    v_cvt_pk_bf16_f32 v88, v112, v113
    v_cvt_pk_bf16_f32 v89, v114, v115
    v_mfma_f32_32x32x16_bf16 v[128:143], v[84:87], v[92:95], v[128:143]
    v_exp_f32 v116, v116
    v_exp_f32 v117, v117
    v_exp_f32 v118, v118
    v_exp_f32 v119, v119
    v_cvt_pk_bf16_f32 v90, v116, v117
    v_cvt_pk_bf16_f32 v91, v118, v119
    v_mfma_f32_32x32x16_bf16 v[96:111], v[56:59], v[40:43], v[96:111]
    v_exp_f32 v120, v120
    v_exp_f32 v121, v121
    v_exp_f32 v122, v122
    v_exp_f32 v123, v123
    v_cvt_pk_bf16_f32 v92, v120, v121
    v_cvt_pk_bf16_f32 v93, v122, v123
    v_mfma_f32_32x32x16_bf16 v[144:159], v[80:83], v[88:91], v[144:159]
    v_exp_f32 v124, v124
    v_exp_f32 v125, v125
    v_exp_f32 v126, v126
    v_exp_f32 v127, v127
    v_cvt_pk_bf16_f32 v94, v124, v125
    v_cvt_pk_bf16_f32 v95, v126, v127
    v_mfma_f32_32x32x16_bf16 v[112:127], v[64:67], v[52:55], 0
    ds_read_b64_tr_b16 v[80:81], v30 offset:0
    ds_read_b64_tr_b16 v[82:83], v30 offset:64
    v_exp_f32 v96, v96
    v_exp_f32 v97, v97
    v_exp_f32 v98, v98
    v_exp_f32 v99, v99
    v_cvt_pk_bf16_f32 v88, v96, v97
    v_cvt_pk_bf16_f32 v89, v98, v99
    v_mfma_f32_32x32x16_bf16 v[144:159], v[84:87], v[92:95], v[144:159]
    ds_read_b64_tr_b16 v[84:85], v30 offset:128
    ds_read_b64_tr_b16 v[86:87], v30 offset:192
    v_exp_f32 v100, v100
    v_exp_f32 v101, v101
    v_exp_f32 v102, v102
    v_exp_f32 v103, v103
    v_cvt_pk_bf16_f32 v90, v100, v101
    v_cvt_pk_bf16_f32 v91, v102, v103
    v_mfma_f32_32x32x16_bf16 v[112:127], v[56:59], v[44:47], v[112:127]
    v_exp_f32 v104, v104
    v_exp_f32 v105, v105
    v_exp_f32 v106, v106
    v_exp_f32 v107, v107
    v_cvt_pk_bf16_f32 v92, v104, v105
    v_cvt_pk_bf16_f32 v93, v106, v107
    v_mfma_f32_32x32x16_bf16 v[128:143], v[72:75], v[88:91], v[128:143]
    v_exp_f32 v108, v108
    v_exp_f32 v109, v109
    v_exp_f32 v110, v110
    v_exp_f32 v111, v111
    v_cvt_pk_bf16_f32 v94, v108, v109
    v_cvt_pk_bf16_f32 v95, v110, v111
    s_waitcnt lgkmcnt(0)
    v_mfma_f32_32x32x16_bf16 v[96:111], v[68:71], v[48:51], 0
    v_exp_f32 v112, v112
    v_exp_f32 v113, v113
    v_exp_f32 v114, v114
    v_exp_f32 v115, v115
    v_cvt_pk_bf16_f32 v88, v112, v113
    v_cvt_pk_bf16_f32 v89, v114, v115
    v_mfma_f32_32x32x16_bf16 v[128:143], v[76:79], v[92:95], v[128:143]
    v_exp_f32 v116, v116
    v_exp_f32 v117, v117
    v_exp_f32 v118, v118
    v_exp_f32 v119, v119
    v_cvt_pk_bf16_f32 v90, v116, v117
    v_cvt_pk_bf16_f32 v91, v118, v119
    v_mfma_f32_32x32x16_bf16 v[96:111], v[60:63], v[40:43], v[96:111]
    v_exp_f32 v120, v120
    v_exp_f32 v121, v121
    v_exp_f32 v122, v122
    v_exp_f32 v123, v123
    v_cvt_pk_bf16_f32 v92, v120, v121
    v_cvt_pk_bf16_f32 v93, v122, v123
    v_mfma_f32_32x32x16_bf16 v[144:159], v[72:75], v[88:91], v[144:159]
    v_exp_f32 v124, v124
    v_exp_f32 v125, v125
    v_exp_f32 v126, v126
    v_exp_f32 v127, v127
    v_cvt_pk_bf16_f32 v94, v124, v125
    v_cvt_pk_bf16_f32 v95, v126, v127
    s_barrier
    s_sub_u32 s48, s48, 1
    s_cmp_lg_u32 s48, 0
    s_cbranch_scc1 L2a_loop
    v_mfma_f32_32x32x16_bf16 v[112:127], v[68:71], v[52:55], 0
    ds_read_b64 v[64:65], v25
    ds_read2_b64 v[56:59], v20 offset0:0 offset1:32
    v_exp_f32 v96, v96
    v_exp_f32 v97, v97
    v_exp_f32 v98, v98
    v_exp_f32 v99, v99
    v_cvt_pk_bf16_f32 v88, v96, v97
    v_cvt_pk_bf16_f32 v89, v98, v99
    v_mfma_f32_32x32x16_bf16 v[144:159], v[76:79], v[92:95], v[144:159]
    ds_read_b64_tr_b16 v[76:77], v31 offset:128
    ds_read_b64_tr_b16 v[78:79], v31 offset:192
    v_exp_f32 v100, v100
    v_exp_f32 v101, v101
    v_exp_f32 v102, v102
    v_exp_f32 v103, v103
    v_cvt_pk_bf16_f32 v90, v100, v101
    v_cvt_pk_bf16_f32 v91, v102, v103
    v_mfma_f32_32x32x16_bf16 v[112:127], v[60:63], v[44:47], v[112:127]
    ds_read_b64_tr_b16 v[72:73], v31 offset:0
    ds_read_b64_tr_b16 v[74:75], v31 offset:64
    v_exp_f32 v104, v104
    v_exp_f32 v105, v105
    v_exp_f32 v106, v106
    v_exp_f32 v107, v107
    v_cvt_pk_bf16_f32 v92, v104, v105
    v_cvt_pk_bf16_f32 v93, v106, v107
    v_mfma_f32_32x32x16_bf16 v[128:143], v[80:83], v[88:91], v[128:143]
    v_exp_f32 v108, v108
    v_exp_f32 v109, v109
    v_exp_f32 v110, v110
    v_exp_f32 v111, v111
    v_cvt_pk_bf16_f32 v94, v108, v109
    v_cvt_pk_bf16_f32 v95, v110, v111
    s_waitcnt lgkmcnt(0)
    v_mfma_f32_32x32x16_bf16 v[96:111], v[64:67], v[48:51], 0
    s_waitcnt vmcnt(0)
    ds_read_b64 v[68:69], v26
    ds_read2_b64 v[60:63], v20 offset0:128 offset1:160
    ds_read_b64_tr_b16 v[160:161], v178 offset:0
    ds_read_b64_tr_b16 v[162:163], v178 offset:2048
    v_exp_f32 v112, v112
    v_exp_f32 v113, v113
    v_exp_f32 v114, v114
    v_exp_f32 v115, v115
    v_cvt_pk_bf16_f32 v88, v112, v113
    v_cvt_pk_bf16_f32 v89, v114, v115
    v_mfma_f32_32x32x16_bf16 v[128:143], v[84:87], v[92:95], v[128:143]
    ds_read_b64_tr_b16 v[164:165], v179 offset:0
    ds_read_b64_tr_b16 v[166:167], v179 offset:2048
    v_exp_f32 v116, v116
    v_exp_f32 v117, v117
    v_exp_f32 v118, v118
    v_exp_f32 v119, v119
    v_cvt_pk_bf16_f32 v90, v116, v117
    v_cvt_pk_bf16_f32 v91, v118, v119
    v_mfma_f32_32x32x16_bf16 v[96:111], v[56:59], v[40:43], v[96:111]
    ds_read_b64_tr_b16 v[168:169], v180 offset:0
    ds_read_b64_tr_b16 v[170:171], v180 offset:2048
    v_exp_f32 v120, v120
    v_exp_f32 v121, v121
    v_exp_f32 v122, v122
    v_exp_f32 v123, v123
    v_cvt_pk_bf16_f32 v92, v120, v121
    v_cvt_pk_bf16_f32 v93, v122, v123
    v_mfma_f32_32x32x16_bf16 v[144:159], v[80:83], v[88:91], v[144:159]
    ds_read_b64_tr_b16 v[172:173], v181 offset:0
    ds_read_b64_tr_b16 v[174:175], v181 offset:2048
    v_exp_f32 v124, v124
    v_exp_f32 v125, v125
    v_exp_f32 v126, v126
    v_exp_f32 v127, v127
    v_cvt_pk_bf16_f32 v94, v124, v125
    v_cvt_pk_bf16_f32 v95, v126, v127
    v_mfma_f32_32x32x16_bf16 v[112:127], v[64:67], v[52:55], 0
    ds_read_b64_tr_b16 v[80:81], v32 offset:0
    ds_read_b64_tr_b16 v[82:83], v32 offset:64
    v_exp_f32 v96, v96
    v_exp_f32 v97, v97
    v_exp_f32 v98, v98
    v_exp_f32 v99, v99
    v_cvt_pk_bf16_f32 v88, v96, v97
    v_cvt_pk_bf16_f32 v89, v98, v99
    v_mfma_f32_32x32x16_bf16 v[144:159], v[84:87], v[92:95], v[144:159]
    ds_read_b64_tr_b16 v[84:85], v32 offset:128
    ds_read_b64_tr_b16 v[86:87], v32 offset:192
    v_exp_f32 v100, v100
    v_exp_f32 v101, v101
    v_exp_f32 v102, v102
    v_exp_f32 v103, v103
    v_cvt_pk_bf16_f32 v90, v100, v101
    v_cvt_pk_bf16_f32 v91, v102, v103
    v_mfma_f32_32x32x16_bf16 v[112:127], v[56:59], v[44:47], v[112:127]
    v_exp_f32 v104, v104
    v_exp_f32 v105, v105
    v_exp_f32 v106, v106
    v_exp_f32 v107, v107
    v_cvt_pk_bf16_f32 v92, v104, v105
    v_cvt_pk_bf16_f32 v93, v106, v107
    v_mfma_f32_32x32x16_bf16 v[128:143], v[72:75], v[88:91], v[128:143]
    v_exp_f32 v108, v108
    v_exp_f32 v109, v109
    v_exp_f32 v110, v110
    v_exp_f32 v111, v111
    v_cvt_pk_bf16_f32 v94, v108, v109
    v_cvt_pk_bf16_f32 v95, v110, v111
    s_waitcnt lgkmcnt(0)
    v_mfma_f32_32x32x16_bf16 v[96:111], v[68:71], v[48:51], 0
    buffer_store_dwordx4 v[160:163], v12, s[8:11], s46 offen offset:0
    v_exp_f32 v112, v112
    v_exp_f32 v113, v113
    v_exp_f32 v114, v114
    v_exp_f32 v115, v115
    v_cvt_pk_bf16_f32 v88, v112, v113
    v_cvt_pk_bf16_f32 v89, v114, v115
    v_mfma_f32_32x32x16_bf16 v[128:143], v[76:79], v[92:95], v[128:143]
    buffer_store_dwordx4 v[164:167], v12, s[8:11], s46 offen offset:1024
    v_exp_f32 v116, v116
    v_exp_f32 v117, v117
    v_exp_f32 v118, v118
    v_exp_f32 v119, v119
    v_cvt_pk_bf16_f32 v90, v116, v117
    v_cvt_pk_bf16_f32 v91, v118, v119
    v_mfma_f32_32x32x16_bf16 v[96:111], v[60:63], v[40:43], v[96:111]
    buffer_store_dwordx4 v[168:171], v12, s[8:11], s46 offen offset:2048
    v_exp_f32 v120, v120
    v_exp_f32 v121, v121
    v_exp_f32 v122, v122
    v_exp_f32 v123, v123
    v_cvt_pk_bf16_f32 v92, v120, v121
    v_cvt_pk_bf16_f32 v93, v122, v123
    v_mfma_f32_32x32x16_bf16 v[144:159], v[72:75], v[88:91], v[144:159]
    buffer_store_dwordx4 v[172:175], v12, s[8:11], s46 offen offset:3072
    v_exp_f32 v124, v124
    v_exp_f32 v125, v125
    v_exp_f32 v126, v126
    v_exp_f32 v127, v127
    v_cvt_pk_bf16_f32 v94, v124, v125
    v_cvt_pk_bf16_f32 v95, v126, v127
    s_barrier
    v_mfma_f32_32x32x16_bf16 v[112:127], v[68:71], v[52:55], 0
    ds_read_b64 v[64:65], v21
    ds_read2_b64 v[56:59], v18 offset0:0 offset1:32
    v_exp_f32 v96, v96
    v_exp_f32 v97, v97
    v_exp_f32 v98, v98
    v_exp_f32 v99, v99
    v_cvt_pk_bf16_f32 v88, v96, v97
    v_cvt_pk_bf16_f32 v89, v98, v99
    v_mfma_f32_32x32x16_bf16 v[144:159], v[76:79], v[92:95], v[144:159]
    ds_read_b64_tr_b16 v[76:77], v27 offset:128
    ds_read_b64_tr_b16 v[78:79], v27 offset:192
    v_exp_f32 v100, v100
    v_exp_f32 v101, v101
    v_exp_f32 v102, v102
    v_exp_f32 v103, v103
    v_cvt_pk_bf16_f32 v90, v100, v101
    v_cvt_pk_bf16_f32 v91, v102, v103
    v_mfma_f32_32x32x16_bf16 v[112:127], v[60:63], v[44:47], v[112:127]
    ds_read_b64_tr_b16 v[72:73], v27 offset:0
    ds_read_b64_tr_b16 v[74:75], v27 offset:64
    v_exp_f32 v104, v104
    v_exp_f32 v105, v105
    v_exp_f32 v106, v106
    v_exp_f32 v107, v107
    v_cvt_pk_bf16_f32 v92, v104, v105
    v_cvt_pk_bf16_f32 v93, v106, v107
    v_mfma_f32_32x32x16_bf16 v[128:143], v[80:83], v[88:91], v[128:143]
    v_exp_f32 v108, v108
    v_exp_f32 v109, v109
    v_exp_f32 v110, v110
    v_exp_f32 v111, v111
    v_cvt_pk_bf16_f32 v94, v108, v109
    v_cvt_pk_bf16_f32 v95, v110, v111
    s_waitcnt lgkmcnt(0)
    v_mfma_f32_32x32x16_bf16 v[96:111], v[64:67], v[48:51], 0
    ds_read_b64 v[68:69], v22
    ds_read2_b64 v[60:63], v18 offset0:128 offset1:160
    v_exp_f32 v112, v112
    v_exp_f32 v113, v113
    v_exp_f32 v114, v114
    v_exp_f32 v115, v115
    v_cvt_pk_bf16_f32 v88, v112, v113
    v_cvt_pk_bf16_f32 v89, v114, v115
    v_mfma_f32_32x32x16_bf16 v[128:143], v[84:87], v[92:95], v[128:143]
    v_exp_f32 v116, v116
    v_exp_f32 v117, v117
    v_exp_f32 v118, v118
    v_exp_f32 v119, v119
    v_cvt_pk_bf16_f32 v90, v116, v117
    v_cvt_pk_bf16_f32 v91, v118, v119
    v_mfma_f32_32x32x16_bf16 v[96:111], v[56:59], v[40:43], v[96:111]
    v_exp_f32 v120, v120
    v_exp_f32 v121, v121
    v_exp_f32 v122, v122
    v_exp_f32 v123, v123
    v_cvt_pk_bf16_f32 v92, v120, v121
    v_cvt_pk_bf16_f32 v93, v122, v123
    v_mfma_f32_32x32x16_bf16 v[144:159], v[80:83], v[88:91], v[144:159]
    v_exp_f32 v124, v124
    v_exp_f32 v125, v125
    v_exp_f32 v126, v126
    v_exp_f32 v127, v127
    v_cvt_pk_bf16_f32 v94, v124, v125
    v_cvt_pk_bf16_f32 v95, v126, v127
    v_mfma_f32_32x32x16_bf16 v[112:127], v[64:67], v[52:55], 0
    ds_read_b64_tr_b16 v[80:81], v28 offset:0
    ds_read_b64_tr_b16 v[82:83], v28 offset:64
    v_exp_f32 v96, v96
    v_exp_f32 v97, v97
    v_exp_f32 v98, v98
    v_exp_f32 v99, v99
    v_cvt_pk_bf16_f32 v88, v96, v97
    v_cvt_pk_bf16_f32 v89, v98, v99
    v_mfma_f32_32x32x16_bf16 v[144:159], v[84:87], v[92:95], v[144:159]
    ds_read_b64_tr_b16 v[84:85], v28 offset:128
    ds_read_b64_tr_b16 v[86:87], v28 offset:192
    v_exp_f32 v100, v100
    v_exp_f32 v101, v101
    v_exp_f32 v102, v102
    v_exp_f32 v103, v103
    v_cvt_pk_bf16_f32 v90, v100, v101
    v_cvt_pk_bf16_f32 v91, v102, v103
    v_mfma_f32_32x32x16_bf16 v[112:127], v[56:59], v[44:47], v[112:127]
    v_exp_f32 v104, v104
    v_exp_f32 v105, v105
    v_exp_f32 v106, v106
    v_exp_f32 v107, v107
    v_cvt_pk_bf16_f32 v92, v104, v105
    v_cvt_pk_bf16_f32 v93, v106, v107
    v_mfma_f32_32x32x16_bf16 v[128:143], v[72:75], v[88:91], v[128:143]
    v_exp_f32 v108, v108
    v_exp_f32 v109, v109
    v_exp_f32 v110, v110
    v_exp_f32 v111, v111
    v_cvt_pk_bf16_f32 v94, v108, v109
    v_cvt_pk_bf16_f32 v95, v110, v111
    s_waitcnt lgkmcnt(0)
    v_mfma_f32_32x32x16_bf16 v[96:111], v[68:71], v[48:51], 0
    v_exp_f32 v112, v112
    v_exp_f32 v113, v113
    v_exp_f32 v114, v114
    v_exp_f32 v115, v115
    v_cvt_pk_bf16_f32 v88, v112, v113
    v_cvt_pk_bf16_f32 v89, v114, v115
    v_mfma_f32_32x32x16_bf16 v[128:143], v[76:79], v[92:95], v[128:143]
    v_exp_f32 v116, v116
    v_exp_f32 v117, v117
    v_exp_f32 v118, v118
    v_exp_f32 v119, v119
    v_cvt_pk_bf16_f32 v90, v116, v117
    v_cvt_pk_bf16_f32 v91, v118, v119
    v_mfma_f32_32x32x16_bf16 v[96:111], v[60:63], v[40:43], v[96:111]
    v_exp_f32 v120, v120
    v_exp_f32 v121, v121
    v_exp_f32 v122, v122
    v_exp_f32 v123, v123
    v_cvt_pk_bf16_f32 v92, v120, v121
    v_cvt_pk_bf16_f32 v93, v122, v123
    v_mfma_f32_32x32x16_bf16 v[144:159], v[72:75], v[88:91], v[144:159]
    v_exp_f32 v124, v124
    v_exp_f32 v125, v125
    v_exp_f32 v126, v126
    v_exp_f32 v127, v127
    v_cvt_pk_bf16_f32 v94, v124, v125
    v_cvt_pk_bf16_f32 v95, v126, v127
    s_barrier
    v_mfma_f32_32x32x16_bf16 v[112:127], v[68:71], v[52:55], 0
    ds_read_b64 v[64:65], v23
    ds_read2_b64 v[56:59], v19 offset0:0 offset1:32
    v_exp_f32 v96, v96
    v_exp_f32 v97, v97
    v_exp_f32 v98, v98
    v_exp_f32 v99, v99
    v_cvt_pk_bf16_f32 v88, v96, v97
    v_cvt_pk_bf16_f32 v89, v98, v99
    v_mfma_f32_32x32x16_bf16 v[144:159], v[76:79], v[92:95], v[144:159]
    ds_read_b64_tr_b16 v[76:77], v29 offset:128
    ds_read_b64_tr_b16 v[78:79], v29 offset:192
    v_exp_f32 v100, v100
    v_exp_f32 v101, v101
    v_exp_f32 v102, v102
    v_exp_f32 v103, v103
    v_cvt_pk_bf16_f32 v90, v100, v101
    v_cvt_pk_bf16_f32 v91, v102, v103
    v_mfma_f32_32x32x16_bf16 v[112:127], v[60:63], v[44:47], v[112:127]
    ds_read_b64_tr_b16 v[72:73], v29 offset:0
    ds_read_b64_tr_b16 v[74:75], v29 offset:64
    v_exp_f32 v104, v104
    v_exp_f32 v105, v105
    v_exp_f32 v106, v106
    v_exp_f32 v107, v107
    v_cvt_pk_bf16_f32 v92, v104, v105
    v_cvt_pk_bf16_f32 v93, v106, v107
    v_mfma_f32_32x32x16_bf16 v[128:143], v[80:83], v[88:91], v[128:143]
    v_exp_f32 v108, v108
    v_exp_f32 v109, v109
    v_exp_f32 v110, v110
    v_exp_f32 v111, v111
    v_cvt_pk_bf16_f32 v94, v108, v109
    v_cvt_pk_bf16_f32 v95, v110, v111
    s_waitcnt lgkmcnt(0)
    v_mfma_f32_32x32x16_bf16 v[96:111], v[64:67], v[48:51], 0
    ds_read_b64 v[68:69], v24
    ds_read2_b64 v[60:63], v19 offset0:128 offset1:160
    v_exp_f32 v112, v112
    v_exp_f32 v113, v113
    v_exp_f32 v114, v114
    v_exp_f32 v115, v115
    v_cvt_pk_bf16_f32 v88, v112, v113
    v_cvt_pk_bf16_f32 v89, v114, v115
    v_mfma_f32_32x32x16_bf16 v[128:143], v[84:87], v[92:95], v[128:143]
    v_exp_f32 v116, v116
    v_exp_f32 v117, v117
    v_exp_f32 v118, v118
    v_exp_f32 v119, v119
    v_cvt_pk_bf16_f32 v90, v116, v117
    v_cvt_pk_bf16_f32 v91, v118, v119
    v_mfma_f32_32x32x16_bf16 v[96:111], v[56:59], v[40:43], v[96:111]
    v_exp_f32 v120, v120
    v_exp_f32 v121, v121
    v_exp_f32 v122, v122
    v_exp_f32 v123, v123
    v_cvt_pk_bf16_f32 v92, v120, v121
    v_cvt_pk_bf16_f32 v93, v122, v123
    v_mfma_f32_32x32x16_bf16 v[144:159], v[80:83], v[88:91], v[144:159]
    v_exp_f32 v124, v124
    v_exp_f32 v125, v125
    v_exp_f32 v126, v126
    v_exp_f32 v127, v127
    v_cvt_pk_bf16_f32 v94, v124, v125
    v_cvt_pk_bf16_f32 v95, v126, v127
    v_mfma_f32_32x32x16_bf16 v[112:127], v[64:67], v[52:55], 0
    ds_read_b64_tr_b16 v[80:81], v30 offset:0
    ds_read_b64_tr_b16 v[82:83], v30 offset:64
    v_exp_f32 v96, v96
    v_exp_f32 v97, v97
    v_exp_f32 v98, v98
    v_exp_f32 v99, v99
    v_cvt_pk_bf16_f32 v88, v96, v97
    v_cvt_pk_bf16_f32 v89, v98, v99
    v_mfma_f32_32x32x16_bf16 v[144:159], v[84:87], v[92:95], v[144:159]
    ds_read_b64_tr_b16 v[84:85], v30 offset:128
    ds_read_b64_tr_b16 v[86:87], v30 offset:192
    v_exp_f32 v100, v100
    v_exp_f32 v101, v101
    v_exp_f32 v102, v102
    v_exp_f32 v103, v103
    v_cvt_pk_bf16_f32 v90, v100, v101
    v_cvt_pk_bf16_f32 v91, v102, v103
    v_mfma_f32_32x32x16_bf16 v[112:127], v[56:59], v[44:47], v[112:127]
    v_exp_f32 v104, v104
    v_exp_f32 v105, v105
    v_exp_f32 v106, v106
    v_exp_f32 v107, v107
    v_cvt_pk_bf16_f32 v92, v104, v105
    v_cvt_pk_bf16_f32 v93, v106, v107
    v_mfma_f32_32x32x16_bf16 v[128:143], v[72:75], v[88:91], v[128:143]
    v_exp_f32 v108, v108
    v_exp_f32 v109, v109
    v_exp_f32 v110, v110
    v_exp_f32 v111, v111
    v_cvt_pk_bf16_f32 v94, v108, v109
    v_cvt_pk_bf16_f32 v95, v110, v111
    s_waitcnt lgkmcnt(0)
    v_mfma_f32_32x32x16_bf16 v[96:111], v[68:71], v[48:51], 0
    v_exp_f32 v112, v112
    v_exp_f32 v113, v113
    v_exp_f32 v114, v114
    v_exp_f32 v115, v115
    v_cvt_pk_bf16_f32 v88, v112, v113
    v_cvt_pk_bf16_f32 v89, v114, v115
    v_mfma_f32_32x32x16_bf16 v[128:143], v[76:79], v[92:95], v[128:143]
    v_exp_f32 v116, v116
    v_exp_f32 v117, v117
    v_exp_f32 v118, v118
    v_exp_f32 v119, v119
    v_cvt_pk_bf16_f32 v90, v116, v117
    v_cvt_pk_bf16_f32 v91, v118, v119
    v_mfma_f32_32x32x16_bf16 v[96:111], v[60:63], v[40:43], v[96:111]
    v_exp_f32 v120, v120
    v_exp_f32 v121, v121
    v_exp_f32 v122, v122
    v_exp_f32 v123, v123
    v_cvt_pk_bf16_f32 v92, v120, v121
    v_cvt_pk_bf16_f32 v93, v122, v123
    v_mfma_f32_32x32x16_bf16 v[144:159], v[72:75], v[88:91], v[144:159]
    v_exp_f32 v124, v124
    v_exp_f32 v125, v125
    v_exp_f32 v126, v126
    v_exp_f32 v127, v127
    v_cvt_pk_bf16_f32 v94, v124, v125
    v_cvt_pk_bf16_f32 v95, v126, v127
    v_mfma_f32_32x32x16_bf16 v[112:127], v[68:71], v[52:55], 0
    v_exp_f32 v96, v96
    v_exp_f32 v97, v97
    v_exp_f32 v98, v98
    v_exp_f32 v99, v99
    v_cvt_pk_bf16_f32 v88, v96, v97
    v_cvt_pk_bf16_f32 v89, v98, v99
    v_mfma_f32_32x32x16_bf16 v[144:159], v[76:79], v[92:95], v[144:159]
    v_exp_f32 v100, v100
    v_exp_f32 v101, v101
    v_exp_f32 v102, v102
    v_exp_f32 v103, v103
    v_cvt_pk_bf16_f32 v90, v100, v101
    v_cvt_pk_bf16_f32 v91, v102, v103
    v_mfma_f32_32x32x16_bf16 v[112:127], v[60:63], v[44:47], v[112:127]
    v_exp_f32 v104, v104
    v_exp_f32 v105, v105
    v_exp_f32 v106, v106
    v_exp_f32 v107, v107
    v_cvt_pk_bf16_f32 v92, v104, v105
    v_cvt_pk_bf16_f32 v93, v106, v107
    v_mfma_f32_32x32x16_bf16 v[128:143], v[80:83], v[88:91], v[128:143]
    v_exp_f32 v108, v108
    v_exp_f32 v109, v109
    v_exp_f32 v110, v110
    v_exp_f32 v111, v111
    v_cvt_pk_bf16_f32 v94, v108, v109
    v_cvt_pk_bf16_f32 v95, v110, v111
    v_exp_f32 v112, v112
    v_exp_f32 v113, v113
    v_exp_f32 v114, v114
    v_exp_f32 v115, v115
    v_cvt_pk_bf16_f32 v88, v112, v113
    v_cvt_pk_bf16_f32 v89, v114, v115
    v_mfma_f32_32x32x16_bf16 v[128:143], v[84:87], v[92:95], v[128:143]
    v_exp_f32 v116, v116
    v_exp_f32 v117, v117
    v_exp_f32 v118, v118
    v_exp_f32 v119, v119
    v_cvt_pk_bf16_f32 v90, v116, v117
    v_cvt_pk_bf16_f32 v91, v118, v119
    v_exp_f32 v120, v120
    v_exp_f32 v121, v121
    v_exp_f32 v122, v122
    v_exp_f32 v123, v123
    v_cvt_pk_bf16_f32 v92, v120, v121
    v_cvt_pk_bf16_f32 v93, v122, v123
    v_mfma_f32_32x32x16_bf16 v[144:159], v[80:83], v[88:91], v[144:159]
    v_exp_f32 v124, v124
    v_exp_f32 v125, v125
    v_exp_f32 v126, v126
    v_exp_f32 v127, v127
    v_cvt_pk_bf16_f32 v94, v124, v125
    v_cvt_pk_bf16_f32 v95, v126, v127
    s_nop 1
    v_mfma_f32_32x32x16_bf16 v[144:159], v[84:87], v[92:95], v[144:159]
    s_mov_b32 s43, 0x7e800000
    s_mov_b32 s44, 0x0a800000
    s_mov_b64 s[66:67], 0
    v_add_f32 v4, abs(v128), abs(v129)
    v_add_f32 v4, v4, abs(v130)
    v_add_f32 v4, v4, abs(v131)
    v_add_f32 v4, v4, abs(v132)
    v_add_f32 v4, v4, abs(v133)
    v_add_f32 v4, v4, abs(v134)
    v_add_f32 v4, v4, abs(v135)
    v_cmp_nle_f32 vcc, s44, v4
    s_nop 0
    s_or_b64 s[66:67], s[66:67], vcc
    v_add_f32 v4, v4, abs(v136)
    v_add_f32 v4, v4, abs(v137)
    v_add_f32 v4, v4, abs(v138)
    v_add_f32 v4, v4, abs(v139)
    v_add_f32 v4, v4, abs(v140)
    v_cmp_ngt_f32 vcc, s43, v4
    s_nop 0
    s_or_b64 s[66:67], s[66:67], vcc
    v_add_f32 v4, abs(v144), abs(v145)
    v_add_f32 v4, v4, abs(v146)
    v_add_f32 v4, v4, abs(v147)
    v_add_f32 v4, v4, abs(v148)
    v_add_f32 v4, v4, abs(v149)
    v_add_f32 v4, v4, abs(v150)
    v_add_f32 v4, v4, abs(v151)
    v_cmp_nle_f32 vcc, s44, v4
    s_nop 0
    s_or_b64 s[66:67], s[66:67], vcc
    v_add_f32 v4, v4, abs(v152)
    v_add_f32 v4, v4, abs(v153)
    v_add_f32 v4, v4, abs(v154)
    v_add_f32 v4, v4, abs(v155)
    v_add_f32 v4, v4, abs(v156)
    v_cmp_ngt_f32 vcc, s43, v4
    s_nop 0
    s_or_b64 s[66:67], s[66:67], vcc
    s_cmp_eq_u64 s[66:67], 0
    s_cbranch_scc0 L2a_fb
L2a_fin:
    v_rcp_f32 v4, v140
    v_cndmask_b32 v136, v136, v138, s[56:57]
    v_cndmask_b32 v137, v137, v139, s[56:57]
    v_mul_f32 v128, v128, v4
    v_mul_f32 v129, v129, v4
    v_mul_f32 v130, v130, v4
    v_mul_f32 v131, v131, v4
    v_mul_f32 v132, v132, v4
    v_mul_f32 v133, v133, v4
    v_mul_f32 v134, v134, v4
    v_mul_f32 v135, v135, v4
    v_mul_f32 v136, v136, v4
    v_mul_f32 v137, v137, v4
    v_cvt_pk_bf16_f32 v88, v128, v129
    v_cvt_pk_bf16_f32 v89, v130, v131
    v_cvt_pk_bf16_f32 v90, v132, v133
    v_cvt_pk_bf16_f32 v91, v134, v135
    v_cvt_pk_bf16_f32 v6, v136, v137
    buffer_store_dwordx4 v[88:91], v33, s[8:11], 0 offen
    buffer_store_dword v6, v35, s[8:11], 0 offen
    v_rcp_f32 v4, v156
    v_cndmask_b32 v152, v152, v154, s[56:57]
    v_cndmask_b32 v153, v153, v155, s[56:57]
    v_mul_f32 v144, v144, v4
    v_mul_f32 v145, v145, v4
    v_mul_f32 v146, v146, v4
    v_mul_f32 v147, v147, v4
    v_mul_f32 v148, v148, v4
    v_mul_f32 v149, v149, v4
    v_mul_f32 v150, v150, v4
    v_mul_f32 v151, v151, v4
    v_mul_f32 v152, v152, v4
    v_mul_f32 v153, v153, v4
    v_cvt_pk_bf16_f32 v92, v144, v145
    v_cvt_pk_bf16_f32 v93, v146, v147
    v_cvt_pk_bf16_f32 v94, v148, v149
    v_cvt_pk_bf16_f32 v95, v150, v151
    v_cvt_pk_bf16_f32 v7, v152, v153
    buffer_store_dwordx4 v[92:95], v34, s[8:11], 0 offen
    buffer_store_dword v7, v36, s[8:11], 0 offen
    s_endpgm
L2a_fb:
    s_mul_i32 s46, s62, 5376
    s_add_u32 s46, s46, 0
    s_add_u32 s61, s46, 1024
    v_add_u32 v18, s46, v13
    v_mad_u32_u24 v21, v16, s46, v14
    v_mad_u32_u24 v27, v17, s46, v15
    v_mad_u32_u24 v22, v16, s61, v14
    v_mad_u32_u24 v28, v17, s61, v15
    s_mov_b32 s52, s46
    v_bfe_u32 v4, v1, 4, 1
    v_lshlrev_b32 v4, 1, v4
    v_xor_b32 v31, v4, v1
    v_lshlrev_b32 v31, 4, v31
    v_lshrrev_b32 v4, 5, v1
    v_lshlrev_b32 v4, 30, v4
    v_lshlrev_b32 v32, 4, v1
    v_add_u32 v32, v32, v4
    s_lshl_b32 s51, s63, 10
    s_mul_i32 s53, s63, 1024
    s_add_u32 s53, s53, 2048
    v_cndmask_b32 v48, v48, 0, s[58:59]
    v_mov_b32 v37, 0xff800000
    v_cndmask_b32 v52, v52, 0, s[58:59]
    v_mov_b32 v38, 0xff800000
    s_mov_b32 s50, s65
    s_mov_b32 s48, 64
L2a_fb1:
    s_mov_b32 m0, s52
    s_add_u32 s43, s50, s51
    buffer_load_dwordx4 v12, s[8:11], s43 offen sc1 lds
    s_add_u32 m0, s52, 2048
    s_add_u32 s43, s50, s53
    buffer_load_dwordx4 v31, s[8:11], s43 offen sc1 lds
    s_add_u32 m0, s52, 4224
    s_add_u32 s43, s50, 4096
    buffer_load_dwordx4 v32, s[8:11], s43 offen sc1 lds
    s_add_u32 s50, s50, 4608
    s_waitcnt vmcnt(0)
    ds_read_b64 v[64:65], v21
    ds_read2_b64 v[56:59], v18 offset0:0 offset1:32
    s_waitcnt lgkmcnt(0)
    v_mfma_f32_32x32x16_bf16 v[96:111], v[64:67], v[48:51], 0
    v_mfma_f32_32x32x16_bf16 v[96:111], v[56:59], v[40:43], v[96:111]
    v_mfma_f32_32x32x16_bf16 v[112:127], v[64:67], v[52:55], 0
    v_mfma_f32_32x32x16_bf16 v[112:127], v[56:59], v[44:47], v[112:127]
    s_nop 15
    v_max3_f32 v37, v96, v97, v37
    v_max3_f32 v37, v98, v99, v37
    v_max3_f32 v37, v100, v101, v37
    v_max3_f32 v37, v102, v103, v37
    v_max3_f32 v37, v104, v105, v37
    v_max3_f32 v37, v106, v107, v37
    v_max3_f32 v37, v108, v109, v37
    v_max3_f32 v37, v110, v111, v37
    v_max3_f32 v38, v112, v113, v38
    v_max3_f32 v38, v114, v115, v38
    v_max3_f32 v38, v116, v117, v38
    v_max3_f32 v38, v118, v119, v38
    v_max3_f32 v38, v120, v121, v38
    v_max3_f32 v38, v122, v123, v38
    v_max3_f32 v38, v124, v125, v38
    v_max3_f32 v38, v126, v127, v38
    s_sub_u32 s48, s48, 1
    s_cmp_lg_u32 s48, 0
    s_cbranch_scc1 L2a_fb1
    v_mov_b32 v4, v37
    s_nop 1
    v_permlane32_swap_b32 v4, v37
    v_max_f32 v4, v4, v37
    v_sub_f32 v4, 0, v4
    v_cvt_pk_bf16_f32 v5, v4, v4
    v_and_b32 v5, 0xffff0000, v5
    v_sub_f32 v4, v4, v5
    v_cvt_pk_bf16_f32 v4, v5, v4
    v_cndmask_b32 v48, v48, v4, s[58:59]
    v_mov_b32 v4, v38
    s_nop 1
    v_permlane32_swap_b32 v4, v38
    v_max_f32 v4, v4, v38
    v_sub_f32 v4, 0, v4
    v_cvt_pk_bf16_f32 v5, v4, v4
    v_and_b32 v5, 0xffff0000, v5
    v_sub_f32 v4, v4, v5
    v_cvt_pk_bf16_f32 v4, v5, v4
    v_cndmask_b32 v52, v52, v4, s[58:59]
    v_mov_b32 v128, 0
    v_mov_b32 v129, 0
    v_mov_b32 v130, 0
    v_mov_b32 v131, 0
    v_mov_b32 v132, 0
    v_mov_b32 v133, 0
    v_mov_b32 v134, 0
    v_mov_b32 v135, 0
    v_mov_b32 v136, 0
    v_mov_b32 v137, 0
    v_mov_b32 v138, 0
    v_mov_b32 v139, 0
    v_mov_b32 v140, 0
    v_mov_b32 v141, 0
    v_mov_b32 v142, 0
    v_mov_b32 v143, 0
    v_mov_b32 v144, 0
    v_mov_b32 v145, 0
    v_mov_b32 v146, 0
    v_mov_b32 v147, 0
    v_mov_b32 v148, 0
    v_mov_b32 v149, 0
    v_mov_b32 v150, 0
    v_mov_b32 v151, 0
    v_mov_b32 v152, 0
    v_mov_b32 v153, 0
    v_mov_b32 v154, 0
    v_mov_b32 v155, 0
    v_mov_b32 v156, 0
    v_mov_b32 v157, 0
    v_mov_b32 v158, 0
    v_mov_b32 v159, 0
    s_mov_b32 s50, s65
    s_mov_b32 s48, 64
L2a_fb2:
    s_mov_b32 m0, s52
    s_add_u32 s43, s50, s51
    buffer_load_dwordx4 v12, s[8:11], s43 offen sc1 lds
    s_add_u32 m0, s52, 2048
    s_add_u32 s43, s50, s53
    buffer_load_dwordx4 v31, s[8:11], s43 offen sc1 lds
    s_add_u32 m0, s52, 4224
    s_add_u32 s43, s50, 4096
    buffer_load_dwordx4 v32, s[8:11], s43 offen sc1 lds
    s_add_u32 s50, s50, 4608
    s_waitcnt vmcnt(0)
    ds_read_b64 v[64:65], v21
    ds_read2_b64 v[56:59], v18 offset0:0 offset1:32
    ds_read_b64_tr_b16 v[72:73], v27 offset:0
    ds_read_b64_tr_b16 v[74:75], v27 offset:64
    ds_read_b64_tr_b16 v[76:77], v27 offset:128
    ds_read_b64_tr_b16 v[78:79], v27 offset:192
    s_waitcnt lgkmcnt(0)
    v_mfma_f32_32x32x16_bf16 v[96:111], v[64:67], v[48:51], 0
    v_mfma_f32_32x32x16_bf16 v[96:111], v[56:59], v[40:43], v[96:111]
    v_mfma_f32_32x32x16_bf16 v[112:127], v[64:67], v[52:55], 0
    v_mfma_f32_32x32x16_bf16 v[112:127], v[56:59], v[44:47], v[112:127]
    s_nop 15
    v_exp_f32 v96, v96
    v_exp_f32 v97, v97
    v_exp_f32 v98, v98
    v_exp_f32 v99, v99
    v_cvt_pk_bf16_f32 v88, v96, v97
    v_cvt_pk_bf16_f32 v89, v98, v99
    v_exp_f32 v100, v100
    v_exp_f32 v101, v101
    v_exp_f32 v102, v102
    v_exp_f32 v103, v103
    v_cvt_pk_bf16_f32 v90, v100, v101
    v_cvt_pk_bf16_f32 v91, v102, v103
    v_exp_f32 v104, v104
    v_exp_f32 v105, v105
    v_exp_f32 v106, v106
    v_exp_f32 v107, v107
    v_cvt_pk_bf16_f32 v92, v104, v105
    v_cvt_pk_bf16_f32 v93, v106, v107
    v_exp_f32 v108, v108
    v_exp_f32 v109, v109
    v_exp_f32 v110, v110
    v_exp_f32 v111, v111
    v_cvt_pk_bf16_f32 v94, v108, v109
    v_cvt_pk_bf16_f32 v95, v110, v111
    v_mfma_f32_32x32x16_bf16 v[128:143], v[72:75], v[88:91], v[128:143]
    s_nop 0
    v_mfma_f32_32x32x16_bf16 v[128:143], v[76:79], v[92:95], v[128:143]
    v_exp_f32 v112, v112
    v_exp_f32 v113, v113
    v_exp_f32 v114, v114
    v_exp_f32 v115, v115
    v_cvt_pk_bf16_f32 v88, v112, v113
    v_cvt_pk_bf16_f32 v89, v114, v115
    v_exp_f32 v116, v116
    v_exp_f32 v117, v117
    v_exp_f32 v118, v118
    v_exp_f32 v119, v119
    v_cvt_pk_bf16_f32 v90, v116, v117
    v_cvt_pk_bf16_f32 v91, v118, v119
    v_exp_f32 v120, v120
    v_exp_f32 v121, v121
    v_exp_f32 v122, v122
    v_exp_f32 v123, v123
    v_cvt_pk_bf16_f32 v92, v120, v121
    v_cvt_pk_bf16_f32 v93, v122, v123
    v_exp_f32 v124, v124
    v_exp_f32 v125, v125
    v_exp_f32 v126, v126
    v_exp_f32 v127, v127
    v_cvt_pk_bf16_f32 v94, v124, v125
    v_cvt_pk_bf16_f32 v95, v126, v127
    v_mfma_f32_32x32x16_bf16 v[144:159], v[72:75], v[88:91], v[144:159]
    s_nop 0
    v_mfma_f32_32x32x16_bf16 v[144:159], v[76:79], v[92:95], v[144:159]
    s_sub_u32 s48, s48, 1
    s_cmp_lg_u32 s48, 0
    s_cbranch_scc1 L2a_fb2
    s_nop 15
    s_branch L2a_fin
L2_codeend:
.globl k3_out_kernel
.p2align 8
.type k3_out_kernel,@function
k3_out_kernel:
    s_cmp_ge_u32 s2, 240
    s_cbranch_scc1 L3_end
    s_load_dwordx2 s[28:29], s[0:1], 80
    s_load_dwordx2 s[34:35], s[0:1], 0
    s_load_dwordx2 s[36:37], s[0:1], 64
    s_and_b32 s46, s2, 7
    s_lshr_b32 s47, s2, 3
    s_mul_i32 s46, s46, 30
    s_add_u32 s46, s46, s47
    s_cmp_ge_u32 s46, 234
    s_cbranch_scc1 L3_end
    s_mul_i32 s41, s46, 7282
    s_lshr_b32 s41, s41, 16
    s_mul_i32 s47, s41, 9
    s_sub_u32 s42, s46, s47
    v_lshrrev_b32 v4, 6, v0
    v_and_b32 v1, 63, v0
    v_readfirstlane_b32 s40, v4
    s_lshl_b32 s42, s42, 7
    v_lshlrev_b32 v6, 4, v1
    s_lshl_b32 s46, s42, 5
    v_add_u32 v13, s46, v6
    s_mul_i32 s43, s40, 21760
    s_mul_i32 s46, s41, 460800
    v_add_u32 v8, s46, v6
    v_add_u32 v9, 92160, v8
    v_add_u32 v10, 184320, v8
    v_add_u32 v11, 276480, v8
    v_add_u32 v12, 368640, v8
    s_waitcnt lgkmcnt(0)
    s_add_u32 s12, s28, 47185920
    s_addc_u32 s13, s29, 0
    s_and_b32 s13, s13, 0xffff
    s_mov_b32 s14, 3317760
    s_mov_b32 s15, 0x20000
    s_add_u32 s8, s28, 20971520
    s_addc_u32 s9, s29, 0
    s_and_b32 s9, s9, 0xffff
    s_mov_b32 s10, 11796480
    s_mov_b32 s11, 0x20000
    s_mul_i32 s44, s40, 18432
    s_mul_i32 s45, s40, 663552
    buffer_load_dwordx4 a[0:3], v13, s[12:15], s45 offen offset:0
    buffer_load_dwordx4 a[4:7], v13, s[12:15], s45 offen offset:1024
    buffer_load_dwordx4 a[8:11], v13, s[12:15], s45 offen offset:2048
    buffer_load_dwordx4 a[12:15], v13, s[12:15], s45 offen offset:3072
    buffer_load_dwordx4 v[112:115], v8, s[8:11], s44 offen
    buffer_load_dwordx4 v[116:119], v9, s[8:11], s44 offen
    buffer_load_dwordx4 v[120:123], v10, s[8:11], s44 offen
    buffer_load_dwordx4 v[124:127], v11, s[8:11], s44 offen
    buffer_load_dwordx4 v[128:131], v12, s[8:11], s44 offen
    s_mov_b32 s20, s34
    s_and_b32 s21, s35, 0xffff
    s_mov_b32 s22, 2359296
    s_mov_b32 s23, 0x20000
    s_mov_b32 s24, s36
    s_and_b32 s25, s37, 0xffff
    s_mov_b32 s26, 2359296
    s_mov_b32 s27, 0x20000
    v_lshrrev_b32 v4, 3, v0
    s_mul_i32 s46, s41, 80
    v_add_u32 v4, s46, v4
    v_mul_u32_u24 v4, 1152, v4
    v_and_b32 v5, 7, v0
    v_lshlrev_b32 v6, 4, v5
    v_add3_u32 v14, v4, v6, s42
    v_add_u32 v15, 36864, v14
    v_add_u32 v16, 73728, v14
    s_add_u32 s44, s44, 1024
    s_add_u32 s45, s45, 36864
    buffer_load_dwordx4 a[16:19], v13, s[12:15], s45 offen offset:0
    buffer_load_dwordx4 a[20:23], v13, s[12:15], s45 offen offset:1024
    buffer_load_dwordx4 a[24:27], v13, s[12:15], s45 offen offset:2048
    buffer_load_dwordx4 a[28:31], v13, s[12:15], s45 offen offset:3072
    buffer_load_dwordx4 v[132:135], v8, s[8:11], s44 offen
    buffer_load_dwordx4 v[136:139], v9, s[8:11], s44 offen
    buffer_load_dwordx4 v[140:143], v10, s[8:11], s44 offen
    buffer_load_dwordx4 v[144:147], v11, s[8:11], s44 offen
    buffer_load_dwordx4 v[148:151], v12, s[8:11], s44 offen
    s_add_u32 s44, s44, 1024
    s_add_u32 s45, s45, 36864
    buffer_load_dwordx4 a[32:35], v13, s[12:15], s45 offen offset:0
    buffer_load_dwordx4 a[36:39], v13, s[12:15], s45 offen offset:1024
    buffer_load_dwordx4 a[40:43], v13, s[12:15], s45 offen offset:2048
    buffer_load_dwordx4 a[44:47], v13, s[12:15], s45 offen offset:3072
    buffer_load_dwordx4 v[152:155], v8, s[8:11], s44 offen
    buffer_load_dwordx4 v[156:159], v9, s[8:11], s44 offen
    buffer_load_dwordx4 v[160:163], v10, s[8:11], s44 offen
    buffer_load_dwordx4 v[164:167], v11, s[8:11], s44 offen
    buffer_load_dwordx4 v[168:171], v12, s[8:11], s44 offen
    buffer_load_dwordx4 v[20:23], v14, s[20:23], 0 offen
    buffer_load_dwordx4 v[24:27], v15, s[20:23], 0 offen
    buffer_load_dwordx4 v[28:31], v16, s[20:23], 0 offen
    v_and_b32 v4, 15, v1
    v_mul_u32_u24 v4, 272, v4
    v_lshrrev_b32 v5, 4, v1
    v_lshlrev_b32 v5, 4, v5
    v_add3_u32 v17, v4, v5, s43
    v_lshrrev_b32 v4, 3, v0
    v_mul_u32_u24 v4, 272, v4
    v_and_b32 v5, 7, v0
    v_lshlrev_b32 v5, 5, v5
    v_add_u32 v18, v4, v5
    s_waitcnt vmcnt(21)
    v_mfma_f32_16x16x32_bf16 v[32:35], a[0:3], v[112:115], 0
    v_mfma_f32_16x16x32_bf16 v[36:39], a[0:3], v[116:119], 0
    s_add_u32 s44, s44, 1024
    s_add_u32 s45, s45, 36864
    buffer_load_dwordx4 a[48:51], v13, s[12:15], s45 offen offset:0
    v_mfma_f32_16x16x32_bf16 v[40:43], a[0:3], v[120:123], 0
    v_mfma_f32_16x16x32_bf16 v[44:47], a[0:3], v[124:127], 0
    buffer_load_dwordx4 a[52:55], v13, s[12:15], s45 offen offset:1024
    v_mfma_f32_16x16x32_bf16 v[48:51], a[0:3], v[128:131], 0
    v_mfma_f32_16x16x32_bf16 v[52:55], a[4:7], v[112:115], 0
    buffer_load_dwordx4 a[56:59], v13, s[12:15], s45 offen offset:2048
    v_mfma_f32_16x16x32_bf16 v[56:59], a[4:7], v[116:119], 0
    v_mfma_f32_16x16x32_bf16 v[60:63], a[4:7], v[120:123], 0
    buffer_load_dwordx4 a[60:63], v13, s[12:15], s45 offen offset:3072
    v_mfma_f32_16x16x32_bf16 v[64:67], a[4:7], v[124:127], 0
    v_mfma_f32_16x16x32_bf16 v[68:71], a[4:7], v[128:131], 0
    buffer_load_dwordx4 v[172:175], v8, s[8:11], s44 offen
    v_mfma_f32_16x16x32_bf16 v[72:75], a[8:11], v[112:115], 0
    v_mfma_f32_16x16x32_bf16 v[76:79], a[8:11], v[116:119], 0
    buffer_load_dwordx4 v[176:179], v9, s[8:11], s44 offen
    v_mfma_f32_16x16x32_bf16 v[80:83], a[8:11], v[120:123], 0
    v_mfma_f32_16x16x32_bf16 v[84:87], a[8:11], v[124:127], 0
    buffer_load_dwordx4 v[180:183], v10, s[8:11], s44 offen
    v_mfma_f32_16x16x32_bf16 v[88:91], a[8:11], v[128:131], 0
    v_mfma_f32_16x16x32_bf16 v[92:95], a[12:15], v[112:115], 0
    buffer_load_dwordx4 v[184:187], v11, s[8:11], s44 offen
    v_mfma_f32_16x16x32_bf16 v[96:99], a[12:15], v[116:119], 0
    v_mfma_f32_16x16x32_bf16 v[100:103], a[12:15], v[120:123], 0
    buffer_load_dwordx4 v[188:191], v12, s[8:11], s44 offen
    v_mfma_f32_16x16x32_bf16 v[104:107], a[12:15], v[124:127], 0
    v_mfma_f32_16x16x32_bf16 v[108:111], a[12:15], v[128:131], 0
    s_waitcnt vmcnt(21)
    v_mfma_f32_16x16x32_bf16 v[32:35], a[16:19], v[132:135], v[32:35]
    v_mfma_f32_16x16x32_bf16 v[36:39], a[16:19], v[136:139], v[36:39]
    s_add_u32 s44, s44, 1024
    s_add_u32 s45, s45, 36864
    buffer_load_dwordx4 a[64:67], v13, s[12:15], s45 offen offset:0
    v_mfma_f32_16x16x32_bf16 v[40:43], a[16:19], v[140:143], v[40:43]
    v_mfma_f32_16x16x32_bf16 v[44:47], a[16:19], v[144:147], v[44:47]
    buffer_load_dwordx4 a[68:71], v13, s[12:15], s45 offen offset:1024
    v_mfma_f32_16x16x32_bf16 v[48:51], a[16:19], v[148:151], v[48:51]
    v_mfma_f32_16x16x32_bf16 v[52:55], a[20:23], v[132:135], v[52:55]
    buffer_load_dwordx4 a[72:75], v13, s[12:15], s45 offen offset:2048
    v_mfma_f32_16x16x32_bf16 v[56:59], a[20:23], v[136:139], v[56:59]
    v_mfma_f32_16x16x32_bf16 v[60:63], a[20:23], v[140:143], v[60:63]
    buffer_load_dwordx4 a[76:79], v13, s[12:15], s45 offen offset:3072
    v_mfma_f32_16x16x32_bf16 v[64:67], a[20:23], v[144:147], v[64:67]
    v_mfma_f32_16x16x32_bf16 v[68:71], a[20:23], v[148:151], v[68:71]
    buffer_load_dwordx4 v[192:195], v8, s[8:11], s44 offen
    v_mfma_f32_16x16x32_bf16 v[72:75], a[24:27], v[132:135], v[72:75]
    v_mfma_f32_16x16x32_bf16 v[76:79], a[24:27], v[136:139], v[76:79]
    buffer_load_dwordx4 v[196:199], v9, s[8:11], s44 offen
    v_mfma_f32_16x16x32_bf16 v[80:83], a[24:27], v[140:143], v[80:83]
    v_mfma_f32_16x16x32_bf16 v[84:87], a[24:27], v[144:147], v[84:87]
    buffer_load_dwordx4 v[200:203], v10, s[8:11], s44 offen
    v_mfma_f32_16x16x32_bf16 v[88:91], a[24:27], v[148:151], v[88:91]
    v_mfma_f32_16x16x32_bf16 v[92:95], a[28:31], v[132:135], v[92:95]
    buffer_load_dwordx4 v[204:207], v11, s[8:11], s44 offen
    v_mfma_f32_16x16x32_bf16 v[96:99], a[28:31], v[136:139], v[96:99]
    v_mfma_f32_16x16x32_bf16 v[100:103], a[28:31], v[140:143], v[100:103]
    buffer_load_dwordx4 v[208:211], v12, s[8:11], s44 offen
    v_mfma_f32_16x16x32_bf16 v[104:107], a[28:31], v[144:147], v[104:107]
    v_mfma_f32_16x16x32_bf16 v[108:111], a[28:31], v[148:151], v[108:111]
    s_waitcnt vmcnt(21)
    v_mfma_f32_16x16x32_bf16 v[32:35], a[32:35], v[152:155], v[32:35]
    v_mfma_f32_16x16x32_bf16 v[36:39], a[32:35], v[156:159], v[36:39]
    s_add_u32 s44, s44, 1024
    s_add_u32 s45, s45, 36864
    buffer_load_dwordx4 a[0:3], v13, s[12:15], s45 offen offset:0
    v_mfma_f32_16x16x32_bf16 v[40:43], a[32:35], v[160:163], v[40:43]
    v_mfma_f32_16x16x32_bf16 v[44:47], a[32:35], v[164:167], v[44:47]
    buffer_load_dwordx4 a[4:7], v13, s[12:15], s45 offen offset:1024
    v_mfma_f32_16x16x32_bf16 v[48:51], a[32:35], v[168:171], v[48:51]
    v_mfma_f32_16x16x32_bf16 v[52:55], a[36:39], v[152:155], v[52:55]
    buffer_load_dwordx4 a[8:11], v13, s[12:15], s45 offen offset:2048
    v_mfma_f32_16x16x32_bf16 v[56:59], a[36:39], v[156:159], v[56:59]
    v_mfma_f32_16x16x32_bf16 v[60:63], a[36:39], v[160:163], v[60:63]
    buffer_load_dwordx4 a[12:15], v13, s[12:15], s45 offen offset:3072
    v_mfma_f32_16x16x32_bf16 v[64:67], a[36:39], v[164:167], v[64:67]
    v_mfma_f32_16x16x32_bf16 v[68:71], a[36:39], v[168:171], v[68:71]
    buffer_load_dwordx4 v[112:115], v8, s[8:11], s44 offen
    v_mfma_f32_16x16x32_bf16 v[72:75], a[40:43], v[152:155], v[72:75]
    v_mfma_f32_16x16x32_bf16 v[76:79], a[40:43], v[156:159], v[76:79]
    buffer_load_dwordx4 v[116:119], v9, s[8:11], s44 offen
    v_mfma_f32_16x16x32_bf16 v[80:83], a[40:43], v[160:163], v[80:83]
    v_mfma_f32_16x16x32_bf16 v[84:87], a[40:43], v[164:167], v[84:87]
    buffer_load_dwordx4 v[120:123], v10, s[8:11], s44 offen
    v_mfma_f32_16x16x32_bf16 v[88:91], a[40:43], v[168:171], v[88:91]
    v_mfma_f32_16x16x32_bf16 v[92:95], a[44:47], v[152:155], v[92:95]
    buffer_load_dwordx4 v[124:127], v11, s[8:11], s44 offen
    v_mfma_f32_16x16x32_bf16 v[96:99], a[44:47], v[156:159], v[96:99]
    v_mfma_f32_16x16x32_bf16 v[100:103], a[44:47], v[160:163], v[100:103]
    buffer_load_dwordx4 v[128:131], v12, s[8:11], s44 offen
    v_mfma_f32_16x16x32_bf16 v[104:107], a[44:47], v[164:167], v[104:107]
    v_mfma_f32_16x16x32_bf16 v[108:111], a[44:47], v[168:171], v[108:111]
    s_waitcnt vmcnt(18)
    v_mfma_f32_16x16x32_bf16 v[32:35], a[48:51], v[172:175], v[32:35]
    v_mfma_f32_16x16x32_bf16 v[36:39], a[48:51], v[176:179], v[36:39]
    s_add_u32 s44, s44, 1024
    s_add_u32 s45, s45, 36864
    buffer_load_dwordx4 a[16:19], v13, s[12:15], s45 offen offset:0
    v_mfma_f32_16x16x32_bf16 v[40:43], a[48:51], v[180:183], v[40:43]
    v_mfma_f32_16x16x32_bf16 v[44:47], a[48:51], v[184:187], v[44:47]
    buffer_load_dwordx4 a[20:23], v13, s[12:15], s45 offen offset:1024
    v_mfma_f32_16x16x32_bf16 v[48:51], a[48:51], v[188:191], v[48:51]
    v_mfma_f32_16x16x32_bf16 v[52:55], a[52:55], v[172:175], v[52:55]
    buffer_load_dwordx4 a[24:27], v13, s[12:15], s45 offen offset:2048
    v_mfma_f32_16x16x32_bf16 v[56:59], a[52:55], v[176:179], v[56:59]
    v_mfma_f32_16x16x32_bf16 v[60:63], a[52:55], v[180:183], v[60:63]
    buffer_load_dwordx4 a[28:31], v13, s[12:15], s45 offen offset:3072
    v_mfma_f32_16x16x32_bf16 v[64:67], a[52:55], v[184:187], v[64:67]
    v_mfma_f32_16x16x32_bf16 v[68:71], a[52:55], v[188:191], v[68:71]
    buffer_load_dwordx4 v[132:135], v8, s[8:11], s44 offen
    v_mfma_f32_16x16x32_bf16 v[72:75], a[56:59], v[172:175], v[72:75]
    v_mfma_f32_16x16x32_bf16 v[76:79], a[56:59], v[176:179], v[76:79]
    buffer_load_dwordx4 v[136:139], v9, s[8:11], s44 offen
    v_mfma_f32_16x16x32_bf16 v[80:83], a[56:59], v[180:183], v[80:83]
    v_mfma_f32_16x16x32_bf16 v[84:87], a[56:59], v[184:187], v[84:87]
    buffer_load_dwordx4 v[140:143], v10, s[8:11], s44 offen
    v_mfma_f32_16x16x32_bf16 v[88:91], a[56:59], v[188:191], v[88:91]
    v_mfma_f32_16x16x32_bf16 v[92:95], a[60:63], v[172:175], v[92:95]
    buffer_load_dwordx4 v[144:147], v11, s[8:11], s44 offen
    v_mfma_f32_16x16x32_bf16 v[96:99], a[60:63], v[176:179], v[96:99]
    v_mfma_f32_16x16x32_bf16 v[100:103], a[60:63], v[180:183], v[100:103]
    buffer_load_dwordx4 v[148:151], v12, s[8:11], s44 offen
    v_mfma_f32_16x16x32_bf16 v[104:107], a[60:63], v[184:187], v[104:107]
    v_mfma_f32_16x16x32_bf16 v[108:111], a[60:63], v[188:191], v[108:111]
    s_waitcnt vmcnt(18)
    v_mfma_f32_16x16x32_bf16 v[32:35], a[64:67], v[192:195], v[32:35]
    v_mfma_f32_16x16x32_bf16 v[36:39], a[64:67], v[196:199], v[36:39]
    s_add_u32 s44, s44, 1024
    s_add_u32 s45, s45, 36864
    buffer_load_dwordx4 a[32:35], v13, s[12:15], s45 offen offset:0
    v_mfma_f32_16x16x32_bf16 v[40:43], a[64:67], v[200:203], v[40:43]
    v_mfma_f32_16x16x32_bf16 v[44:47], a[64:67], v[204:207], v[44:47]
    buffer_load_dwordx4 a[36:39], v13, s[12:15], s45 offen offset:1024
    v_mfma_f32_16x16x32_bf16 v[48:51], a[64:67], v[208:211], v[48:51]
    v_mfma_f32_16x16x32_bf16 v[52:55], a[68:71], v[192:195], v[52:55]
    buffer_load_dwordx4 a[40:43], v13, s[12:15], s45 offen offset:2048
    v_mfma_f32_16x16x32_bf16 v[56:59], a[68:71], v[196:199], v[56:59]
    v_mfma_f32_16x16x32_bf16 v[60:63], a[68:71], v[200:203], v[60:63]
    buffer_load_dwordx4 a[44:47], v13, s[12:15], s45 offen offset:3072
    v_mfma_f32_16x16x32_bf16 v[64:67], a[68:71], v[204:207], v[64:67]
    v_mfma_f32_16x16x32_bf16 v[68:71], a[68:71], v[208:211], v[68:71]
    buffer_load_dwordx4 v[152:155], v8, s[8:11], s44 offen
    v_mfma_f32_16x16x32_bf16 v[72:75], a[72:75], v[192:195], v[72:75]
    v_mfma_f32_16x16x32_bf16 v[76:79], a[72:75], v[196:199], v[76:79]
    buffer_load_dwordx4 v[156:159], v9, s[8:11], s44 offen
    v_mfma_f32_16x16x32_bf16 v[80:83], a[72:75], v[200:203], v[80:83]
    v_mfma_f32_16x16x32_bf16 v[84:87], a[72:75], v[204:207], v[84:87]
    buffer_load_dwordx4 v[160:163], v10, s[8:11], s44 offen
    v_mfma_f32_16x16x32_bf16 v[88:91], a[72:75], v[208:211], v[88:91]
    v_mfma_f32_16x16x32_bf16 v[92:95], a[76:79], v[192:195], v[92:95]
    buffer_load_dwordx4 v[164:167], v11, s[8:11], s44 offen
    v_mfma_f32_16x16x32_bf16 v[96:99], a[76:79], v[196:199], v[96:99]
    v_mfma_f32_16x16x32_bf16 v[100:103], a[76:79], v[200:203], v[100:103]
    buffer_load_dwordx4 v[168:171], v12, s[8:11], s44 offen
    v_mfma_f32_16x16x32_bf16 v[104:107], a[76:79], v[204:207], v[104:107]
    v_mfma_f32_16x16x32_bf16 v[108:111], a[76:79], v[208:211], v[108:111]
    s_waitcnt vmcnt(18)
    v_mfma_f32_16x16x32_bf16 v[32:35], a[0:3], v[112:115], v[32:35]
    v_mfma_f32_16x16x32_bf16 v[36:39], a[0:3], v[116:119], v[36:39]
    s_add_u32 s44, s44, 1024
    s_add_u32 s45, s45, 36864
    buffer_load_dwordx4 a[48:51], v13, s[12:15], s45 offen offset:0
    v_mfma_f32_16x16x32_bf16 v[40:43], a[0:3], v[120:123], v[40:43]
    v_mfma_f32_16x16x32_bf16 v[44:47], a[0:3], v[124:127], v[44:47]
    buffer_load_dwordx4 a[52:55], v13, s[12:15], s45 offen offset:1024
    v_mfma_f32_16x16x32_bf16 v[48:51], a[0:3], v[128:131], v[48:51]
    v_mfma_f32_16x16x32_bf16 v[52:55], a[4:7], v[112:115], v[52:55]
    buffer_load_dwordx4 a[56:59], v13, s[12:15], s45 offen offset:2048
    v_mfma_f32_16x16x32_bf16 v[56:59], a[4:7], v[116:119], v[56:59]
    v_mfma_f32_16x16x32_bf16 v[60:63], a[4:7], v[120:123], v[60:63]
    buffer_load_dwordx4 a[60:63], v13, s[12:15], s45 offen offset:3072
    v_mfma_f32_16x16x32_bf16 v[64:67], a[4:7], v[124:127], v[64:67]
    v_mfma_f32_16x16x32_bf16 v[68:71], a[4:7], v[128:131], v[68:71]
    buffer_load_dwordx4 v[172:175], v8, s[8:11], s44 offen
    v_mfma_f32_16x16x32_bf16 v[72:75], a[8:11], v[112:115], v[72:75]
    v_mfma_f32_16x16x32_bf16 v[76:79], a[8:11], v[116:119], v[76:79]
    buffer_load_dwordx4 v[176:179], v9, s[8:11], s44 offen
    v_mfma_f32_16x16x32_bf16 v[80:83], a[8:11], v[120:123], v[80:83]
    v_mfma_f32_16x16x32_bf16 v[84:87], a[8:11], v[124:127], v[84:87]
    buffer_load_dwordx4 v[180:183], v10, s[8:11], s44 offen
    v_mfma_f32_16x16x32_bf16 v[88:91], a[8:11], v[128:131], v[88:91]
    v_mfma_f32_16x16x32_bf16 v[92:95], a[12:15], v[112:115], v[92:95]
    buffer_load_dwordx4 v[184:187], v11, s[8:11], s44 offen
    v_mfma_f32_16x16x32_bf16 v[96:99], a[12:15], v[116:119], v[96:99]
    v_mfma_f32_16x16x32_bf16 v[100:103], a[12:15], v[120:123], v[100:103]
    buffer_load_dwordx4 v[188:191], v12, s[8:11], s44 offen
    v_mfma_f32_16x16x32_bf16 v[104:107], a[12:15], v[124:127], v[104:107]
    v_mfma_f32_16x16x32_bf16 v[108:111], a[12:15], v[128:131], v[108:111]
    s_waitcnt vmcnt(18)
    v_mfma_f32_16x16x32_bf16 v[32:35], a[16:19], v[132:135], v[32:35]
    v_mfma_f32_16x16x32_bf16 v[36:39], a[16:19], v[136:139], v[36:39]
    s_add_u32 s44, s44, 1024
    s_add_u32 s45, s45, 36864
    buffer_load_dwordx4 a[64:67], v13, s[12:15], s45 offen offset:0
    v_mfma_f32_16x16x32_bf16 v[40:43], a[16:19], v[140:143], v[40:43]
    v_mfma_f32_16x16x32_bf16 v[44:47], a[16:19], v[144:147], v[44:47]
    buffer_load_dwordx4 a[68:71], v13, s[12:15], s45 offen offset:1024
    v_mfma_f32_16x16x32_bf16 v[48:51], a[16:19], v[148:151], v[48:51]
    v_mfma_f32_16x16x32_bf16 v[52:55], a[20:23], v[132:135], v[52:55]
    buffer_load_dwordx4 a[72:75], v13, s[12:15], s45 offen offset:2048
    v_mfma_f32_16x16x32_bf16 v[56:59], a[20:23], v[136:139], v[56:59]
    v_mfma_f32_16x16x32_bf16 v[60:63], a[20:23], v[140:143], v[60:63]
    buffer_load_dwordx4 a[76:79], v13, s[12:15], s45 offen offset:3072
    v_mfma_f32_16x16x32_bf16 v[64:67], a[20:23], v[144:147], v[64:67]
    v_mfma_f32_16x16x32_bf16 v[68:71], a[20:23], v[148:151], v[68:71]
    buffer_load_dwordx4 v[192:195], v8, s[8:11], s44 offen
    v_mfma_f32_16x16x32_bf16 v[72:75], a[24:27], v[132:135], v[72:75]
    v_mfma_f32_16x16x32_bf16 v[76:79], a[24:27], v[136:139], v[76:79]
    buffer_load_dwordx4 v[196:199], v9, s[8:11], s44 offen
    v_mfma_f32_16x16x32_bf16 v[80:83], a[24:27], v[140:143], v[80:83]
    v_mfma_f32_16x16x32_bf16 v[84:87], a[24:27], v[144:147], v[84:87]
    buffer_load_dwordx4 v[200:203], v10, s[8:11], s44 offen
    v_mfma_f32_16x16x32_bf16 v[88:91], a[24:27], v[148:151], v[88:91]
    v_mfma_f32_16x16x32_bf16 v[92:95], a[28:31], v[132:135], v[92:95]
    buffer_load_dwordx4 v[204:207], v11, s[8:11], s44 offen
    v_mfma_f32_16x16x32_bf16 v[96:99], a[28:31], v[136:139], v[96:99]
    v_mfma_f32_16x16x32_bf16 v[100:103], a[28:31], v[140:143], v[100:103]
    buffer_load_dwordx4 v[208:211], v12, s[8:11], s44 offen
    v_mfma_f32_16x16x32_bf16 v[104:107], a[28:31], v[144:147], v[104:107]
    v_mfma_f32_16x16x32_bf16 v[108:111], a[28:31], v[148:151], v[108:111]
    s_waitcnt vmcnt(18)
    v_mfma_f32_16x16x32_bf16 v[32:35], a[32:35], v[152:155], v[32:35]
    v_mfma_f32_16x16x32_bf16 v[36:39], a[32:35], v[156:159], v[36:39]
    s_add_u32 s44, s44, 1024
    s_add_u32 s45, s45, 36864
    buffer_load_dwordx4 a[0:3], v13, s[12:15], s45 offen offset:0
    v_mfma_f32_16x16x32_bf16 v[40:43], a[32:35], v[160:163], v[40:43]
    v_mfma_f32_16x16x32_bf16 v[44:47], a[32:35], v[164:167], v[44:47]
    buffer_load_dwordx4 a[4:7], v13, s[12:15], s45 offen offset:1024
    v_mfma_f32_16x16x32_bf16 v[48:51], a[32:35], v[168:171], v[48:51]
    v_mfma_f32_16x16x32_bf16 v[52:55], a[36:39], v[152:155], v[52:55]
    buffer_load_dwordx4 a[8:11], v13, s[12:15], s45 offen offset:2048
    v_mfma_f32_16x16x32_bf16 v[56:59], a[36:39], v[156:159], v[56:59]
    v_mfma_f32_16x16x32_bf16 v[60:63], a[36:39], v[160:163], v[60:63]
    buffer_load_dwordx4 a[12:15], v13, s[12:15], s45 offen offset:3072
    v_mfma_f32_16x16x32_bf16 v[64:67], a[36:39], v[164:167], v[64:67]
    v_mfma_f32_16x16x32_bf16 v[68:71], a[36:39], v[168:171], v[68:71]
    buffer_load_dwordx4 v[112:115], v8, s[8:11], s44 offen
    v_mfma_f32_16x16x32_bf16 v[72:75], a[40:43], v[152:155], v[72:75]
    v_mfma_f32_16x16x32_bf16 v[76:79], a[40:43], v[156:159], v[76:79]
    buffer_load_dwordx4 v[116:119], v9, s[8:11], s44 offen
    v_mfma_f32_16x16x32_bf16 v[80:83], a[40:43], v[160:163], v[80:83]
    v_mfma_f32_16x16x32_bf16 v[84:87], a[40:43], v[164:167], v[84:87]
    buffer_load_dwordx4 v[120:123], v10, s[8:11], s44 offen
    v_mfma_f32_16x16x32_bf16 v[88:91], a[40:43], v[168:171], v[88:91]
    v_mfma_f32_16x16x32_bf16 v[92:95], a[44:47], v[152:155], v[92:95]
    buffer_load_dwordx4 v[124:127], v11, s[8:11], s44 offen
    v_mfma_f32_16x16x32_bf16 v[96:99], a[44:47], v[156:159], v[96:99]
    v_mfma_f32_16x16x32_bf16 v[100:103], a[44:47], v[160:163], v[100:103]
    buffer_load_dwordx4 v[128:131], v12, s[8:11], s44 offen
    v_mfma_f32_16x16x32_bf16 v[104:107], a[44:47], v[164:167], v[104:107]
    v_mfma_f32_16x16x32_bf16 v[108:111], a[44:47], v[168:171], v[108:111]
    s_waitcnt vmcnt(18)
    v_mfma_f32_16x16x32_bf16 v[32:35], a[48:51], v[172:175], v[32:35]
    v_mfma_f32_16x16x32_bf16 v[36:39], a[48:51], v[176:179], v[36:39]
    s_add_u32 s44, s44, 1024
    s_add_u32 s45, s45, 36864
    buffer_load_dwordx4 a[16:19], v13, s[12:15], s45 offen offset:0
    v_mfma_f32_16x16x32_bf16 v[40:43], a[48:51], v[180:183], v[40:43]
    v_mfma_f32_16x16x32_bf16 v[44:47], a[48:51], v[184:187], v[44:47]
    buffer_load_dwordx4 a[20:23], v13, s[12:15], s45 offen offset:1024
    v_mfma_f32_16x16x32_bf16 v[48:51], a[48:51], v[188:191], v[48:51]
    v_mfma_f32_16x16x32_bf16 v[52:55], a[52:55], v[172:175], v[52:55]
    buffer_load_dwordx4 a[24:27], v13, s[12:15], s45 offen offset:2048
    v_mfma_f32_16x16x32_bf16 v[56:59], a[52:55], v[176:179], v[56:59]
    v_mfma_f32_16x16x32_bf16 v[60:63], a[52:55], v[180:183], v[60:63]
    buffer_load_dwordx4 a[28:31], v13, s[12:15], s45 offen offset:3072
    v_mfma_f32_16x16x32_bf16 v[64:67], a[52:55], v[184:187], v[64:67]
    v_mfma_f32_16x16x32_bf16 v[68:71], a[52:55], v[188:191], v[68:71]
    buffer_load_dwordx4 v[132:135], v8, s[8:11], s44 offen
    v_mfma_f32_16x16x32_bf16 v[72:75], a[56:59], v[172:175], v[72:75]
    v_mfma_f32_16x16x32_bf16 v[76:79], a[56:59], v[176:179], v[76:79]
    buffer_load_dwordx4 v[136:139], v9, s[8:11], s44 offen
    v_mfma_f32_16x16x32_bf16 v[80:83], a[56:59], v[180:183], v[80:83]
    v_mfma_f32_16x16x32_bf16 v[84:87], a[56:59], v[184:187], v[84:87]
    buffer_load_dwordx4 v[140:143], v10, s[8:11], s44 offen
    v_mfma_f32_16x16x32_bf16 v[88:91], a[56:59], v[188:191], v[88:91]
    v_mfma_f32_16x16x32_bf16 v[92:95], a[60:63], v[172:175], v[92:95]
    buffer_load_dwordx4 v[144:147], v11, s[8:11], s44 offen
    v_mfma_f32_16x16x32_bf16 v[96:99], a[60:63], v[176:179], v[96:99]
    v_mfma_f32_16x16x32_bf16 v[100:103], a[60:63], v[180:183], v[100:103]
    buffer_load_dwordx4 v[148:151], v12, s[8:11], s44 offen
    v_mfma_f32_16x16x32_bf16 v[104:107], a[60:63], v[184:187], v[104:107]
    v_mfma_f32_16x16x32_bf16 v[108:111], a[60:63], v[188:191], v[108:111]
    s_waitcnt vmcnt(18)
    v_mfma_f32_16x16x32_bf16 v[32:35], a[64:67], v[192:195], v[32:35]
    v_mfma_f32_16x16x32_bf16 v[36:39], a[64:67], v[196:199], v[36:39]
    s_add_u32 s44, s44, 1024
    s_add_u32 s45, s45, 36864
    buffer_load_dwordx4 a[32:35], v13, s[12:15], s45 offen offset:0
    v_mfma_f32_16x16x32_bf16 v[40:43], a[64:67], v[200:203], v[40:43]
    v_mfma_f32_16x16x32_bf16 v[44:47], a[64:67], v[204:207], v[44:47]
    buffer_load_dwordx4 a[36:39], v13, s[12:15], s45 offen offset:1024
    v_mfma_f32_16x16x32_bf16 v[48:51], a[64:67], v[208:211], v[48:51]
    v_mfma_f32_16x16x32_bf16 v[52:55], a[68:71], v[192:195], v[52:55]
    buffer_load_dwordx4 a[40:43], v13, s[12:15], s45 offen offset:2048
    v_mfma_f32_16x16x32_bf16 v[56:59], a[68:71], v[196:199], v[56:59]
    v_mfma_f32_16x16x32_bf16 v[60:63], a[68:71], v[200:203], v[60:63]
    buffer_load_dwordx4 a[44:47], v13, s[12:15], s45 offen offset:3072
    v_mfma_f32_16x16x32_bf16 v[64:67], a[68:71], v[204:207], v[64:67]
    v_mfma_f32_16x16x32_bf16 v[68:71], a[68:71], v[208:211], v[68:71]
    buffer_load_dwordx4 v[152:155], v8, s[8:11], s44 offen
    v_mfma_f32_16x16x32_bf16 v[72:75], a[72:75], v[192:195], v[72:75]
    v_mfma_f32_16x16x32_bf16 v[76:79], a[72:75], v[196:199], v[76:79]
    buffer_load_dwordx4 v[156:159], v9, s[8:11], s44 offen
    v_mfma_f32_16x16x32_bf16 v[80:83], a[72:75], v[200:203], v[80:83]
    v_mfma_f32_16x16x32_bf16 v[84:87], a[72:75], v[204:207], v[84:87]
    buffer_load_dwordx4 v[160:163], v10, s[8:11], s44 offen
    v_mfma_f32_16x16x32_bf16 v[88:91], a[72:75], v[208:211], v[88:91]
    v_mfma_f32_16x16x32_bf16 v[92:95], a[76:79], v[192:195], v[92:95]
    buffer_load_dwordx4 v[164:167], v11, s[8:11], s44 offen
    v_mfma_f32_16x16x32_bf16 v[96:99], a[76:79], v[196:199], v[96:99]
    v_mfma_f32_16x16x32_bf16 v[100:103], a[76:79], v[200:203], v[100:103]
    buffer_load_dwordx4 v[168:171], v12, s[8:11], s44 offen
    v_mfma_f32_16x16x32_bf16 v[104:107], a[76:79], v[204:207], v[104:107]
    v_mfma_f32_16x16x32_bf16 v[108:111], a[76:79], v[208:211], v[108:111]
    s_waitcnt vmcnt(18)
    v_mfma_f32_16x16x32_bf16 v[32:35], a[0:3], v[112:115], v[32:35]
    v_mfma_f32_16x16x32_bf16 v[36:39], a[0:3], v[116:119], v[36:39]
    s_add_u32 s44, s44, 1024
    s_add_u32 s45, s45, 36864
    buffer_load_dwordx4 a[48:51], v13, s[12:15], s45 offen offset:0
    v_mfma_f32_16x16x32_bf16 v[40:43], a[0:3], v[120:123], v[40:43]
    v_mfma_f32_16x16x32_bf16 v[44:47], a[0:3], v[124:127], v[44:47]
    buffer_load_dwordx4 a[52:55], v13, s[12:15], s45 offen offset:1024
    v_mfma_f32_16x16x32_bf16 v[48:51], a[0:3], v[128:131], v[48:51]
    v_mfma_f32_16x16x32_bf16 v[52:55], a[4:7], v[112:115], v[52:55]
    buffer_load_dwordx4 a[56:59], v13, s[12:15], s45 offen offset:2048
    v_mfma_f32_16x16x32_bf16 v[56:59], a[4:7], v[116:119], v[56:59]
    v_mfma_f32_16x16x32_bf16 v[60:63], a[4:7], v[120:123], v[60:63]
    buffer_load_dwordx4 a[60:63], v13, s[12:15], s45 offen offset:3072
    v_mfma_f32_16x16x32_bf16 v[64:67], a[4:7], v[124:127], v[64:67]
    v_mfma_f32_16x16x32_bf16 v[68:71], a[4:7], v[128:131], v[68:71]
    buffer_load_dwordx4 v[172:175], v8, s[8:11], s44 offen
    v_mfma_f32_16x16x32_bf16 v[72:75], a[8:11], v[112:115], v[72:75]
    v_mfma_f32_16x16x32_bf16 v[76:79], a[8:11], v[116:119], v[76:79]
    buffer_load_dwordx4 v[176:179], v9, s[8:11], s44 offen
    v_mfma_f32_16x16x32_bf16 v[80:83], a[8:11], v[120:123], v[80:83]
    v_mfma_f32_16x16x32_bf16 v[84:87], a[8:11], v[124:127], v[84:87]
    buffer_load_dwordx4 v[180:183], v10, s[8:11], s44 offen
    v_mfma_f32_16x16x32_bf16 v[88:91], a[8:11], v[128:131], v[88:91]
    v_mfma_f32_16x16x32_bf16 v[92:95], a[12:15], v[112:115], v[92:95]
    buffer_load_dwordx4 v[184:187], v11, s[8:11], s44 offen
    v_mfma_f32_16x16x32_bf16 v[96:99], a[12:15], v[116:119], v[96:99]
    v_mfma_f32_16x16x32_bf16 v[100:103], a[12:15], v[120:123], v[100:103]
    buffer_load_dwordx4 v[188:191], v12, s[8:11], s44 offen
    v_mfma_f32_16x16x32_bf16 v[104:107], a[12:15], v[124:127], v[104:107]
    v_mfma_f32_16x16x32_bf16 v[108:111], a[12:15], v[128:131], v[108:111]
    s_waitcnt vmcnt(18)
    v_mfma_f32_16x16x32_bf16 v[32:35], a[16:19], v[132:135], v[32:35]
    v_mfma_f32_16x16x32_bf16 v[36:39], a[16:19], v[136:139], v[36:39]
    s_add_u32 s44, s44, 1024
    s_add_u32 s45, s45, 36864
    buffer_load_dwordx4 a[64:67], v13, s[12:15], s45 offen offset:0
    v_mfma_f32_16x16x32_bf16 v[40:43], a[16:19], v[140:143], v[40:43]
    v_mfma_f32_16x16x32_bf16 v[44:47], a[16:19], v[144:147], v[44:47]
    buffer_load_dwordx4 a[68:71], v13, s[12:15], s45 offen offset:1024
    v_mfma_f32_16x16x32_bf16 v[48:51], a[16:19], v[148:151], v[48:51]
    v_mfma_f32_16x16x32_bf16 v[52:55], a[20:23], v[132:135], v[52:55]
    buffer_load_dwordx4 a[72:75], v13, s[12:15], s45 offen offset:2048
    v_mfma_f32_16x16x32_bf16 v[56:59], a[20:23], v[136:139], v[56:59]
    v_mfma_f32_16x16x32_bf16 v[60:63], a[20:23], v[140:143], v[60:63]
    buffer_load_dwordx4 a[76:79], v13, s[12:15], s45 offen offset:3072
    v_mfma_f32_16x16x32_bf16 v[64:67], a[20:23], v[144:147], v[64:67]
    v_mfma_f32_16x16x32_bf16 v[68:71], a[20:23], v[148:151], v[68:71]
    buffer_load_dwordx4 v[192:195], v8, s[8:11], s44 offen
    v_mfma_f32_16x16x32_bf16 v[72:75], a[24:27], v[132:135], v[72:75]
    v_mfma_f32_16x16x32_bf16 v[76:79], a[24:27], v[136:139], v[76:79]
    buffer_load_dwordx4 v[196:199], v9, s[8:11], s44 offen
    v_mfma_f32_16x16x32_bf16 v[80:83], a[24:27], v[140:143], v[80:83]
    v_mfma_f32_16x16x32_bf16 v[84:87], a[24:27], v[144:147], v[84:87]
    buffer_load_dwordx4 v[200:203], v10, s[8:11], s44 offen
    v_mfma_f32_16x16x32_bf16 v[88:91], a[24:27], v[148:151], v[88:91]
    v_mfma_f32_16x16x32_bf16 v[92:95], a[28:31], v[132:135], v[92:95]
    buffer_load_dwordx4 v[204:207], v11, s[8:11], s44 offen
    v_mfma_f32_16x16x32_bf16 v[96:99], a[28:31], v[136:139], v[96:99]
    v_mfma_f32_16x16x32_bf16 v[100:103], a[28:31], v[140:143], v[100:103]
    buffer_load_dwordx4 v[208:211], v12, s[8:11], s44 offen
    v_mfma_f32_16x16x32_bf16 v[104:107], a[28:31], v[144:147], v[104:107]
    v_mfma_f32_16x16x32_bf16 v[108:111], a[28:31], v[148:151], v[108:111]
    s_waitcnt vmcnt(18)
    v_mfma_f32_16x16x32_bf16 v[32:35], a[32:35], v[152:155], v[32:35]
    v_mfma_f32_16x16x32_bf16 v[36:39], a[32:35], v[156:159], v[36:39]
    s_add_u32 s44, s44, 1024
    s_add_u32 s45, s45, 36864
    buffer_load_dwordx4 a[0:3], v13, s[12:15], s45 offen offset:0
    v_mfma_f32_16x16x32_bf16 v[40:43], a[32:35], v[160:163], v[40:43]
    v_mfma_f32_16x16x32_bf16 v[44:47], a[32:35], v[164:167], v[44:47]
    buffer_load_dwordx4 a[4:7], v13, s[12:15], s45 offen offset:1024
    v_mfma_f32_16x16x32_bf16 v[48:51], a[32:35], v[168:171], v[48:51]
    v_mfma_f32_16x16x32_bf16 v[52:55], a[36:39], v[152:155], v[52:55]
    buffer_load_dwordx4 a[8:11], v13, s[12:15], s45 offen offset:2048
    v_mfma_f32_16x16x32_bf16 v[56:59], a[36:39], v[156:159], v[56:59]
    v_mfma_f32_16x16x32_bf16 v[60:63], a[36:39], v[160:163], v[60:63]
    buffer_load_dwordx4 a[12:15], v13, s[12:15], s45 offen offset:3072
    v_mfma_f32_16x16x32_bf16 v[64:67], a[36:39], v[164:167], v[64:67]
    v_mfma_f32_16x16x32_bf16 v[68:71], a[36:39], v[168:171], v[68:71]
    buffer_load_dwordx4 v[112:115], v8, s[8:11], s44 offen
    v_mfma_f32_16x16x32_bf16 v[72:75], a[40:43], v[152:155], v[72:75]
    v_mfma_f32_16x16x32_bf16 v[76:79], a[40:43], v[156:159], v[76:79]
    buffer_load_dwordx4 v[116:119], v9, s[8:11], s44 offen
    v_mfma_f32_16x16x32_bf16 v[80:83], a[40:43], v[160:163], v[80:83]
    v_mfma_f32_16x16x32_bf16 v[84:87], a[40:43], v[164:167], v[84:87]
    buffer_load_dwordx4 v[120:123], v10, s[8:11], s44 offen
    v_mfma_f32_16x16x32_bf16 v[88:91], a[40:43], v[168:171], v[88:91]
    v_mfma_f32_16x16x32_bf16 v[92:95], a[44:47], v[152:155], v[92:95]
    buffer_load_dwordx4 v[124:127], v11, s[8:11], s44 offen
    v_mfma_f32_16x16x32_bf16 v[96:99], a[44:47], v[156:159], v[96:99]
    v_mfma_f32_16x16x32_bf16 v[100:103], a[44:47], v[160:163], v[100:103]
    buffer_load_dwordx4 v[128:131], v12, s[8:11], s44 offen
    v_mfma_f32_16x16x32_bf16 v[104:107], a[44:47], v[164:167], v[104:107]
    v_mfma_f32_16x16x32_bf16 v[108:111], a[44:47], v[168:171], v[108:111]
    s_waitcnt vmcnt(18)
    v_mfma_f32_16x16x32_bf16 v[32:35], a[48:51], v[172:175], v[32:35]
    v_mfma_f32_16x16x32_bf16 v[36:39], a[48:51], v[176:179], v[36:39]
    s_add_u32 s44, s44, 1024
    s_add_u32 s45, s45, 36864
    buffer_load_dwordx4 a[16:19], v13, s[12:15], s45 offen offset:0
    v_mfma_f32_16x16x32_bf16 v[40:43], a[48:51], v[180:183], v[40:43]
    v_mfma_f32_16x16x32_bf16 v[44:47], a[48:51], v[184:187], v[44:47]
    buffer_load_dwordx4 a[20:23], v13, s[12:15], s45 offen offset:1024
    v_mfma_f32_16x16x32_bf16 v[48:51], a[48:51], v[188:191], v[48:51]
    v_mfma_f32_16x16x32_bf16 v[52:55], a[52:55], v[172:175], v[52:55]
    buffer_load_dwordx4 a[24:27], v13, s[12:15], s45 offen offset:2048
    v_mfma_f32_16x16x32_bf16 v[56:59], a[52:55], v[176:179], v[56:59]
    v_mfma_f32_16x16x32_bf16 v[60:63], a[52:55], v[180:183], v[60:63]
    buffer_load_dwordx4 a[28:31], v13, s[12:15], s45 offen offset:3072
    v_mfma_f32_16x16x32_bf16 v[64:67], a[52:55], v[184:187], v[64:67]
    v_mfma_f32_16x16x32_bf16 v[68:71], a[52:55], v[188:191], v[68:71]
    buffer_load_dwordx4 v[132:135], v8, s[8:11], s44 offen
    v_mfma_f32_16x16x32_bf16 v[72:75], a[56:59], v[172:175], v[72:75]
    v_mfma_f32_16x16x32_bf16 v[76:79], a[56:59], v[176:179], v[76:79]
    buffer_load_dwordx4 v[136:139], v9, s[8:11], s44 offen
    v_mfma_f32_16x16x32_bf16 v[80:83], a[56:59], v[180:183], v[80:83]
    v_mfma_f32_16x16x32_bf16 v[84:87], a[56:59], v[184:187], v[84:87]
    buffer_load_dwordx4 v[140:143], v10, s[8:11], s44 offen
    v_mfma_f32_16x16x32_bf16 v[88:91], a[56:59], v[188:191], v[88:91]
    v_mfma_f32_16x16x32_bf16 v[92:95], a[60:63], v[172:175], v[92:95]
    buffer_load_dwordx4 v[144:147], v11, s[8:11], s44 offen
    v_mfma_f32_16x16x32_bf16 v[96:99], a[60:63], v[176:179], v[96:99]
    v_mfma_f32_16x16x32_bf16 v[100:103], a[60:63], v[180:183], v[100:103]
    buffer_load_dwordx4 v[148:151], v12, s[8:11], s44 offen
    v_mfma_f32_16x16x32_bf16 v[104:107], a[60:63], v[184:187], v[104:107]
    v_mfma_f32_16x16x32_bf16 v[108:111], a[60:63], v[188:191], v[108:111]
    s_waitcnt vmcnt(18)
    v_mfma_f32_16x16x32_bf16 v[32:35], a[64:67], v[192:195], v[32:35]
    v_mfma_f32_16x16x32_bf16 v[36:39], a[64:67], v[196:199], v[36:39]
    s_add_u32 s44, s44, 1024
    s_add_u32 s45, s45, 36864
    buffer_load_dwordx4 a[32:35], v13, s[12:15], s45 offen offset:0
    v_mfma_f32_16x16x32_bf16 v[40:43], a[64:67], v[200:203], v[40:43]
    v_mfma_f32_16x16x32_bf16 v[44:47], a[64:67], v[204:207], v[44:47]
    buffer_load_dwordx4 a[36:39], v13, s[12:15], s45 offen offset:1024
    v_mfma_f32_16x16x32_bf16 v[48:51], a[64:67], v[208:211], v[48:51]
    v_mfma_f32_16x16x32_bf16 v[52:55], a[68:71], v[192:195], v[52:55]
    buffer_load_dwordx4 a[40:43], v13, s[12:15], s45 offen offset:2048
    v_mfma_f32_16x16x32_bf16 v[56:59], a[68:71], v[196:199], v[56:59]
    v_mfma_f32_16x16x32_bf16 v[60:63], a[68:71], v[200:203], v[60:63]
    buffer_load_dwordx4 a[44:47], v13, s[12:15], s45 offen offset:3072
    v_mfma_f32_16x16x32_bf16 v[64:67], a[68:71], v[204:207], v[64:67]
    v_mfma_f32_16x16x32_bf16 v[68:71], a[68:71], v[208:211], v[68:71]
    buffer_load_dwordx4 v[152:155], v8, s[8:11], s44 offen
    v_mfma_f32_16x16x32_bf16 v[72:75], a[72:75], v[192:195], v[72:75]
    v_mfma_f32_16x16x32_bf16 v[76:79], a[72:75], v[196:199], v[76:79]
    buffer_load_dwordx4 v[156:159], v9, s[8:11], s44 offen
    v_mfma_f32_16x16x32_bf16 v[80:83], a[72:75], v[200:203], v[80:83]
    v_mfma_f32_16x16x32_bf16 v[84:87], a[72:75], v[204:207], v[84:87]
    buffer_load_dwordx4 v[160:163], v10, s[8:11], s44 offen
    v_mfma_f32_16x16x32_bf16 v[88:91], a[72:75], v[208:211], v[88:91]
    v_mfma_f32_16x16x32_bf16 v[92:95], a[76:79], v[192:195], v[92:95]
    buffer_load_dwordx4 v[164:167], v11, s[8:11], s44 offen
    v_mfma_f32_16x16x32_bf16 v[96:99], a[76:79], v[196:199], v[96:99]
    v_mfma_f32_16x16x32_bf16 v[100:103], a[76:79], v[200:203], v[100:103]
    buffer_load_dwordx4 v[168:171], v12, s[8:11], s44 offen
    v_mfma_f32_16x16x32_bf16 v[104:107], a[76:79], v[204:207], v[104:107]
    v_mfma_f32_16x16x32_bf16 v[108:111], a[76:79], v[208:211], v[108:111]
    s_waitcnt vmcnt(18)
    v_mfma_f32_16x16x32_bf16 v[32:35], a[0:3], v[112:115], v[32:35]
    v_mfma_f32_16x16x32_bf16 v[36:39], a[0:3], v[116:119], v[36:39]
    s_lshl_b32 s44, s40, 12
    s_add_u32 s44, s44, 73728
    s_mul_i32 s45, s44, 36
    buffer_load_dwordx4 a[48:51], v13, s[12:15], s45 offen offset:0
    v_mfma_f32_16x16x32_bf16 v[40:43], a[0:3], v[120:123], v[40:43]
    v_mfma_f32_16x16x32_bf16 v[44:47], a[0:3], v[124:127], v[44:47]
    buffer_load_dwordx4 a[52:55], v13, s[12:15], s45 offen offset:1024
    v_mfma_f32_16x16x32_bf16 v[48:51], a[0:3], v[128:131], v[48:51]
    v_mfma_f32_16x16x32_bf16 v[52:55], a[4:7], v[112:115], v[52:55]
    buffer_load_dwordx4 a[56:59], v13, s[12:15], s45 offen offset:2048
    v_mfma_f32_16x16x32_bf16 v[56:59], a[4:7], v[116:119], v[56:59]
    v_mfma_f32_16x16x32_bf16 v[60:63], a[4:7], v[120:123], v[60:63]
    buffer_load_dwordx4 a[60:63], v13, s[12:15], s45 offen offset:3072
    v_mfma_f32_16x16x32_bf16 v[64:67], a[4:7], v[124:127], v[64:67]
    v_mfma_f32_16x16x32_bf16 v[68:71], a[4:7], v[128:131], v[68:71]
    buffer_load_dwordx4 v[172:175], v8, s[8:11], s44 offen
    v_mfma_f32_16x16x32_bf16 v[72:75], a[8:11], v[112:115], v[72:75]
    v_mfma_f32_16x16x32_bf16 v[76:79], a[8:11], v[116:119], v[76:79]
    buffer_load_dwordx4 v[176:179], v9, s[8:11], s44 offen
    v_mfma_f32_16x16x32_bf16 v[80:83], a[8:11], v[120:123], v[80:83]
    v_mfma_f32_16x16x32_bf16 v[84:87], a[8:11], v[124:127], v[84:87]
    buffer_load_dwordx4 v[180:183], v10, s[8:11], s44 offen
    v_mfma_f32_16x16x32_bf16 v[88:91], a[8:11], v[128:131], v[88:91]
    v_mfma_f32_16x16x32_bf16 v[92:95], a[12:15], v[112:115], v[92:95]
    buffer_load_dwordx4 v[184:187], v11, s[8:11], s44 offen
    v_mfma_f32_16x16x32_bf16 v[96:99], a[12:15], v[116:119], v[96:99]
    v_mfma_f32_16x16x32_bf16 v[100:103], a[12:15], v[120:123], v[100:103]
    buffer_load_dwordx4 v[188:191], v12, s[8:11], s44 offen
    v_mfma_f32_16x16x32_bf16 v[104:107], a[12:15], v[124:127], v[104:107]
    v_mfma_f32_16x16x32_bf16 v[108:111], a[12:15], v[128:131], v[108:111]
    s_waitcnt vmcnt(18)
    v_mfma_f32_16x16x32_bf16 v[32:35], a[16:19], v[132:135], v[32:35]
    v_mfma_f32_16x16x32_bf16 v[36:39], a[16:19], v[136:139], v[36:39]
    s_lshl_b32 s44, s40, 12
    s_add_u32 s44, s44, 74752
    s_mul_i32 s45, s44, 36
    buffer_load_dwordx4 a[64:67], v13, s[12:15], s45 offen offset:0
    v_mfma_f32_16x16x32_bf16 v[40:43], a[16:19], v[140:143], v[40:43]
    v_mfma_f32_16x16x32_bf16 v[44:47], a[16:19], v[144:147], v[44:47]
    buffer_load_dwordx4 a[68:71], v13, s[12:15], s45 offen offset:1024
    v_mfma_f32_16x16x32_bf16 v[48:51], a[16:19], v[148:151], v[48:51]
    v_mfma_f32_16x16x32_bf16 v[52:55], a[20:23], v[132:135], v[52:55]
    buffer_load_dwordx4 a[72:75], v13, s[12:15], s45 offen offset:2048
    v_mfma_f32_16x16x32_bf16 v[56:59], a[20:23], v[136:139], v[56:59]
    v_mfma_f32_16x16x32_bf16 v[60:63], a[20:23], v[140:143], v[60:63]
    buffer_load_dwordx4 a[76:79], v13, s[12:15], s45 offen offset:3072
    v_mfma_f32_16x16x32_bf16 v[64:67], a[20:23], v[144:147], v[64:67]
    v_mfma_f32_16x16x32_bf16 v[68:71], a[20:23], v[148:151], v[68:71]
    buffer_load_dwordx4 v[192:195], v8, s[8:11], s44 offen
    v_mfma_f32_16x16x32_bf16 v[72:75], a[24:27], v[132:135], v[72:75]
    v_mfma_f32_16x16x32_bf16 v[76:79], a[24:27], v[136:139], v[76:79]
    buffer_load_dwordx4 v[196:199], v9, s[8:11], s44 offen
    v_mfma_f32_16x16x32_bf16 v[80:83], a[24:27], v[140:143], v[80:83]
    v_mfma_f32_16x16x32_bf16 v[84:87], a[24:27], v[144:147], v[84:87]
    buffer_load_dwordx4 v[200:203], v10, s[8:11], s44 offen
    v_mfma_f32_16x16x32_bf16 v[88:91], a[24:27], v[148:151], v[88:91]
    v_mfma_f32_16x16x32_bf16 v[92:95], a[28:31], v[132:135], v[92:95]
    buffer_load_dwordx4 v[204:207], v11, s[8:11], s44 offen
    v_mfma_f32_16x16x32_bf16 v[96:99], a[28:31], v[136:139], v[96:99]
    v_mfma_f32_16x16x32_bf16 v[100:103], a[28:31], v[140:143], v[100:103]
    buffer_load_dwordx4 v[208:211], v12, s[8:11], s44 offen
    v_mfma_f32_16x16x32_bf16 v[104:107], a[28:31], v[144:147], v[104:107]
    v_mfma_f32_16x16x32_bf16 v[108:111], a[28:31], v[148:151], v[108:111]
    s_waitcnt vmcnt(18)
    v_mfma_f32_16x16x32_bf16 v[32:35], a[32:35], v[152:155], v[32:35]
    v_mfma_f32_16x16x32_bf16 v[36:39], a[32:35], v[156:159], v[36:39]
    s_lshl_b32 s44, s40, 12
    s_add_u32 s44, s44, 75776
    s_mul_i32 s45, s44, 36
    buffer_load_dwordx4 a[0:3], v13, s[12:15], s45 offen offset:0
    v_mfma_f32_16x16x32_bf16 v[40:43], a[32:35], v[160:163], v[40:43]
    v_mfma_f32_16x16x32_bf16 v[44:47], a[32:35], v[164:167], v[44:47]
    buffer_load_dwordx4 a[4:7], v13, s[12:15], s45 offen offset:1024
    v_mfma_f32_16x16x32_bf16 v[48:51], a[32:35], v[168:171], v[48:51]
    v_mfma_f32_16x16x32_bf16 v[52:55], a[36:39], v[152:155], v[52:55]
    buffer_load_dwordx4 a[8:11], v13, s[12:15], s45 offen offset:2048
    v_mfma_f32_16x16x32_bf16 v[56:59], a[36:39], v[156:159], v[56:59]
    v_mfma_f32_16x16x32_bf16 v[60:63], a[36:39], v[160:163], v[60:63]
    buffer_load_dwordx4 a[12:15], v13, s[12:15], s45 offen offset:3072
    v_mfma_f32_16x16x32_bf16 v[64:67], a[36:39], v[164:167], v[64:67]
    v_mfma_f32_16x16x32_bf16 v[68:71], a[36:39], v[168:171], v[68:71]
    buffer_load_dwordx4 v[112:115], v8, s[8:11], s44 offen
    v_mfma_f32_16x16x32_bf16 v[72:75], a[40:43], v[152:155], v[72:75]
    v_mfma_f32_16x16x32_bf16 v[76:79], a[40:43], v[156:159], v[76:79]
    buffer_load_dwordx4 v[116:119], v9, s[8:11], s44 offen
    v_mfma_f32_16x16x32_bf16 v[80:83], a[40:43], v[160:163], v[80:83]
    v_mfma_f32_16x16x32_bf16 v[84:87], a[40:43], v[164:167], v[84:87]
    buffer_load_dwordx4 v[120:123], v10, s[8:11], s44 offen
    v_mfma_f32_16x16x32_bf16 v[88:91], a[40:43], v[168:171], v[88:91]
    v_mfma_f32_16x16x32_bf16 v[92:95], a[44:47], v[152:155], v[92:95]
    buffer_load_dwordx4 v[124:127], v11, s[8:11], s44 offen
    v_mfma_f32_16x16x32_bf16 v[96:99], a[44:47], v[156:159], v[96:99]
    v_mfma_f32_16x16x32_bf16 v[100:103], a[44:47], v[160:163], v[100:103]
    buffer_load_dwordx4 v[128:131], v12, s[8:11], s44 offen
    v_mfma_f32_16x16x32_bf16 v[104:107], a[44:47], v[164:167], v[104:107]
    v_mfma_f32_16x16x32_bf16 v[108:111], a[44:47], v[168:171], v[108:111]
    s_waitcnt vmcnt(18)
    v_mfma_f32_16x16x32_bf16 v[32:35], a[48:51], v[172:175], v[32:35]
    v_mfma_f32_16x16x32_bf16 v[36:39], a[48:51], v[176:179], v[36:39]
    s_lshl_b32 s44, s40, 12
    s_add_u32 s44, s44, 76800
    s_mul_i32 s45, s44, 36
    buffer_load_dwordx4 a[16:19], v13, s[12:15], s45 offen offset:0
    v_mfma_f32_16x16x32_bf16 v[40:43], a[48:51], v[180:183], v[40:43]
    v_mfma_f32_16x16x32_bf16 v[44:47], a[48:51], v[184:187], v[44:47]
    buffer_load_dwordx4 a[20:23], v13, s[12:15], s45 offen offset:1024
    v_mfma_f32_16x16x32_bf16 v[48:51], a[48:51], v[188:191], v[48:51]
    v_mfma_f32_16x16x32_bf16 v[52:55], a[52:55], v[172:175], v[52:55]
    buffer_load_dwordx4 a[24:27], v13, s[12:15], s45 offen offset:2048
    v_mfma_f32_16x16x32_bf16 v[56:59], a[52:55], v[176:179], v[56:59]
    v_mfma_f32_16x16x32_bf16 v[60:63], a[52:55], v[180:183], v[60:63]
    buffer_load_dwordx4 a[28:31], v13, s[12:15], s45 offen offset:3072
    v_mfma_f32_16x16x32_bf16 v[64:67], a[52:55], v[184:187], v[64:67]
    v_mfma_f32_16x16x32_bf16 v[68:71], a[52:55], v[188:191], v[68:71]
    buffer_load_dwordx4 v[132:135], v8, s[8:11], s44 offen
    v_mfma_f32_16x16x32_bf16 v[72:75], a[56:59], v[172:175], v[72:75]
    v_mfma_f32_16x16x32_bf16 v[76:79], a[56:59], v[176:179], v[76:79]
    buffer_load_dwordx4 v[136:139], v9, s[8:11], s44 offen
    v_mfma_f32_16x16x32_bf16 v[80:83], a[56:59], v[180:183], v[80:83]
    v_mfma_f32_16x16x32_bf16 v[84:87], a[56:59], v[184:187], v[84:87]
    buffer_load_dwordx4 v[140:143], v10, s[8:11], s44 offen
    v_mfma_f32_16x16x32_bf16 v[88:91], a[56:59], v[188:191], v[88:91]
    v_mfma_f32_16x16x32_bf16 v[92:95], a[60:63], v[172:175], v[92:95]
    buffer_load_dwordx4 v[144:147], v11, s[8:11], s44 offen
    v_mfma_f32_16x16x32_bf16 v[96:99], a[60:63], v[176:179], v[96:99]
    v_mfma_f32_16x16x32_bf16 v[100:103], a[60:63], v[180:183], v[100:103]
    buffer_load_dwordx4 v[148:151], v12, s[8:11], s44 offen
    v_mfma_f32_16x16x32_bf16 v[104:107], a[60:63], v[184:187], v[104:107]
    v_mfma_f32_16x16x32_bf16 v[108:111], a[60:63], v[188:191], v[108:111]
    s_waitcnt vmcnt(18)
    s_cmp_ge_u32 s40, 2
    s_cbranch_scc1 L3_nol
    s_lshl_b32 s44, s40, 10
    s_add_u32 s44, s44, 90112
    s_mul_i32 s45, s44, 36
    buffer_load_dwordx4 a[32:35], v13, s[12:15], s45 offen offset:0
    buffer_load_dwordx4 a[36:39], v13, s[12:15], s45 offen offset:1024
    buffer_load_dwordx4 a[40:43], v13, s[12:15], s45 offen offset:2048
    buffer_load_dwordx4 a[44:47], v13, s[12:15], s45 offen offset:3072
    buffer_load_dwordx4 v[152:155], v8, s[8:11], s44 offen
    buffer_load_dwordx4 v[156:159], v9, s[8:11], s44 offen
    buffer_load_dwordx4 v[160:163], v10, s[8:11], s44 offen
    buffer_load_dwordx4 v[164:167], v11, s[8:11], s44 offen
    buffer_load_dwordx4 v[168:171], v12, s[8:11], s44 offen
L3_nol:
    v_mfma_f32_16x16x32_bf16 v[32:35], a[64:67], v[192:195], v[32:35]
    v_mfma_f32_16x16x32_bf16 v[36:39], a[64:67], v[196:199], v[36:39]
    v_mfma_f32_16x16x32_bf16 v[40:43], a[64:67], v[200:203], v[40:43]
    v_mfma_f32_16x16x32_bf16 v[44:47], a[64:67], v[204:207], v[44:47]
    v_mfma_f32_16x16x32_bf16 v[48:51], a[64:67], v[208:211], v[48:51]
    v_mfma_f32_16x16x32_bf16 v[52:55], a[68:71], v[192:195], v[52:55]
    v_mfma_f32_16x16x32_bf16 v[56:59], a[68:71], v[196:199], v[56:59]
    v_mfma_f32_16x16x32_bf16 v[60:63], a[68:71], v[200:203], v[60:63]
    v_mfma_f32_16x16x32_bf16 v[64:67], a[68:71], v[204:207], v[64:67]
    v_mfma_f32_16x16x32_bf16 v[68:71], a[68:71], v[208:211], v[68:71]
    v_mfma_f32_16x16x32_bf16 v[72:75], a[72:75], v[192:195], v[72:75]
    v_mfma_f32_16x16x32_bf16 v[76:79], a[72:75], v[196:199], v[76:79]
    v_mfma_f32_16x16x32_bf16 v[80:83], a[72:75], v[200:203], v[80:83]
    v_mfma_f32_16x16x32_bf16 v[84:87], a[72:75], v[204:207], v[84:87]
    v_mfma_f32_16x16x32_bf16 v[88:91], a[72:75], v[208:211], v[88:91]
    v_mfma_f32_16x16x32_bf16 v[92:95], a[76:79], v[192:195], v[92:95]
    v_mfma_f32_16x16x32_bf16 v[96:99], a[76:79], v[196:199], v[96:99]
    v_mfma_f32_16x16x32_bf16 v[100:103], a[76:79], v[200:203], v[100:103]
    v_mfma_f32_16x16x32_bf16 v[104:107], a[76:79], v[204:207], v[104:107]
    v_mfma_f32_16x16x32_bf16 v[108:111], a[76:79], v[208:211], v[108:111]
    s_waitcnt vmcnt(9)
    v_mfma_f32_16x16x32_bf16 v[32:35], a[0:3], v[112:115], v[32:35]
    v_mfma_f32_16x16x32_bf16 v[36:39], a[0:3], v[116:119], v[36:39]
    v_mfma_f32_16x16x32_bf16 v[40:43], a[0:3], v[120:123], v[40:43]
    v_mfma_f32_16x16x32_bf16 v[44:47], a[0:3], v[124:127], v[44:47]
    v_mfma_f32_16x16x32_bf16 v[48:51], a[0:3], v[128:131], v[48:51]
    v_mfma_f32_16x16x32_bf16 v[52:55], a[4:7], v[112:115], v[52:55]
    v_mfma_f32_16x16x32_bf16 v[56:59], a[4:7], v[116:119], v[56:59]
    v_mfma_f32_16x16x32_bf16 v[60:63], a[4:7], v[120:123], v[60:63]
    v_mfma_f32_16x16x32_bf16 v[64:67], a[4:7], v[124:127], v[64:67]
    v_mfma_f32_16x16x32_bf16 v[68:71], a[4:7], v[128:131], v[68:71]
    v_mfma_f32_16x16x32_bf16 v[72:75], a[8:11], v[112:115], v[72:75]
    v_mfma_f32_16x16x32_bf16 v[76:79], a[8:11], v[116:119], v[76:79]
    v_mfma_f32_16x16x32_bf16 v[80:83], a[8:11], v[120:123], v[80:83]
    v_mfma_f32_16x16x32_bf16 v[84:87], a[8:11], v[124:127], v[84:87]
    v_mfma_f32_16x16x32_bf16 v[88:91], a[8:11], v[128:131], v[88:91]
    v_mfma_f32_16x16x32_bf16 v[92:95], a[12:15], v[112:115], v[92:95]
    v_mfma_f32_16x16x32_bf16 v[96:99], a[12:15], v[116:119], v[96:99]
    v_mfma_f32_16x16x32_bf16 v[100:103], a[12:15], v[120:123], v[100:103]
    v_mfma_f32_16x16x32_bf16 v[104:107], a[12:15], v[124:127], v[104:107]
    v_mfma_f32_16x16x32_bf16 v[108:111], a[12:15], v[128:131], v[108:111]
    s_cmp_ge_u32 s40, 2
    s_cbranch_scc1 L3_short
    s_waitcnt vmcnt(9)
    v_mfma_f32_16x16x32_bf16 v[32:35], a[16:19], v[132:135], v[32:35]
    v_mfma_f32_16x16x32_bf16 v[36:39], a[16:19], v[136:139], v[36:39]
    v_mfma_f32_16x16x32_bf16 v[40:43], a[16:19], v[140:143], v[40:43]
    v_mfma_f32_16x16x32_bf16 v[44:47], a[16:19], v[144:147], v[44:47]
    v_mfma_f32_16x16x32_bf16 v[48:51], a[16:19], v[148:151], v[48:51]
    v_mfma_f32_16x16x32_bf16 v[52:55], a[20:23], v[132:135], v[52:55]
    v_mfma_f32_16x16x32_bf16 v[56:59], a[20:23], v[136:139], v[56:59]
    v_mfma_f32_16x16x32_bf16 v[60:63], a[20:23], v[140:143], v[60:63]
    v_mfma_f32_16x16x32_bf16 v[64:67], a[20:23], v[144:147], v[64:67]
    v_mfma_f32_16x16x32_bf16 v[68:71], a[20:23], v[148:151], v[68:71]
    v_mfma_f32_16x16x32_bf16 v[72:75], a[24:27], v[132:135], v[72:75]
    v_mfma_f32_16x16x32_bf16 v[76:79], a[24:27], v[136:139], v[76:79]
    v_mfma_f32_16x16x32_bf16 v[80:83], a[24:27], v[140:143], v[80:83]
    v_mfma_f32_16x16x32_bf16 v[84:87], a[24:27], v[144:147], v[84:87]
    v_mfma_f32_16x16x32_bf16 v[88:91], a[24:27], v[148:151], v[88:91]
    v_mfma_f32_16x16x32_bf16 v[92:95], a[28:31], v[132:135], v[92:95]
    v_mfma_f32_16x16x32_bf16 v[96:99], a[28:31], v[136:139], v[96:99]
    v_mfma_f32_16x16x32_bf16 v[100:103], a[28:31], v[140:143], v[100:103]
    v_mfma_f32_16x16x32_bf16 v[104:107], a[28:31], v[144:147], v[104:107]
    v_mfma_f32_16x16x32_bf16 v[108:111], a[28:31], v[148:151], v[108:111]
    s_waitcnt vmcnt(0)
    v_mfma_f32_16x16x32_bf16 v[32:35], a[32:35], v[152:155], v[32:35]
    v_mfma_f32_16x16x32_bf16 v[36:39], a[32:35], v[156:159], v[36:39]
    v_mfma_f32_16x16x32_bf16 v[40:43], a[32:35], v[160:163], v[40:43]
    v_mfma_f32_16x16x32_bf16 v[44:47], a[32:35], v[164:167], v[44:47]
    v_mfma_f32_16x16x32_bf16 v[48:51], a[32:35], v[168:171], v[48:51]
    v_mfma_f32_16x16x32_bf16 v[52:55], a[36:39], v[152:155], v[52:55]
    v_mfma_f32_16x16x32_bf16 v[56:59], a[36:39], v[156:159], v[56:59]
    v_mfma_f32_16x16x32_bf16 v[60:63], a[36:39], v[160:163], v[60:63]
    v_mfma_f32_16x16x32_bf16 v[64:67], a[36:39], v[164:167], v[64:67]
    v_mfma_f32_16x16x32_bf16 v[68:71], a[36:39], v[168:171], v[68:71]
    ds_write_b128 v17, v[32:35] offset:0
    v_mfma_f32_16x16x32_bf16 v[72:75], a[40:43], v[152:155], v[72:75]
    v_mfma_f32_16x16x32_bf16 v[76:79], a[40:43], v[156:159], v[76:79]
    ds_write_b128 v17, v[36:39] offset:4352
    v_mfma_f32_16x16x32_bf16 v[80:83], a[40:43], v[160:163], v[80:83]
    v_mfma_f32_16x16x32_bf16 v[84:87], a[40:43], v[164:167], v[84:87]
    ds_write_b128 v17, v[40:43] offset:8704
    v_mfma_f32_16x16x32_bf16 v[88:91], a[40:43], v[168:171], v[88:91]
    v_mfma_f32_16x16x32_bf16 v[92:95], a[44:47], v[152:155], v[92:95]
    ds_write_b128 v17, v[44:47] offset:13056
    v_mfma_f32_16x16x32_bf16 v[96:99], a[44:47], v[156:159], v[96:99]
    v_mfma_f32_16x16x32_bf16 v[100:103], a[44:47], v[160:163], v[100:103]
    ds_write_b128 v17, v[48:51] offset:17408
    v_mfma_f32_16x16x32_bf16 v[104:107], a[44:47], v[164:167], v[104:107]
    v_mfma_f32_16x16x32_bf16 v[108:111], a[44:47], v[168:171], v[108:111]
    ds_write_b128 v17, v[52:55] offset:64
    ds_write_b128 v17, v[56:59] offset:4416
    ds_write_b128 v17, v[60:63] offset:8768
    ds_write_b128 v17, v[64:67] offset:13120
    ds_write_b128 v17, v[68:71] offset:17472
    ds_write_b128 v17, v[72:75] offset:128
    ds_write_b128 v17, v[76:79] offset:4480
    ds_write_b128 v17, v[80:83] offset:8832
    ds_write_b128 v17, v[84:87] offset:13184
    ds_write_b128 v17, v[88:91] offset:17536
    ds_write_b128 v17, v[92:95] offset:192
    ds_write_b128 v17, v[96:99] offset:4544
    ds_write_b128 v17, v[100:103] offset:8896
    ds_write_b128 v17, v[104:107] offset:13248
    ds_write_b128 v17, v[108:111] offset:17600
    s_branch L3_red
L3_short:
    s_waitcnt vmcnt(0)
    v_mfma_f32_16x16x32_bf16 v[32:35], a[16:19], v[132:135], v[32:35]
    v_mfma_f32_16x16x32_bf16 v[36:39], a[16:19], v[136:139], v[36:39]
    v_mfma_f32_16x16x32_bf16 v[40:43], a[16:19], v[140:143], v[40:43]
    v_mfma_f32_16x16x32_bf16 v[44:47], a[16:19], v[144:147], v[44:47]
    v_mfma_f32_16x16x32_bf16 v[48:51], a[16:19], v[148:151], v[48:51]
    v_mfma_f32_16x16x32_bf16 v[52:55], a[20:23], v[132:135], v[52:55]
    v_mfma_f32_16x16x32_bf16 v[56:59], a[20:23], v[136:139], v[56:59]
    v_mfma_f32_16x16x32_bf16 v[60:63], a[20:23], v[140:143], v[60:63]
    v_mfma_f32_16x16x32_bf16 v[64:67], a[20:23], v[144:147], v[64:67]
    v_mfma_f32_16x16x32_bf16 v[68:71], a[20:23], v[148:151], v[68:71]
    ds_write_b128 v17, v[32:35] offset:0
    v_mfma_f32_16x16x32_bf16 v[72:75], a[24:27], v[132:135], v[72:75]
    v_mfma_f32_16x16x32_bf16 v[76:79], a[24:27], v[136:139], v[76:79]
    ds_write_b128 v17, v[36:39] offset:4352
    v_mfma_f32_16x16x32_bf16 v[80:83], a[24:27], v[140:143], v[80:83]
    v_mfma_f32_16x16x32_bf16 v[84:87], a[24:27], v[144:147], v[84:87]
    ds_write_b128 v17, v[40:43] offset:8704
    v_mfma_f32_16x16x32_bf16 v[88:91], a[24:27], v[148:151], v[88:91]
    v_mfma_f32_16x16x32_bf16 v[92:95], a[28:31], v[132:135], v[92:95]
    ds_write_b128 v17, v[44:47] offset:13056
    v_mfma_f32_16x16x32_bf16 v[96:99], a[28:31], v[136:139], v[96:99]
    v_mfma_f32_16x16x32_bf16 v[100:103], a[28:31], v[140:143], v[100:103]
    ds_write_b128 v17, v[48:51] offset:17408
    v_mfma_f32_16x16x32_bf16 v[104:107], a[28:31], v[144:147], v[104:107]
    v_mfma_f32_16x16x32_bf16 v[108:111], a[28:31], v[148:151], v[108:111]
    ds_write_b128 v17, v[52:55] offset:64
    ds_write_b128 v17, v[56:59] offset:4416
    ds_write_b128 v17, v[60:63] offset:8768
    ds_write_b128 v17, v[64:67] offset:13120
    ds_write_b128 v17, v[68:71] offset:17472
    ds_write_b128 v17, v[72:75] offset:128
    ds_write_b128 v17, v[76:79] offset:4480
    ds_write_b128 v17, v[80:83] offset:8832
    ds_write_b128 v17, v[84:87] offset:13184
    ds_write_b128 v17, v[88:91] offset:17536
    ds_write_b128 v17, v[92:95] offset:192
    ds_write_b128 v17, v[96:99] offset:4544
    ds_write_b128 v17, v[100:103] offset:8896
    ds_write_b128 v17, v[104:107] offset:13248
    ds_write_b128 v17, v[108:111] offset:17600
L3_red:
    v_add_u32 v4, 43520, v18
    s_waitcnt lgkmcnt(0)
    s_barrier
    ds_read_b128 v[112:115], v18 offset:0
    ds_read_b128 v[116:119], v18 offset:16
    ds_read_b128 v[120:123], v18 offset:21760
    ds_read_b128 v[124:127], v18 offset:21776
    ds_read_b128 v[128:131], v4 offset:0
    ds_read_b128 v[132:135], v4 offset:16
    ds_read_b128 v[136:139], v4 offset:21760
    ds_read_b128 v[140:143], v4 offset:21776
    ds_read_b128 v[144:147], v18 offset:8704
    ds_read_b128 v[148:151], v18 offset:8720
    ds_read_b128 v[152:155], v18 offset:30464
    ds_read_b128 v[156:159], v18 offset:30480
    ds_read_b128 v[160:163], v4 offset:8704
    ds_read_b128 v[164:167], v4 offset:8720
    ds_read_b128 v[168:171], v4 offset:30464
    ds_read_b128 v[172:175], v4 offset:30480
    s_cmp_ge_u32 s40, 2
    s_cbranch_scc1 L3_two
    s_waitcnt lgkmcnt(12)
    v_add_f32 v112, v112, v120
    v_add_f32 v113, v113, v121
    v_add_f32 v114, v114, v122
    v_add_f32 v115, v115, v123
    v_add_f32 v116, v116, v124
    v_add_f32 v117, v117, v125
    v_add_f32 v118, v118, v126
    v_add_f32 v119, v119, v127
    v_lshlrev_b32 v120, 16, v20
    v_and_b32 v121, 0xffff0000, v20
    v_lshlrev_b32 v122, 16, v21
    v_and_b32 v123, 0xffff0000, v21
    v_lshlrev_b32 v124, 16, v22
    v_and_b32 v125, 0xffff0000, v22
    v_lshlrev_b32 v126, 16, v23
    v_and_b32 v127, 0xffff0000, v23
    ds_read_b128 v[176:179], v18 offset:17408
    ds_read_b128 v[180:183], v18 offset:17424
    ds_read_b128 v[184:187], v18 offset:39168
    ds_read_b128 v[188:191], v18 offset:39184
    ds_read_b128 v[192:195], v4 offset:17408
    ds_read_b128 v[196:199], v4 offset:17424
    ds_read_b128 v[200:203], v4 offset:39168
    ds_read_b128 v[204:207], v4 offset:39184
    v_add_f32 v112, v112, v120
    v_add_f32 v113, v113, v121
    v_add_f32 v114, v114, v122
    v_add_f32 v115, v115, v123
    v_add_f32 v116, v116, v124
    v_add_f32 v117, v117, v125
    v_add_f32 v118, v118, v126
    v_add_f32 v119, v119, v127
    s_waitcnt lgkmcnt(15)
    v_add_f32 v128, v128, v136
    v_add_f32 v129, v129, v137
    v_add_f32 v130, v130, v138
    v_add_f32 v131, v131, v139
    v_add_f32 v132, v132, v140
    v_add_f32 v133, v133, v141
    v_add_f32 v134, v134, v142
    v_add_f32 v135, v135, v143
    v_add_f32 v112, v112, v128
    v_add_f32 v113, v113, v129
    v_add_f32 v114, v114, v130
    v_add_f32 v115, v115, v131
    v_add_f32 v116, v116, v132
    v_add_f32 v117, v117, v133
    v_add_f32 v118, v118, v134
    v_add_f32 v119, v119, v135
    v_cvt_pk_bf16_f32 v20, v112, v113
    v_cvt_pk_bf16_f32 v21, v114, v115
    v_cvt_pk_bf16_f32 v22, v116, v117
    v_cvt_pk_bf16_f32 v23, v118, v119
    buffer_store_dwordx4 v[20:23], v14, s[24:27], 0 offen nt
    s_waitcnt lgkmcnt(12)
    v_add_f32 v144, v144, v152
    v_add_f32 v145, v145, v153
    v_add_f32 v146, v146, v154
    v_add_f32 v147, v147, v155
    v_add_f32 v148, v148, v156
    v_add_f32 v149, v149, v157
    v_add_f32 v150, v150, v158
    v_add_f32 v151, v151, v159
    v_lshlrev_b32 v152, 16, v24
    v_and_b32 v153, 0xffff0000, v24
    v_lshlrev_b32 v154, 16, v25
    v_and_b32 v155, 0xffff0000, v25
    v_lshlrev_b32 v156, 16, v26
    v_and_b32 v157, 0xffff0000, v26
    v_lshlrev_b32 v158, 16, v27
    v_and_b32 v159, 0xffff0000, v27
    v_add_f32 v144, v144, v152
    v_add_f32 v145, v145, v153
    v_add_f32 v146, v146, v154
    v_add_f32 v147, v147, v155
    v_add_f32 v148, v148, v156
    v_add_f32 v149, v149, v157
    v_add_f32 v150, v150, v158
    v_add_f32 v151, v151, v159
    s_waitcnt lgkmcnt(8)
    v_add_f32 v160, v160, v168
    v_add_f32 v161, v161, v169
    v_add_f32 v162, v162, v170
    v_add_f32 v163, v163, v171
    v_add_f32 v164, v164, v172
    v_add_f32 v165, v165, v173
    v_add_f32 v166, v166, v174
    v_add_f32 v167, v167, v175
    v_add_f32 v144, v144, v160
    v_add_f32 v145, v145, v161
    v_add_f32 v146, v146, v162
    v_add_f32 v147, v147, v163
    v_add_f32 v148, v148, v164
    v_add_f32 v149, v149, v165
    v_add_f32 v150, v150, v166
    v_add_f32 v151, v151, v167
    v_cvt_pk_bf16_f32 v24, v144, v145
    v_cvt_pk_bf16_f32 v25, v146, v147
    v_cvt_pk_bf16_f32 v26, v148, v149
    v_cvt_pk_bf16_f32 v27, v150, v151
    buffer_store_dwordx4 v[24:27], v15, s[24:27], 0 offen nt
    s_waitcnt lgkmcnt(4)
    v_add_f32 v176, v176, v184
    v_add_f32 v177, v177, v185
    v_add_f32 v178, v178, v186
    v_add_f32 v179, v179, v187
    v_add_f32 v180, v180, v188
    v_add_f32 v181, v181, v189
    v_add_f32 v182, v182, v190
    v_add_f32 v183, v183, v191
    v_lshlrev_b32 v184, 16, v28
    v_and_b32 v185, 0xffff0000, v28
    v_lshlrev_b32 v186, 16, v29
    v_and_b32 v187, 0xffff0000, v29
    v_lshlrev_b32 v188, 16, v30
    v_and_b32 v189, 0xffff0000, v30
    v_lshlrev_b32 v190, 16, v31
    v_and_b32 v191, 0xffff0000, v31
    v_add_f32 v176, v176, v184
    v_add_f32 v177, v177, v185
    v_add_f32 v178, v178, v186
    v_add_f32 v179, v179, v187
    v_add_f32 v180, v180, v188
    v_add_f32 v181, v181, v189
    v_add_f32 v182, v182, v190
    v_add_f32 v183, v183, v191
    s_waitcnt lgkmcnt(0)
    v_add_f32 v192, v192, v200
    v_add_f32 v193, v193, v201
    v_add_f32 v194, v194, v202
    v_add_f32 v195, v195, v203
    v_add_f32 v196, v196, v204
    v_add_f32 v197, v197, v205
    v_add_f32 v198, v198, v206
    v_add_f32 v199, v199, v207
    v_add_f32 v176, v176, v192
    v_add_f32 v177, v177, v193
    v_add_f32 v178, v178, v194
    v_add_f32 v179, v179, v195
    v_add_f32 v180, v180, v196
    v_add_f32 v181, v181, v197
    v_add_f32 v182, v182, v198
    v_add_f32 v183, v183, v199
    v_cvt_pk_bf16_f32 v28, v176, v177
    v_cvt_pk_bf16_f32 v29, v178, v179
    v_cvt_pk_bf16_f32 v30, v180, v181
    v_cvt_pk_bf16_f32 v31, v182, v183
    buffer_store_dwordx4 v[28:31], v16, s[24:27], 0 offen nt
L3_end:
    s_endpgm
L3_two:
    s_waitcnt lgkmcnt(12)
    v_add_f32 v112, v112, v120
    v_add_f32 v113, v113, v121
    v_add_f32 v114, v114, v122
    v_add_f32 v115, v115, v123
    v_add_f32 v116, v116, v124
    v_add_f32 v117, v117, v125
    v_add_f32 v118, v118, v126
    v_add_f32 v119, v119, v127
    v_lshlrev_b32 v120, 16, v20
    v_and_b32 v121, 0xffff0000, v20
    v_lshlrev_b32 v122, 16, v21
    v_and_b32 v123, 0xffff0000, v21
    v_lshlrev_b32 v124, 16, v22
    v_and_b32 v125, 0xffff0000, v22
    v_lshlrev_b32 v126, 16, v23
    v_and_b32 v127, 0xffff0000, v23
    v_add_f32 v112, v112, v120
    v_add_f32 v113, v113, v121
    v_add_f32 v114, v114, v122
    v_add_f32 v115, v115, v123
    v_add_f32 v116, v116, v124
    v_add_f32 v117, v117, v125
    v_add_f32 v118, v118, v126
    v_add_f32 v119, v119, v127
    s_waitcnt lgkmcnt(8)
    v_add_f32 v128, v128, v136
    v_add_f32 v129, v129, v137
    v_add_f32 v130, v130, v138
    v_add_f32 v131, v131, v139
    v_add_f32 v132, v132, v140
    v_add_f32 v133, v133, v141
    v_add_f32 v134, v134, v142
    v_add_f32 v135, v135, v143
    v_add_f32 v112, v112, v128
    v_add_f32 v113, v113, v129
    v_add_f32 v114, v114, v130
    v_add_f32 v115, v115, v131
    v_add_f32 v116, v116, v132
    v_add_f32 v117, v117, v133
    v_add_f32 v118, v118, v134
    v_add_f32 v119, v119, v135
    v_cvt_pk_bf16_f32 v20, v112, v113
    v_cvt_pk_bf16_f32 v21, v114, v115
    v_cvt_pk_bf16_f32 v22, v116, v117
    v_cvt_pk_bf16_f32 v23, v118, v119
    buffer_store_dwordx4 v[20:23], v14, s[24:27], 0 offen nt
    s_waitcnt lgkmcnt(4)
    v_add_f32 v144, v144, v152
    v_add_f32 v145, v145, v153
    v_add_f32 v146, v146, v154
    v_add_f32 v147, v147, v155
    v_add_f32 v148, v148, v156
    v_add_f32 v149, v149, v157
    v_add_f32 v150, v150, v158
    v_add_f32 v151, v151, v159
    v_lshlrev_b32 v152, 16, v24
    v_and_b32 v153, 0xffff0000, v24
    v_lshlrev_b32 v154, 16, v25
    v_and_b32 v155, 0xffff0000, v25
    v_lshlrev_b32 v156, 16, v26
    v_and_b32 v157, 0xffff0000, v26
    v_lshlrev_b32 v158, 16, v27
    v_and_b32 v159, 0xffff0000, v27
    v_add_f32 v144, v144, v152
    v_add_f32 v145, v145, v153
    v_add_f32 v146, v146, v154
    v_add_f32 v147, v147, v155
    v_add_f32 v148, v148, v156
    v_add_f32 v149, v149, v157
    v_add_f32 v150, v150, v158
    v_add_f32 v151, v151, v159
    s_waitcnt lgkmcnt(0)
    v_add_f32 v160, v160, v168
    v_add_f32 v161, v161, v169
    v_add_f32 v162, v162, v170
    v_add_f32 v163, v163, v171
    v_add_f32 v164, v164, v172
    v_add_f32 v165, v165, v173
    v_add_f32 v166, v166, v174
    v_add_f32 v167, v167, v175
    v_add_f32 v144, v144, v160
    v_add_f32 v145, v145, v161
    v_add_f32 v146, v146, v162
    v_add_f32 v147, v147, v163
    v_add_f32 v148, v148, v164
    v_add_f32 v149, v149, v165
    v_add_f32 v150, v150, v166
    v_add_f32 v151, v151, v167
    v_cvt_pk_bf16_f32 v24, v144, v145
    v_cvt_pk_bf16_f32 v25, v146, v147
    v_cvt_pk_bf16_f32 v26, v148, v149
    v_cvt_pk_bf16_f32 v27, v150, v151
    buffer_store_dwordx4 v[24:27], v15, s[24:27], 0 offen nt
    s_endpgm
L3_codeend:
L_allend:
.section .rodata,"a"
.p2align 6
.amdhsa_kernel k1_proj_kernel
  .amdhsa_next_free_vgpr 256
  .amdhsa_next_free_sgpr 100
  .amdhsa_accum_offset 256
  .amdhsa_group_segment_fixed_size 0
  .amdhsa_kernarg_size 88
  .amdhsa_user_sgpr_count 2
  .amdhsa_user_sgpr_kernarg_segment_ptr 1
  .amdhsa_system_sgpr_workgroup_id_x 1
  .amdhsa_float_denorm_mode_32 3
.end_amdhsa_kernel
.p2align 6
.amdhsa_kernel k3_out_kernel
  .amdhsa_next_free_vgpr 292
  .amdhsa_next_free_sgpr 96
  .amdhsa_accum_offset 212
  .amdhsa_group_segment_fixed_size 0
  .amdhsa_kernarg_size 88
  .amdhsa_user_sgpr_count 2
  .amdhsa_user_sgpr_kernarg_segment_ptr 1
  .amdhsa_system_sgpr_workgroup_id_x 1
  .amdhsa_float_denorm_mode_32 3
.end_amdhsa_kernel
```
